```python
import torch

def _softmax(x, axis=-1):
    return torch.softmax(x, dim=axis)
def _gelu(x):
    return torch.nn.functional.gelu(x, approximate="tanh")
def _silu(x):
    return torch.nn.functional.silu(x)
def _sigmoid(x):
    return torch.sigmoid(x)
def _layernorm(x, axis=-1, eps=1e-5):
    m = x.mean(dim=axis, keepdim=True)
    v = x.var(dim=axis, keepdim=True, unbiased=False)
    return (x - m) / torch.sqrt(v + eps)
def _scatter_add(tgt, idx, src, axis=0):
    return tgt.clone().index_add_(axis, idx, src)
def _segment_sum(src, seg, n):
    out = torch.zeros((n,) + src.shape[1:], dtype=src.dtype)
    return out.index_add_(0, seg, src)
def _pad(x, pw):
    flat = tuple(v for pair in reversed(pw) for v in pair)
    return torch.nn.functional.pad(x, flat)

kernel_name = 'parallel_sum__ssm_conv_s4d__glu_gated_reglu__prompt'

def setup_inputs():

    _w = (lambda a: (lambda t: t.to(torch.bfloat16) if t.is_floating_point() else t)(torch.as_tensor(a)))
    def _A_setup():
        Bsz, L, D, N = 1, 2048, 640, 128
        return {
            "u": _w((lambda *s: torch.randn(*s, dtype=torch.bfloat16) * 0.05)(Bsz, L, D)),
            "log_A_real": _w((lambda *s: torch.randn(*s, dtype=torch.bfloat16) * 3.2)(D, N) * 0.5),
            "A_imag": _w((lambda *s: torch.randn(*s, dtype=torch.bfloat16) * 0.05)(D, N) * 3.14),
            "C_real": _w((lambda *s: torch.randn(*s, dtype=torch.bfloat16) * 0.2)(D, N) / N ** 0.5),
            "C_imag": _w((lambda *s: torch.randn(*s, dtype=torch.bfloat16) * 0.2)(D, N) / N ** 0.5),
            "log_dt": _w((lambda *s: torch.randn(*s, dtype=torch.bfloat16) * 0.05)(D) * 0.5 - 4.0),
            "D_skip": _w((lambda *s: torch.randn(*s, dtype=torch.bfloat16) * 0.05)(D)),
        }
    _A_in = _A_setup()

    def _B_setup():
        B, S, D, F = 1, 2048, 640, 1728
        return {
            "x": _w((lambda *s: torch.randn(*s, dtype=torch.bfloat16) * 0.05)(B, S, D)),
            "W_gate": _w((lambda *s: torch.randn(*s, dtype=torch.bfloat16) * 0.4)(D, F) * (2.0 / D) ** 0.5),
            "W_up": _w((lambda *s: torch.randn(*s, dtype=torch.bfloat16) * 0.4)(D, F) * (2.0 / D) ** 0.5),
            "W_down": _w((lambda *s: torch.randn(*s, dtype=torch.bfloat16) * 0.4)(F, D) * (1.0 / F) ** 0.5),
        }
    _B_in = _B_setup()

    return {
        "A_u": _A_in["u"],
        "A_log_A_real": _A_in["log_A_real"],
        "A_A_imag": _A_in["A_imag"],
        "A_C_real": _A_in["C_real"],
        "A_C_imag": _A_in["C_imag"],
        "A_log_dt": _A_in["log_dt"],
        "A_D_skip": _A_in["D_skip"],
        "B_x": _B_in["x"],
        "B_W_gate": _B_in["W_gate"],
        "B_W_up": _B_in["W_up"],
        "B_W_down": _B_in["W_down"],
    }

def reference(A_u, A_log_A_real, A_A_imag, A_C_real, A_C_imag, A_log_dt, A_D_skip, B_x, B_W_gate, B_W_up, B_W_down):
    def _A_ref(u, log_A_real, A_imag, C_real, C_imag, log_dt, D_skip):
        L = u.shape[1]
        dt = torch.exp(log_dt)
        A = -torch.exp(log_A_real) + 1j * A_imag
        C = (C_real + 1j * C_imag) * dt[:, None]
        pos = (lambda x, dt: x.to(dt))(torch.arange(L), log_dt.dtype)
        P = torch.exp((A * dt[:, None])[:, :, None] * pos[None, None, :])
        K = 2.0 * torch.einsum("dn,dnl->dl", C, P).real
        L2 = 2 * L
        u_t = (lambda x, *d: x.permute(*d))(u, 0, 2, 1)
        Kf = (lambda x, *a, **k: torch.fft.rfft(x.float(), *a, **k))(K, L2)
        Uf = (lambda x, *a, **k: torch.fft.rfft(x.float(), *a, **k))(u_t, L2)
        y = (lambda x, *a, **k: torch.fft.irfft(x, *a, **k).to(torch.bfloat16))(Uf * Kf[None, :, :], L2)[:, :, :L]
        y = (lambda x, *d: x.permute(*d))(y, 0, 2, 1)
        return y + u * D_skip[None, None, :]

    def _B_ref(x, W_gate, W_up, W_down):
        gate = torch.einsum("bsd,df->bsf", x, W_gate)
        up = torch.einsum("bsd,df->bsf", x, W_up)
        gate = gate * (lambda x, dt: x.to(dt))(gate > 0, gate.dtype)
        h = gate * up
        return torch.einsum("bsf,fd->bsd", h, W_down)

    x = A_u
    xn = _layernorm(x, axis=-1)
    return x + _A_ref(xn, A_log_A_real, A_A_imag, A_C_real, A_C_imag, A_log_dt, A_D_skip) + _B_ref(xn, B_W_gate, B_W_up, B_W_down)
```

```asm
; @launch grid=(256,1,1) block=(512,1,1) lds=161920
.amdgcn_target "amdgcn-amd-amdhsa--gfx950"
.text
.globl parallel_sum__ssm_conv_s4d__glu_gated_reglu__prompt_kernel
.p2align 8
.type parallel_sum__ssm_conv_s4d__glu_gated_reglu__prompt_kernel,@function
parallel_sum__ssm_conv_s4d__glu_gated_reglu__prompt_kernel:
    s_cmp_ge_u32 s2, 256
    s_cbranch_scc1 L_END
    s_load_dwordx16 s[40:55], s[0:1], 0
    s_load_dwordx8 s[56:63], s[0:1], 64
    s_load_dwordx4 s[64:67], s[0:1], 96
    s_getpc_b64 s[4:5]
L_PC0:
    v_cmp_gt_u32 vcc, 16, v0
    s_lshr_b32 s6, s2, 3
    s_lshl_b32 s6, s6, 11
    v_lshlrev_b32 v6, 7, v0
    v_add_u32 v6, s6, v6
    v_min_u32 v6, L_TABLE-L_PC0, v6
    s_and_saveexec_b64 s[8:9], vcc
    s_cbranch_execz L_NOPF
    global_load_dword v255, v6, s[4:5]
L_NOPF:
    s_mov_b64 exec, -1
    v_lshrrev_b32 v1, 6, v0
    v_min_u32 v3, 159, v0
    v_and_b32 v0, 63, v0
    v_mov_b32 v2, 0
    v_readfirstlane_b32 s3, v1
    v_lshlrev_b32 v3, 2, v3
    v_add_u32 v3, 161280, v3
    ds_write_b32 v3, v2
    s_and_b32 s68, s2, 7
    s_lshr_b32 s69, s2, 3
    s_lshr_b32 s77, s68, 2
    s_lshl_b32 s77, s77, 3
    s_and_b32 s78, s68, 3
    s_mul_i32 s79, s78, 7
    s_add_u32 s79, s79, 1
    s_lshr_b32 s79, s79, 1
    s_and_b32 s70, s69, 7
    s_lshr_b32 s71, s69, 3
    s_add_u32 s71, s71, s79
    s_and_b32 s80, s78, 1
    s_lshl_b32 s80, s80, 2
    s_and_b32 s81, s69, 3
    s_add_u32 s80, s80, s81
    s_lshr_b32 s81, s78, 1
    s_mul_i32 s81, s81, 7
    s_add_u32 s81, s81, 3
    s_cmp_ge_u32 s69, 24
    s_cselect_b32 s70, s80, s70
    s_cselect_b32 s71, s81, s71
    s_add_u32 s70, s70, s77
    s_lshl_b32 s74, s68, 5
    s_add_u32 s74, s74, s69
    s_lshr_b32 s72, s68, 1
    s_lshl_b32 s72, s72, 3
    s_and_b32 s79, s69, 7
    s_add_u32 s72, s72, s79
    s_and_b32 s73, s68, 1
    s_lshl_b32 s73, s73, 2
    s_lshr_b32 s79, s69, 3
    s_add_u32 s73, s73, s79
    s_lshl_b32 s79, s69, 1
    s_mul_i32 s80, s69, 6
    s_sub_u32 s80, s80, 112
    s_cmp_ge_u32 s69, 28
    s_cselect_b32 s79, s80, s79
    s_mov_b32 s76, 4
    s_mul_i32 s75, s68, 80
    s_add_u32 s75, s75, s79
    s_lshr_b32 s77, s3, 1
    s_cmp_ge_u32 s69, 28
    s_cselect_b32 s78, s3, s77
    s_cselect_b32 s77, 0, s77
    s_cselect_b32 s79, 6, 4
    s_cmp_eq_u32 s77, 2
    s_cbranch_scc1 L_LDPRE
    s_add_u32 s14, s75, s78
    s_lshl_b32 s77, s14, 8
    v_lshlrev_b32 v1, 2, v0
    v_add_u32 v1, s77, v1
    s_lshl_b32 s77, s14, 1
    v_mov_b32 v4, s77
    s_cmp_ge_u32 s3, s79
    s_waitcnt lgkmcnt(0)
    s_cbranch_scc1 L_NPAR
    global_load_dword v52, v1, s[42:43]
    global_load_dword v53, v1, s[44:45]
    global_load_dword v54, v1, s[46:47]
    global_load_dword v55, v1, s[48:49]
    global_load_ushort v56, v4, s[50:51]
L_NPAR:
    s_cmp_ge_u32 s69, 28
    s_cselect_b32 s55, 1, 0
    s_add_u32 s66, s66, 125829120
    s_addc_u32 s67, s67, 0
    s_or_b32 s4, s2, s3
    s_cmp_lg_u32 s4, 0
    s_cbranch_scc1 L_NTOK
    s_memrealtime s[12:13]
    s_mov_b32 s36, s64
    s_and_b32 s37, s65, 0xffff
    s_mov_b32 s38, 256
    s_mov_b32 s39, 0x00020000
    s_waitcnt lgkmcnt(0)
    s_or_b32 s12, s12, 1
    v_mov_b32 v5, s12
    s_mov_b64 exec, 1
    buffer_store_dword v5, off, s[36:39], 0 sc1
    s_mov_b64 exec, -1
L_NTOK:
    s_barrier
    s_cmp_lt_u32 s3, 6
    s_cbranch_scc1 L_NAUX
    s_sub_u32 s15, s3, 6
    s_mul_i32 s15, s15, 22528
    s_add_u32 s15, s15, 114688
    s_cmp_eq_u32 s55, 0
    s_cbranch_scc1 L_EXP2
L_AUXD:
    s_add_u32 s4, s3, s55
    s_cmp_lt_u32 s4, 8
    s_cbranch_scc1 L_LN
    s_branch L_W7
L_NAUX:
    s_cmp_eq_u32 s55, 1
    s_cbranch_scc1 L_HELPK
    s_branch L_CK
L_LDPRE:
    v_lshrrev_b32 v3, 3, v0
    v_mul_u32_u24 v4, 1280, v3
    v_lshrrev_b32 v5, 4, v0
    v_and_b32 v6, 7, v0
    v_xor_b32 v7, v6, v5
    v_lshl_add_u32 v10, v7, 4, v4
    v_xor_b32 v7, 4, v7
    v_lshl_add_u32 v11, v7, 4, v4
    v_add_u32 v11, 10240, v11
    s_sub_u32 s20, s3, 4
    v_bfe_u32 v7, v0, 1, 3
    v_xor_b32 v7, v7, v5
    v_lshlrev_b32 v7, 5, v7
    v_and_b32 v6, 1, v0
    v_lshl_add_u32 v7, v6, 4, v7
    v_mul_u32_u24 v5, 3456, v5
    v_add_u32 v12, v5, v7
    v_xor_b32 v7, 128, v7
    v_add_u32 v14, v5, v7
    s_cmp_eq_u32 s71, 13
    s_cselect_b32 s77, 128, 0
    v_and_b32 v6, s77, v7
    v_lshlrev_b32 v6, 23, v6
    v_or_b32 v14, v14, v6
    v_xor_b32 v7, 128, v7
    v_and_b32 v6, s77, v7
    v_lshlrev_b32 v6, 23, v6
    v_or_b32 v12, v12, v6
    s_mul_i32 s21, s70, 163840
    s_mul_i32 s77, s20, 81920
    s_add_u32 s21, s21, s77
    s_lshl_b32 s23, s20, 13
    s_lshl_b32 s22, s71, 8
    s_add_u32 s24, s23, 49152
    s_mul_i32 s29, s70, 1
    s_lshr_b32 s77, s71, 0
    s_mul_i32 s77, s77, 2
    s_add_u32 s29, s29, s77
    s_mul_hi_u32 s77, s29, 858993460
    s_mul_i32 s77, s77, 5
    s_sub_u32 s29, s29, s77
    s_lshl_b32 s28, s20, 8
    s_add_u32 s28, s28, 161408
    s_getpc_b64 s[30:31]
L_PCREF:
    s_add_u32 s30, s30, L_TABLE-L_PCREF
    s_addc_u32 s31, s31, 0
    v_mov_b32 v20, 0
    v_mov_b32 v21, 161280
    v_min_u32 v22, 3, v0
    v_lshlrev_b32 v22, 2, v22
    v_add_u32 v22, 161280, v22
    v_mov_b32 v28, 0
    s_lshr_b32 s77, s2, 2
    s_mul_i32 s77, s77, 40960
    s_and_b32 s78, s2, 3
    s_mul_i32 s78, s78, 5120
    s_add_u32 s77, s77, s78
    s_mul_i32 s16, s74, 10240
    s_cmp_eq_u32 s3, 4
    s_mov_b32 s14, 2211840
    s_cselect_b32 s14, 2621440, s14
    s_mov_b32 s17, 147968
    s_cselect_b32 s17, 125440, s17
    s_cselect_b32 s18, 0, 15360
    s_cselect_b32 s16, s16, s77
    s_cselect_b32 s19, 0, 1
    v_and_b32 v13, 7, v0
    v_lshl_add_u32 v13, v13, 4, v4
    v_lshrrev_b32 v6, 5, v0
    v_mad_u32_u24 v13, v6, s18, v13
    s_lshl_b32 s18, s20, 2
    s_add_u32 s18, s18, 161396
    s_mov_b32 s25, 0
    s_mov_b32 s26, 0
    s_mov_b32 s27, 0
    s_mov_b32 s33, 0
    s_cmp_ge_u32 s68, 4
    s_cselect_b32 s32, 5, 0
    s_waitcnt lgkmcnt(0)
    s_mov_b32 s55, 0
    s_add_u32 s66, s66, 125829120
    s_addc_u32 s67, s67, 0
    s_mov_b32 s4, s40
    s_and_b32 s5, s41, 0xffff
    s_mov_b32 s6, 2621440
    s_mov_b32 s7, 0x00020000
    s_cmp_eq_u32 s3, 4
    s_cselect_b32 s8, s56, s58
    s_cselect_b32 s9, s57, s59
    s_cselect_b32 s12, s4, s60
    s_cselect_b32 s13, s5, s61
    s_and_b32 s9, s9, 0xffff
    s_mov_b32 s10, 2211840
    s_mov_b32 s11, 0x00020000
    s_and_b32 s13, s13, 0xffff
    s_mov_b32 s15, 0x00020000
    s_barrier
    s_setprio 0
L_LDLOOP:
    s_cmp_ge_u32 s27, 5
    s_cselect_b32 s77, 5, 0
    s_xor_b32 s77, s77, s32
    s_add_u32 s77, s77, s29
    s_lshl_b32 s78, s77, 7
    s_add_u32 s78, s78, s21
    s_mul_i32 s79, s77, 221184
    s_add_u32 s79, s79, s22
    s_add_u32 s29, s29, 1
    s_cmp_ge_u32 s29, 5
    s_cselect_b32 s29, 0, s29
    s_add_u32 s80, s25, s23
    s_lshl_b32 s81, s27, 1
    s_sub_u32 s82, s19, 0
    s_cmp_lg_u32 s82, s81
    s_cbranch_scc1 NK1
    s_waitcnt vmcnt(48)
    s_add_u32 m0, s17, 0
    s_nop 0
    buffer_load_dwordx4 v13, s[12:15], s16 offen offset:0  lds
    s_add_u32 m0, s17, 896
    s_nop 0
    buffer_load_dwordx4 v13, s[12:15], s16 offen offset:128  lds
    s_add_u32 m0, s17, 1792
    s_nop 0
    buffer_load_dwordx4 v13, s[12:15], s16 offen offset:256  lds
    s_add_u32 m0, s17, 2688
    s_nop 0
    buffer_load_dwordx4 v13, s[12:15], s16 offen offset:384  lds
    global_load_dword v29, v20, s[30:31]
    s_add_u32 m0, s17, 3584
    s_nop 0
    buffer_load_dwordx4 v13, s[12:15], s16 offen offset:512  lds
    s_add_u32 m0, s17, 4480
    s_nop 0
    buffer_load_dwordx4 v13, s[12:15], s16 offen offset:640  lds
    s_add_u32 m0, s17, 5376
    s_nop 0
    buffer_load_dwordx4 v13, s[12:15], s16 offen offset:768  lds
    s_add_u32 m0, s17, 6272
    s_nop 0
    buffer_load_dwordx4 v13, s[12:15], s16 offen offset:896  lds
    global_load_dword v29, v20, s[30:31]
    s_add_u32 m0, s17, 7168
    s_nop 0
    buffer_load_dwordx4 v13, s[12:15], s16 offen offset:1024  lds
    s_add_u32 m0, s17, 8064
    s_nop 0
    buffer_load_dwordx4 v13, s[12:15], s16 offen offset:1152  lds
    s_mov_b32 m0, s18
    s_mov_b64 exec, 1
    global_load_lds_dword v20, s[30:31]
    s_mov_b64 exec, -1
NK1:
    s_add_i32 s81, s81, -3
    s_waitcnt vmcnt(42)
    s_waitcnt lgkmcnt(0)
    v_cmp_gt_i32 vcc, s81, v28
    s_cbranch_vccz NS2
    s_mov_b32 s83, 200000
NP3:
    s_sleep 1
    ds_read_b32 v28, v22
    s_sub_u32 s83, s83, 1
    s_cbranch_scc1 NS2
    s_waitcnt lgkmcnt(0)
    v_cmp_gt_i32 vcc, s81, v28
    s_cbranch_vccnz NP3
NS2:
    s_add_u32 s81, s26, s24
    s_add_u32 m0, s80, 0
    s_add_u32 s82, s78, 0
    buffer_load_dwordx4 v10, s[4:7], s82 offen  lds
    s_add_u32 m0, s81, 0
    s_add_u32 s82, s79, 0
    buffer_load_dwordx4 v12, s[8:11], s82 offen  lds
    s_add_u32 m0, s80, 1024
    s_add_u32 s82, s78, 0
    buffer_load_dwordx4 v11, s[4:7], s82 offen  lds
    s_add_u32 m0, s81, 1024
    s_add_u32 s82, s79, 13824
    buffer_load_dwordx4 v12, s[8:11], s82 offen  lds
    global_load_dword v29, v20, s[30:31]
    s_add_u32 m0, s80, 2048
    s_add_u32 s82, s78, 20480
    buffer_load_dwordx4 v10, s[4:7], s82 offen  lds
    s_add_u32 m0, s81, 2048
    s_add_u32 s82, s79, 27648
    buffer_load_dwordx4 v14, s[8:11], s82 offen  lds
    s_add_u32 m0, s80, 3072
    s_add_u32 s82, s78, 20480
    buffer_load_dwordx4 v11, s[4:7], s82 offen  lds
    s_add_u32 m0, s81, 3072
    s_add_u32 s82, s79, 41472
    buffer_load_dwordx4 v14, s[8:11], s82 offen  lds
    global_load_dword v29, v20, s[30:31]
    s_add_u32 m0, s80, 4096
    s_add_u32 s82, s78, 40960
    buffer_load_dwordx4 v10, s[4:7], s82 offen  lds
    s_add_u32 m0, s81, 4096
    s_add_u32 s82, s79, 55296
    buffer_load_dwordx4 v12, s[8:11], s82 offen  lds
    s_add_u32 m0, s80, 5120
    s_add_u32 s82, s78, 40960
    buffer_load_dwordx4 v11, s[4:7], s82 offen  lds
    s_add_u32 m0, s81, 5120
    s_add_u32 s82, s79, 69120
    buffer_load_dwordx4 v12, s[8:11], s82 offen  lds
    global_load_dword v29, v20, s[30:31]
    s_add_u32 m0, s80, 6144
    s_add_u32 s82, s78, 61440
    buffer_load_dwordx4 v10, s[4:7], s82 offen  lds
    s_add_u32 m0, s81, 6144
    s_add_u32 s82, s79, 82944
    buffer_load_dwordx4 v14, s[8:11], s82 offen  lds
    s_waitcnt lgkmcnt(0)
    ds_read_b32 v28, v22
    s_add_u32 m0, s80, 7168
    s_add_u32 s82, s78, 61440
    buffer_load_dwordx4 v11, s[4:7], s82 offen  lds
    s_add_u32 m0, s81, 7168
    s_add_u32 s82, s79, 96768
    buffer_load_dwordx4 v14, s[8:11], s82 offen  lds
    global_load_dword v29, v20, s[30:31]
    s_mov_b32 m0, s28
    s_add_u32 s26, s26, 16384
    global_load_lds_dword v20, s[30:31]
    s_add_u32 s30, s30, 4
    s_addc_u32 s31, s31, 0
    s_cmp_ge_u32 s26, 65536
    s_cselect_b32 s26, 0, s26
    s_lshl_b32 s81, s27, 1
    s_sub_u32 s82, s19, 1
    s_cmp_lg_u32 s82, s81
    s_cbranch_scc1 NK4
    s_waitcnt vmcnt(48)
    s_add_u32 m0, s17, 0
    s_nop 0
    buffer_load_dwordx4 v13, s[12:15], s16 offen offset:0  lds
    s_add_u32 m0, s17, 896
    s_nop 0
    buffer_load_dwordx4 v13, s[12:15], s16 offen offset:128  lds
    s_add_u32 m0, s17, 1792
    s_nop 0
    buffer_load_dwordx4 v13, s[12:15], s16 offen offset:256  lds
    s_add_u32 m0, s17, 2688
    s_nop 0
    buffer_load_dwordx4 v13, s[12:15], s16 offen offset:384  lds
    global_load_dword v29, v20, s[30:31]
    s_add_u32 m0, s17, 3584
    s_nop 0
    buffer_load_dwordx4 v13, s[12:15], s16 offen offset:512  lds
    s_add_u32 m0, s17, 4480
    s_nop 0
    buffer_load_dwordx4 v13, s[12:15], s16 offen offset:640  lds
    s_add_u32 m0, s17, 5376
    s_nop 0
    buffer_load_dwordx4 v13, s[12:15], s16 offen offset:768  lds
    s_add_u32 m0, s17, 6272
    s_nop 0
    buffer_load_dwordx4 v13, s[12:15], s16 offen offset:896  lds
    global_load_dword v29, v20, s[30:31]
    s_add_u32 m0, s17, 7168
    s_nop 0
    buffer_load_dwordx4 v13, s[12:15], s16 offen offset:1024  lds
    s_add_u32 m0, s17, 8064
    s_nop 0
    buffer_load_dwordx4 v13, s[12:15], s16 offen offset:1152  lds
    s_mov_b32 m0, s18
    s_mov_b64 exec, 1
    global_load_lds_dword v20, s[30:31]
    s_mov_b64 exec, -1
NK4:
    s_add_i32 s81, s81, -2
    s_waitcnt vmcnt(52)
    s_waitcnt lgkmcnt(0)
    v_cmp_gt_i32 vcc, s81, v28
    s_cbranch_vccz NS5
    s_mov_b32 s83, 200000
NP6:
    s_sleep 1
    ds_read_b32 v28, v22
    s_sub_u32 s83, s83, 1
    s_cbranch_scc1 NS5
    s_waitcnt lgkmcnt(0)
    v_cmp_gt_i32 vcc, s81, v28
    s_cbranch_vccnz NP6
NS5:
    s_add_u32 s81, s26, s24
    s_add_u32 m0, s81, 0
    s_add_u32 s82, s79, 110592
    buffer_load_dwordx4 v12, s[8:11], s82 offen  lds
    s_add_u32 m0, s81, 1024
    s_add_u32 s82, s79, 124416
    buffer_load_dwordx4 v12, s[8:11], s82 offen  lds
    s_add_u32 m0, s81, 2048
    s_add_u32 s82, s79, 138240
    buffer_load_dwordx4 v14, s[8:11], s82 offen  lds
    s_add_u32 m0, s81, 3072
    s_add_u32 s82, s79, 152064
    buffer_load_dwordx4 v14, s[8:11], s82 offen  lds
    global_load_dword v29, v20, s[30:31]
    s_add_u32 m0, s81, 4096
    s_add_u32 s82, s79, 165888
    buffer_load_dwordx4 v12, s[8:11], s82 offen  lds
    s_add_u32 m0, s81, 5120
    s_add_u32 s82, s79, 179712
    buffer_load_dwordx4 v12, s[8:11], s82 offen  lds
    s_add_u32 m0, s81, 6144
    s_add_u32 s82, s79, 193536
    buffer_load_dwordx4 v14, s[8:11], s82 offen  lds
    s_waitcnt lgkmcnt(0)
    ds_read_b32 v28, v22
    s_add_u32 m0, s81, 7168
    s_add_u32 s82, s79, 207360
    buffer_load_dwordx4 v14, s[8:11], s82 offen  lds
    global_load_dword v29, v20, s[30:31]
    s_mov_b32 m0, s28
    s_add_u32 s26, s26, 16384
    global_load_lds_dword v20, s[30:31]
    s_add_u32 s30, s30, 4
    s_addc_u32 s31, s31, 0
    s_cmp_ge_u32 s26, 65536
    s_cselect_b32 s26, 0, s26
    s_add_u32 s25, s25, 16384
    s_cmp_ge_u32 s25, 49152
    s_cselect_b32 s25, 0, s25
    s_add_u32 s27, s27, 1
    s_cmp_lt_u32 s27, 10
    s_cbranch_scc1 L_LDLOOP
    s_setprio 0
    v_mov_b32 v1, 161280
    v_mov_b32 v3, 1
    s_mov_b64 exec, 1
    ds_add_u32 v1, v3 offset:124
    s_mov_b64 exec, -1
    s_mov_b32 s16, s66
    s_and_b32 s17, s67, 0xffff
    s_mov_b32 s18, 19529728
    s_mov_b32 s19, 0x00020000
    s_branch L_G2
L_LN:
    s_setprio 0
    s_cmp_eq_u32 s55, 0
    s_cbranch_scc1 PR7
    s_setprio 2
PR7:
    s_mul_i32 s10, s74, 10240
    s_sub_u32 s9, s3, 6
    s_add_u32 s14, s75, s9
    s_mul_i32 s9, s9, 5120
    s_cmp_eq_u32 s55, 1
    s_mov_b32 s11, 90112
    s_cselect_b32 s11, s11, 125440
    s_cbranch_scc0 IG8
    s_mov_b32 s4, s40
    s_and_b32 s5, s41, 0xffff
    s_mov_b32 s6, 2621440
    s_mov_b32 s7, 0x00020000
    v_lshrrev_b32 v3, 3, v0
    v_mul_u32_u24 v3, 1280, v3
    v_and_b32 v4, 7, v0
    v_lshl_add_u32 v3, v4, 4, v3
    s_waitcnt vmcnt(48)
    s_add_u32 m0, s11, 0
    s_nop 0
    buffer_load_dwordx4 v3, s[4:7], s10 offen offset:0  lds
    s_add_u32 m0, s11, 896
    s_nop 0
    buffer_load_dwordx4 v3, s[4:7], s10 offen offset:128  lds
    s_add_u32 m0, s11, 1792
    s_nop 0
    buffer_load_dwordx4 v3, s[4:7], s10 offen offset:256  lds
    s_add_u32 m0, s11, 2688
    s_nop 0
    buffer_load_dwordx4 v3, s[4:7], s10 offen offset:384  lds
    s_add_u32 m0, s11, 3584
    s_nop 0
    buffer_load_dwordx4 v3, s[4:7], s10 offen offset:512  lds
    s_add_u32 m0, s11, 4480
    s_nop 0
    buffer_load_dwordx4 v3, s[4:7], s10 offen offset:640  lds
    s_add_u32 m0, s11, 5376
    s_nop 0
    buffer_load_dwordx4 v3, s[4:7], s10 offen offset:768  lds
    s_add_u32 m0, s11, 6272
    s_nop 0
    buffer_load_dwordx4 v3, s[4:7], s10 offen offset:896  lds
    s_add_u32 m0, s11, 7168
    s_nop 0
    buffer_load_dwordx4 v3, s[4:7], s10 offen offset:1024  lds
    s_add_u32 m0, s11, 8064
    s_nop 0
    buffer_load_dwordx4 v3, s[4:7], s10 offen offset:1152  lds
IG8:
    s_mov_b32 s16, s66
    s_and_b32 s17, s67, 0xffff
    s_mov_b32 s18, 19529728
    s_mov_b32 s19, 0x00020000
    v_bfe_u32 v4, v0, 2, 2
    v_lshlrev_b32 v4, 7, v4
    v_lshrrev_b32 v5, 4, v0
    v_lshl_add_u32 v4, v5, 5, v4
    v_and_b32 v5, 3, v0
    v_lshl_add_u32 v4, v5, 3, v4
    v_add_u32 v4, s11, v4
    v_lshlrev_b32 v5, 4, v0
    v_add_u32 v4, s9, v4
    s_add_u32 s10, s10, s9
    v_mov_b32 v8, 161280
    s_cmp_eq_u32 s55, 1
    s_cbranch_scc1 IH9
    s_mov_b32 s83, 200000
SPL11:
    ds_read_b32 v12, v8 offset:116
    s_waitcnt lgkmcnt(0)
    s_nop 0
    v_readfirstlane_b32 s82, v12
    s_sub_u32 s83, s83, 1
    s_cselect_b32 s82, -1, s82
    s_cmp_ge_u32 s82, 1
    s_cbranch_scc1 SPD12
    s_sleep 2
    s_branch SPL11
SPD12:
    s_branch II10
IH9:
    s_waitcnt vmcnt(0)
II10:
    s_mov_b32 s36, s64
    s_and_b32 s37, s65, 0xffff
    s_mov_b32 s38, 256
    s_mov_b32 s39, 0x00020000
    buffer_load_dword v9, off, s[36:39], 0 sc1
    v_add_u32 v3, s11, v5
    ds_read_b128 v[16:19], v3 offset:0
    ds_read_b128 v[20:23], v3 offset:1024
    ds_read_b128 v[24:27], v3 offset:2048
    ds_read_b128 v[28:31], v3 offset:3072
    ds_read_b128 v[32:35], v3 offset:4096
    ds_read_b128 v[36:39], v3 offset:5120
    ds_read_b128 v[40:43], v3 offset:6144
    ds_read_b128 v[44:47], v3 offset:7168
    ds_read_b128 v[48:51], v3 offset:8192
    ds_read_b128 v[52:55], v3 offset:9216
    s_mov_b32 s12, 0xffff0000
    s_waitcnt lgkmcnt(9)
    v_lshlrev_b32 v104, 16, v16
    v_and_b32 v105, s12, v16
    v_lshlrev_b32 v106, 16, v17
    v_and_b32 v107, s12, v17
    v_mov_b32 v96, v104
    v_mul_f32 v100, v104, v104
    v_mov_b32 v97, v105
    v_mul_f32 v101, v105, v105
    v_mov_b32 v98, v106
    v_mul_f32 v102, v106, v106
    v_mov_b32 v99, v107
    v_mul_f32 v103, v107, v107
    v_lshlrev_b32 v104, 16, v18
    v_and_b32 v105, s12, v18
    v_lshlrev_b32 v106, 16, v19
    v_and_b32 v107, s12, v19
    v_add_f32 v96, v96, v104
    v_fmac_f32 v100, v104, v104
    v_add_f32 v97, v97, v105
    v_fmac_f32 v101, v105, v105
    v_add_f32 v98, v98, v106
    v_fmac_f32 v102, v106, v106
    v_add_f32 v99, v99, v107
    v_fmac_f32 v103, v107, v107
    s_waitcnt lgkmcnt(8)
    v_lshlrev_b32 v104, 16, v20
    v_and_b32 v105, s12, v20
    v_lshlrev_b32 v106, 16, v21
    v_and_b32 v107, s12, v21
    v_add_f32 v96, v96, v104
    v_fmac_f32 v100, v104, v104
    v_add_f32 v97, v97, v105
    v_fmac_f32 v101, v105, v105
    v_add_f32 v98, v98, v106
    v_fmac_f32 v102, v106, v106
    v_add_f32 v99, v99, v107
    v_fmac_f32 v103, v107, v107
    v_lshlrev_b32 v104, 16, v22
    v_and_b32 v105, s12, v22
    v_lshlrev_b32 v106, 16, v23
    v_and_b32 v107, s12, v23
    v_add_f32 v96, v96, v104
    v_fmac_f32 v100, v104, v104
    v_add_f32 v97, v97, v105
    v_fmac_f32 v101, v105, v105
    v_add_f32 v98, v98, v106
    v_fmac_f32 v102, v106, v106
    v_add_f32 v99, v99, v107
    v_fmac_f32 v103, v107, v107
    s_waitcnt lgkmcnt(7)
    v_lshlrev_b32 v104, 16, v24
    v_and_b32 v105, s12, v24
    v_lshlrev_b32 v106, 16, v25
    v_and_b32 v107, s12, v25
    v_add_f32 v96, v96, v104
    v_fmac_f32 v100, v104, v104
    v_add_f32 v97, v97, v105
    v_fmac_f32 v101, v105, v105
    v_add_f32 v98, v98, v106
    v_fmac_f32 v102, v106, v106
    v_add_f32 v99, v99, v107
    v_fmac_f32 v103, v107, v107
    v_lshlrev_b32 v104, 16, v26
    v_and_b32 v105, s12, v26
    v_lshlrev_b32 v106, 16, v27
    v_and_b32 v107, s12, v27
    v_add_f32 v96, v96, v104
    v_fmac_f32 v100, v104, v104
    v_add_f32 v97, v97, v105
    v_fmac_f32 v101, v105, v105
    v_add_f32 v98, v98, v106
    v_fmac_f32 v102, v106, v106
    v_add_f32 v99, v99, v107
    v_fmac_f32 v103, v107, v107
    s_waitcnt lgkmcnt(6)
    v_lshlrev_b32 v104, 16, v28
    v_and_b32 v105, s12, v28
    v_lshlrev_b32 v106, 16, v29
    v_and_b32 v107, s12, v29
    v_add_f32 v96, v96, v104
    v_fmac_f32 v100, v104, v104
    v_add_f32 v97, v97, v105
    v_fmac_f32 v101, v105, v105
    v_add_f32 v98, v98, v106
    v_fmac_f32 v102, v106, v106
    v_add_f32 v99, v99, v107
    v_fmac_f32 v103, v107, v107
    v_lshlrev_b32 v104, 16, v30
    v_and_b32 v105, s12, v30
    v_lshlrev_b32 v106, 16, v31
    v_and_b32 v107, s12, v31
    v_add_f32 v96, v96, v104
    v_fmac_f32 v100, v104, v104
    v_add_f32 v97, v97, v105
    v_fmac_f32 v101, v105, v105
    v_add_f32 v98, v98, v106
    v_fmac_f32 v102, v106, v106
    v_add_f32 v99, v99, v107
    v_fmac_f32 v103, v107, v107
    s_waitcnt lgkmcnt(5)
    v_lshlrev_b32 v104, 16, v32
    v_and_b32 v105, s12, v32
    v_lshlrev_b32 v106, 16, v33
    v_and_b32 v107, s12, v33
    v_add_f32 v96, v96, v104
    v_fmac_f32 v100, v104, v104
    v_add_f32 v97, v97, v105
    v_fmac_f32 v101, v105, v105
    v_add_f32 v98, v98, v106
    v_fmac_f32 v102, v106, v106
    v_add_f32 v99, v99, v107
    v_fmac_f32 v103, v107, v107
    v_lshlrev_b32 v104, 16, v34
    v_and_b32 v105, s12, v34
    v_lshlrev_b32 v106, 16, v35
    v_and_b32 v107, s12, v35
    v_add_f32 v96, v96, v104
    v_fmac_f32 v100, v104, v104
    v_add_f32 v97, v97, v105
    v_fmac_f32 v101, v105, v105
    v_add_f32 v98, v98, v106
    v_fmac_f32 v102, v106, v106
    v_add_f32 v99, v99, v107
    v_fmac_f32 v103, v107, v107
    s_waitcnt lgkmcnt(4)
    v_lshlrev_b32 v104, 16, v36
    v_and_b32 v105, s12, v36
    v_lshlrev_b32 v106, 16, v37
    v_and_b32 v107, s12, v37
    v_add_f32 v96, v96, v104
    v_fmac_f32 v100, v104, v104
    v_add_f32 v97, v97, v105
    v_fmac_f32 v101, v105, v105
    v_add_f32 v98, v98, v106
    v_fmac_f32 v102, v106, v106
    v_add_f32 v99, v99, v107
    v_fmac_f32 v103, v107, v107
    v_lshlrev_b32 v104, 16, v38
    v_and_b32 v105, s12, v38
    v_lshlrev_b32 v106, 16, v39
    v_and_b32 v107, s12, v39
    v_add_f32 v96, v96, v104
    v_fmac_f32 v100, v104, v104
    v_add_f32 v97, v97, v105
    v_fmac_f32 v101, v105, v105
    v_add_f32 v98, v98, v106
    v_fmac_f32 v102, v106, v106
    v_add_f32 v99, v99, v107
    v_fmac_f32 v103, v107, v107
    ds_read_b64_tr_b16 v[56:57], v4 offset:0
    ds_read_b64_tr_b16 v[58:59], v4 offset:512
    s_waitcnt lgkmcnt(5)
    v_lshlrev_b32 v104, 16, v40
    v_and_b32 v105, s12, v40
    v_lshlrev_b32 v106, 16, v41
    v_and_b32 v107, s12, v41
    v_add_f32 v96, v96, v104
    v_fmac_f32 v100, v104, v104
    v_add_f32 v97, v97, v105
    v_fmac_f32 v101, v105, v105
    v_add_f32 v98, v98, v106
    v_fmac_f32 v102, v106, v106
    v_add_f32 v99, v99, v107
    v_fmac_f32 v103, v107, v107
    v_lshlrev_b32 v104, 16, v42
    v_and_b32 v105, s12, v42
    v_lshlrev_b32 v106, 16, v43
    v_and_b32 v107, s12, v43
    v_add_f32 v96, v96, v104
    v_fmac_f32 v100, v104, v104
    v_add_f32 v97, v97, v105
    v_fmac_f32 v101, v105, v105
    v_add_f32 v98, v98, v106
    v_fmac_f32 v102, v106, v106
    v_add_f32 v99, v99, v107
    v_fmac_f32 v103, v107, v107
    ds_read_b64_tr_b16 v[60:61], v4 offset:1024
    ds_read_b64_tr_b16 v[62:63], v4 offset:1536
    s_waitcnt lgkmcnt(6)
    v_lshlrev_b32 v104, 16, v44
    v_and_b32 v105, s12, v44
    v_lshlrev_b32 v106, 16, v45
    v_and_b32 v107, s12, v45
    v_add_f32 v96, v96, v104
    v_fmac_f32 v100, v104, v104
    v_add_f32 v97, v97, v105
    v_fmac_f32 v101, v105, v105
    v_add_f32 v98, v98, v106
    v_fmac_f32 v102, v106, v106
    v_add_f32 v99, v99, v107
    v_fmac_f32 v103, v107, v107
    v_lshlrev_b32 v104, 16, v46
    v_and_b32 v105, s12, v46
    v_lshlrev_b32 v106, 16, v47
    v_and_b32 v107, s12, v47
    v_add_f32 v96, v96, v104
    v_fmac_f32 v100, v104, v104
    v_add_f32 v97, v97, v105
    v_fmac_f32 v101, v105, v105
    v_add_f32 v98, v98, v106
    v_fmac_f32 v102, v106, v106
    v_add_f32 v99, v99, v107
    v_fmac_f32 v103, v107, v107
    ds_read_b64_tr_b16 v[64:65], v4 offset:2048
    ds_read_b64_tr_b16 v[66:67], v4 offset:2560
    s_waitcnt lgkmcnt(7)
    v_lshlrev_b32 v104, 16, v48
    v_and_b32 v105, s12, v48
    v_lshlrev_b32 v106, 16, v49
    v_and_b32 v107, s12, v49
    v_add_f32 v96, v96, v104
    v_fmac_f32 v100, v104, v104
    v_add_f32 v97, v97, v105
    v_fmac_f32 v101, v105, v105
    v_add_f32 v98, v98, v106
    v_fmac_f32 v102, v106, v106
    v_add_f32 v99, v99, v107
    v_fmac_f32 v103, v107, v107
    v_lshlrev_b32 v104, 16, v50
    v_and_b32 v105, s12, v50
    v_lshlrev_b32 v106, 16, v51
    v_and_b32 v107, s12, v51
    v_add_f32 v96, v96, v104
    v_fmac_f32 v100, v104, v104
    v_add_f32 v97, v97, v105
    v_fmac_f32 v101, v105, v105
    v_add_f32 v98, v98, v106
    v_fmac_f32 v102, v106, v106
    v_add_f32 v99, v99, v107
    v_fmac_f32 v103, v107, v107
    ds_read_b64_tr_b16 v[68:69], v4 offset:3072
    ds_read_b64_tr_b16 v[70:71], v4 offset:3584
    s_waitcnt lgkmcnt(8)
    v_lshlrev_b32 v104, 16, v52
    v_and_b32 v105, s12, v52
    v_lshlrev_b32 v106, 16, v53
    v_and_b32 v107, s12, v53
    v_add_f32 v96, v96, v104
    v_fmac_f32 v100, v104, v104
    v_add_f32 v97, v97, v105
    v_fmac_f32 v101, v105, v105
    v_add_f32 v98, v98, v106
    v_fmac_f32 v102, v106, v106
    v_add_f32 v99, v99, v107
    v_fmac_f32 v103, v107, v107
    v_lshlrev_b32 v104, 16, v54
    v_and_b32 v105, s12, v54
    v_lshlrev_b32 v106, 16, v55
    v_and_b32 v107, s12, v55
    v_add_f32 v96, v96, v104
    v_fmac_f32 v100, v104, v104
    v_add_f32 v97, v97, v105
    v_fmac_f32 v101, v105, v105
    v_add_f32 v98, v98, v106
    v_fmac_f32 v102, v106, v106
    v_add_f32 v99, v99, v107
    v_fmac_f32 v103, v107, v107
    ds_read_b64_tr_b16 v[72:73], v4 offset:4096
    ds_read_b64_tr_b16 v[74:75], v4 offset:4608
    v_add_f32 v96, v96, v98
    v_add_f32 v97, v97, v99
    v_add_f32 v100, v100, v102
    v_add_f32 v101, v101, v103
    v_add_f32 v10, v96, v97
    v_add_f32 v11, v100, v101
    s_nop 0
    v_add_f32_dpp v10, v10, v10 quad_perm:[1,0,3,2] row_mask:0xf bank_mask:0xf
    v_add_f32_dpp v11, v11, v11 quad_perm:[1,0,3,2] row_mask:0xf bank_mask:0xf
    s_nop 0
    v_add_f32_dpp v10, v10, v10 quad_perm:[2,3,0,1] row_mask:0xf bank_mask:0xf
    v_add_f32_dpp v11, v11, v11 quad_perm:[2,3,0,1] row_mask:0xf bank_mask:0xf
    s_nop 0
    v_add_f32_dpp v10, v10, v10 row_half_mirror row_mask:0xf bank_mask:0xf
    v_add_f32_dpp v11, v11, v11 row_half_mirror row_mask:0xf bank_mask:0xf
    v_mul_f32 v16, 0x3acccccd, v10
    v_mul_f32 v17, 0x3acccccd, v11
    v_fma_f32 v17, -v16, v16, v17
    v_max_f32 v17, 0, v17
    v_cvt_pk_bf16_f32 v10, v16, v17
    v_lshlrev_b32 v16, 16, v10
    v_and_b32 v17, s12, v10
    v_add_f32 v17, 0x3727c5ac, v17
    v_cvt_pk_bf16_f32 v17, v17, v17
    v_lshlrev_b32 v17, 16, v17
    v_sqrt_f32 v17, v17
    v_readlane_b32 s20, v16, 0
    v_readlane_b32 s21, v16, 8
    v_readlane_b32 s22, v16, 16
    v_readlane_b32 s23, v16, 24
    v_readlane_b32 s24, v16, 32
    v_readlane_b32 s25, v16, 40
    v_readlane_b32 s26, v16, 48
    v_readlane_b32 s27, v16, 56
    v_cvt_pk_bf16_f32 v17, v17, v17
    v_lshlrev_b32 v17, 16, v17
    v_rcp_f32 v17, v17
    s_nop 0
    v_readlane_b32 s28, v17, 0
    v_readlane_b32 s29, v17, 8
    v_readlane_b32 s30, v17, 16
    v_readlane_b32 s31, v17, 24
    v_readlane_b32 s32, v17, 32
    v_readlane_b32 s33, v17, 40
    v_readlane_b32 s34, v17, 48
    v_readlane_b32 s35, v17, 56
    v_and_b32 v3, 7, v0
    v_cmp_eq_u32 vcc, 0, v3
    v_lshlrev_b32 v3, 1, v0
    s_lshl_b32 s78, s74, 7
    s_add_u32 s78, s78, 16777216
    v_cndmask_b32 v3, -1, v3, vcc
    s_waitcnt vmcnt(0)
    v_readfirstlane_b32 s54, v9
    s_cmp_lg_u32 s54, 0
    s_cbranch_scc1 TKD14
    s_mov_b32 s83, 12500
TKP13:
    buffer_load_dword v9, off, s[36:39], 0 sc1
    s_waitcnt vmcnt(0)
    v_readfirstlane_b32 s54, v9
    s_sub_u32 s83, s83, 1
    s_cselect_b32 s54, 1, s54
    s_cmp_eq_u32 s54, 0
    s_cbranch_scc1 TKP13
TKD14:
    v_mov_b32 v18, s54
    v_mov_b32 v19, s54
    s_waitcnt lgkmcnt(0)
    s_cmp_eq_u32 s3, 7
    s_cselect_b32 s79, 32, 0
    s_cselect_b32 s80, -1, 0
    v_or_b32 v3, s80, v3
    v_add_u32 v10, s79, v8
    buffer_store_dwordx4 v[16:19], v3, s[16:19], s78 offen sc1
    ds_write_b32 v10, v18 offset:20
    s_mov_b32 s9, s55
L_LNP:
    v_lshlrev_b32 v96, 16, v56
    v_and_b32 v97, s12, v56
    v_lshlrev_b32 v98, 16, v57
    v_and_b32 v99, s12, v57
    v_lshlrev_b32 v100, 16, v58
    v_and_b32 v101, s12, v58
    v_lshlrev_b32 v102, 16, v59
    v_and_b32 v103, s12, v59
    v_subrev_f32 v96, s20, v96
    v_subrev_f32 v97, s21, v97
    v_subrev_f32 v98, s22, v98
    v_subrev_f32 v99, s23, v99
    v_subrev_f32 v100, s24, v100
    v_subrev_f32 v101, s25, v101
    v_subrev_f32 v102, s26, v102
    v_subrev_f32 v103, s27, v103
    v_cvt_pk_bf16_f32 v96, 0, v96
    v_cvt_pk_bf16_f32 v97, 0, v97
    v_cvt_pk_bf16_f32 v98, 0, v98
    v_cvt_pk_bf16_f32 v99, 0, v99
    v_cvt_pk_bf16_f32 v100, 0, v100
    v_cvt_pk_bf16_f32 v101, 0, v101
    v_cvt_pk_bf16_f32 v102, 0, v102
    v_cvt_pk_bf16_f32 v103, 0, v103
    v_mul_f32 v96, s28, v96
    v_mul_f32 v97, s29, v97
    v_mul_f32 v98, s30, v98
    v_mul_f32 v99, s31, v99
    v_mul_f32 v100, s32, v100
    v_mul_f32 v101, s33, v101
    v_mul_f32 v102, s34, v102
    v_mul_f32 v103, s35, v103
    v_cvt_pk_bf16_f32 v56, v96, v97
    v_cvt_pk_bf16_f32 v57, v98, v99
    v_cvt_pk_bf16_f32 v58, v100, v101
    v_cvt_pk_bf16_f32 v59, v102, v103
    s_add_u32 s77, s10, 0
    buffer_store_dwordx4 v[56:59], v5, s[16:19], s77 offen offset:0 sc1
    v_lshlrev_b32 v104, 16, v60
    v_and_b32 v105, s12, v60
    v_lshlrev_b32 v106, 16, v61
    v_and_b32 v107, s12, v61
    v_lshlrev_b32 v108, 16, v62
    v_and_b32 v109, s12, v62
    v_lshlrev_b32 v110, 16, v63
    v_and_b32 v111, s12, v63
    v_subrev_f32 v104, s20, v104
    v_subrev_f32 v105, s21, v105
    v_subrev_f32 v106, s22, v106
    v_subrev_f32 v107, s23, v107
    v_subrev_f32 v108, s24, v108
    v_subrev_f32 v109, s25, v109
    v_subrev_f32 v110, s26, v110
    v_subrev_f32 v111, s27, v111
    v_cvt_pk_bf16_f32 v104, 0, v104
    v_cvt_pk_bf16_f32 v105, 0, v105
    v_cvt_pk_bf16_f32 v106, 0, v106
    v_cvt_pk_bf16_f32 v107, 0, v107
    v_cvt_pk_bf16_f32 v108, 0, v108
    v_cvt_pk_bf16_f32 v109, 0, v109
    v_cvt_pk_bf16_f32 v110, 0, v110
    v_cvt_pk_bf16_f32 v111, 0, v111
    v_mul_f32 v104, s28, v104
    v_mul_f32 v105, s29, v105
    v_mul_f32 v106, s30, v106
    v_mul_f32 v107, s31, v107
    v_mul_f32 v108, s32, v108
    v_mul_f32 v109, s33, v109
    v_mul_f32 v110, s34, v110
    v_mul_f32 v111, s35, v111
    v_cvt_pk_bf16_f32 v60, v104, v105
    v_cvt_pk_bf16_f32 v61, v106, v107
    v_cvt_pk_bf16_f32 v62, v108, v109
    v_cvt_pk_bf16_f32 v63, v110, v111
    buffer_store_dwordx4 v[60:63], v5, s[16:19], s77 offen offset:1024 sc1
    v_lshlrev_b32 v96, 16, v64
    v_and_b32 v97, s12, v64
    v_lshlrev_b32 v98, 16, v65
    v_and_b32 v99, s12, v65
    v_lshlrev_b32 v100, 16, v66
    v_and_b32 v101, s12, v66
    v_lshlrev_b32 v102, 16, v67
    v_and_b32 v103, s12, v67
    v_subrev_f32 v96, s20, v96
    v_subrev_f32 v97, s21, v97
    v_subrev_f32 v98, s22, v98
    v_subrev_f32 v99, s23, v99
    v_subrev_f32 v100, s24, v100
    v_subrev_f32 v101, s25, v101
    v_subrev_f32 v102, s26, v102
    v_subrev_f32 v103, s27, v103
    v_cvt_pk_bf16_f32 v96, 0, v96
    v_cvt_pk_bf16_f32 v97, 0, v97
    v_cvt_pk_bf16_f32 v98, 0, v98
    v_cvt_pk_bf16_f32 v99, 0, v99
    v_cvt_pk_bf16_f32 v100, 0, v100
    v_cvt_pk_bf16_f32 v101, 0, v101
    v_cvt_pk_bf16_f32 v102, 0, v102
    v_cvt_pk_bf16_f32 v103, 0, v103
    v_mul_f32 v96, s28, v96
    v_mul_f32 v97, s29, v97
    v_mul_f32 v98, s30, v98
    v_mul_f32 v99, s31, v99
    v_mul_f32 v100, s32, v100
    v_mul_f32 v101, s33, v101
    v_mul_f32 v102, s34, v102
    v_mul_f32 v103, s35, v103
    v_cvt_pk_bf16_f32 v64, v96, v97
    v_cvt_pk_bf16_f32 v65, v98, v99
    v_cvt_pk_bf16_f32 v66, v100, v101
    v_cvt_pk_bf16_f32 v67, v102, v103
    buffer_store_dwordx4 v[64:67], v5, s[16:19], s77 offen offset:2048 sc1
    v_lshlrev_b32 v104, 16, v68
    v_and_b32 v105, s12, v68
    v_lshlrev_b32 v106, 16, v69
    v_and_b32 v107, s12, v69
    v_lshlrev_b32 v108, 16, v70
    v_and_b32 v109, s12, v70
    v_lshlrev_b32 v110, 16, v71
    v_and_b32 v111, s12, v71
    v_subrev_f32 v104, s20, v104
    v_subrev_f32 v105, s21, v105
    v_subrev_f32 v106, s22, v106
    v_subrev_f32 v107, s23, v107
    v_subrev_f32 v108, s24, v108
    v_subrev_f32 v109, s25, v109
    v_subrev_f32 v110, s26, v110
    v_subrev_f32 v111, s27, v111
    v_cvt_pk_bf16_f32 v104, 0, v104
    v_cvt_pk_bf16_f32 v105, 0, v105
    v_cvt_pk_bf16_f32 v106, 0, v106
    v_cvt_pk_bf16_f32 v107, 0, v107
    v_cvt_pk_bf16_f32 v108, 0, v108
    v_cvt_pk_bf16_f32 v109, 0, v109
    v_cvt_pk_bf16_f32 v110, 0, v110
    v_cvt_pk_bf16_f32 v111, 0, v111
    v_mul_f32 v104, s28, v104
    v_mul_f32 v105, s29, v105
    v_mul_f32 v106, s30, v106
    v_mul_f32 v107, s31, v107
    v_mul_f32 v108, s32, v108
    v_mul_f32 v109, s33, v109
    v_mul_f32 v110, s34, v110
    v_mul_f32 v111, s35, v111
    v_cvt_pk_bf16_f32 v68, v104, v105
    v_cvt_pk_bf16_f32 v69, v106, v107
    v_cvt_pk_bf16_f32 v70, v108, v109
    v_cvt_pk_bf16_f32 v71, v110, v111
    buffer_store_dwordx4 v[68:71], v5, s[16:19], s77 offen offset:3072 sc1
    v_lshlrev_b32 v96, 16, v72
    v_and_b32 v97, s12, v72
    v_lshlrev_b32 v98, 16, v73
    v_and_b32 v99, s12, v73
    v_lshlrev_b32 v100, 16, v74
    v_and_b32 v101, s12, v74
    v_lshlrev_b32 v102, 16, v75
    v_and_b32 v103, s12, v75
    v_subrev_f32 v96, s20, v96
    v_subrev_f32 v97, s21, v97
    v_subrev_f32 v98, s22, v98
    v_subrev_f32 v99, s23, v99
    v_subrev_f32 v100, s24, v100
    v_subrev_f32 v101, s25, v101
    v_subrev_f32 v102, s26, v102
    v_subrev_f32 v103, s27, v103
    v_cvt_pk_bf16_f32 v96, 0, v96
    v_cvt_pk_bf16_f32 v97, 0, v97
    v_cvt_pk_bf16_f32 v98, 0, v98
    v_cvt_pk_bf16_f32 v99, 0, v99
    v_cvt_pk_bf16_f32 v100, 0, v100
    v_cvt_pk_bf16_f32 v101, 0, v101
    v_cvt_pk_bf16_f32 v102, 0, v102
    v_cvt_pk_bf16_f32 v103, 0, v103
    v_mul_f32 v96, s28, v96
    v_mul_f32 v97, s29, v97
    v_mul_f32 v98, s30, v98
    v_mul_f32 v99, s31, v99
    v_mul_f32 v100, s32, v100
    v_mul_f32 v101, s33, v101
    v_mul_f32 v102, s34, v102
    v_mul_f32 v103, s35, v103
    v_cvt_pk_bf16_f32 v72, v96, v97
    v_cvt_pk_bf16_f32 v73, v98, v99
    v_cvt_pk_bf16_f32 v74, v100, v101
    v_cvt_pk_bf16_f32 v75, v102, v103
    s_add_u32 s77, s10, 4096
    buffer_store_dwordx4 v[72:75], v5, s[16:19], s77 offen offset:0 sc1
    s_cmp_eq_u32 s9, 0
    s_cbranch_scc1 L_LND
    s_mov_b32 s9, 0
    v_add_u32 v4, 5120, v4
    s_add_u32 s10, s10, 5120
    ds_read_b64_tr_b16 v[56:57], v4 offset:0
    ds_read_b64_tr_b16 v[58:59], v4 offset:512
    ds_read_b64_tr_b16 v[60:61], v4 offset:1024
    ds_read_b64_tr_b16 v[62:63], v4 offset:1536
    ds_read_b64_tr_b16 v[64:65], v4 offset:2048
    ds_read_b64_tr_b16 v[66:67], v4 offset:2560
    ds_read_b64_tr_b16 v[68:69], v4 offset:3072
    ds_read_b64_tr_b16 v[70:71], v4 offset:3584
    ds_read_b64_tr_b16 v[72:73], v4 offset:4096
    ds_read_b64_tr_b16 v[74:75], v4 offset:4608
    s_waitcnt lgkmcnt(0)
    s_branch L_LNP
L_LND:
    s_cmp_eq_u32 s3, 7
    s_cbranch_scc1 L_W7X
    v_mov_b32 v9, s54
    s_lshl_b32 s77, s2, 8
    s_add_u32 s77, s77, 19365888
    s_setprio 0
    s_waitcnt vmcnt(0)
    s_mov_b64 exec, 1
    buffer_store_dword v9, off, s[16:19], s77 sc1
    s_cmp_eq_u32 s55, 0
    s_cbranch_scc1 NC15
    buffer_store_dword v9, off, s[16:19], s77 offset:128 sc1
    s_mov_b64 exec, -1
    s_sub_u32 s12, s2, 224
    s_lshl_b32 s13, s12, 11
    s_add_u32 s13, s13, 19365888
    v_and_b32 v3, 15, v0
    v_lshlrev_b32 v3, 7, v3
    s_mov_b32 s83, 12500
SPG16:
    buffer_load_dword v4, v3, s[16:19], s13 offen sc1
    s_waitcnt vmcnt(0)
    v_cmp_ne_u32 vcc, s54, v4
    s_sub_u32 s83, s83, 1
    s_cbranch_scc1 SPE17
    s_cmp_eq_u64 vcc, 0
    s_cbranch_scc1 SPE17
    s_sleep 2
    s_branch SPG16
SPE17:
    s_lshl_b32 s13, s12, 7
    s_add_u32 s13, s13, 19464192
    s_mov_b64 exec, 1
    buffer_store_dword v9, off, s[16:19], s13 sc1
NC15:
    s_mov_b64 exec, -1
    s_cmp_eq_u32 s55, 1
    s_cbranch_scc1 L_WA
    s_lshl_b32 s12, s70, 11
    s_add_u32 s12, s12, 16777216
    v_lshlrev_b32 v6, 2, v0
    v_add_u32 v6, 160768, v6
    s_mov_b32 s83, 12500
L_STP:
    buffer_load_dwordx4 v[16:19], v5, s[16:19], s12 offen sc1
    buffer_load_dwordx4 v[20:23], v5, s[16:19], s12 offen offset:1024 sc1
    s_waitcnt vmcnt(0)
    v_xor_b32 v18, s54, v18
    v_xor_b32 v22, s54, v22
    v_or_b32 v18, v18, v22
    v_cmp_ne_u32 vcc, 0, v18
    s_sub_u32 s83, s83, 1
    s_cbranch_scc1 L_STD
    s_cbranch_vccz L_STD
    s_sleep 8
    s_branch L_STP
L_STD:
    ds_write2st64_b32 v6, v16, v20 offset0:0 offset1:1
    s_waitcnt lgkmcnt(0)
    v_mov_b32 v1, 161280
    v_mov_b32 v3, 1
    s_mov_b64 exec, 1
    ds_add_u32 v1, v3 offset:40
    s_mov_b64 exec, -1
    s_mov_b32 s83, 200000
SPL18:
    ds_read_b32 v12, v8 offset:52
    s_waitcnt lgkmcnt(0)
    s_nop 0
    v_readfirstlane_b32 s82, v12
    s_sub_u32 s83, s83, 1
    s_cselect_b32 s82, -1, s82
    s_cmp_ge_u32 s82, 1
    s_cbranch_scc1 SPD19
    s_sleep 1
    s_branch SPL18
SPD19:
    s_branch L_EXP
L_PF:
    s_add_u32 s24, s66, 3145728
    s_addc_u32 s25, s67, 0
    s_and_b32 s25, s25, 0xffff
    s_mov_b32 s26, 2211840
    s_mov_b32 s27, 0x00020000
    s_sub_u32 s12, s69, 28
    s_cmp_eq_u32 s3, 6
    s_cbranch_scc1 L_G2
L_PB:
L_PF3:
    s_getpc_b64 s[52:53]
CT20:
    s_add_u32 s52, s52, L_G2-CT20
    s_addc_u32 s53, s53, 0
    v_lshlrev_b32 v3, 7, v0
    v_min_u32 v3, L_TABLE-L_G2, v3
    global_load_dword v4, v3, s[52:53]
    v_add_u32 v3, 8192, v3
    v_min_u32 v3, L_TABLE-L_G2, v3
    global_load_dword v4, v3, s[52:53]
    v_add_u32 v3, 8192, v3
    v_min_u32 v3, L_TABLE-L_G2, v3
    global_load_dword v4, v3, s[52:53]
    v_add_u32 v3, 8192, v3
    v_min_u32 v3, L_TABLE-L_G2, v3
    global_load_dword v4, v3, s[52:53]
    v_add_u32 v3, 8192, v3
    v_min_u32 v3, L_TABLE-L_G2, v3
    global_load_dword v4, v3, s[52:53]
    v_add_u32 v3, 8192, v3
L_PB6:
    v_and_b32 v3, 31, v0
    v_lshlrev_b32 v3, 7, v3
    s_mov_b32 s13, 19468288
    s_mov_b32 s83, 12500
SPG21:
    buffer_load_dword v4, v3, s[16:19], s13 offen sc1
    s_waitcnt vmcnt(0)
    v_cmp_ne_u32 vcc, s54, v4
    s_sub_u32 s83, s83, 1
    s_cbranch_scc1 SPE22
    s_cmp_eq_u64 vcc, 0
    s_cbranch_scc1 SPE22
    s_sleep 2
    s_branch SPG21
SPE22:
    v_mov_b32 v4, s54
    v_mov_b32 v8, 161280
    ds_write_b32 v8, v4 offset:32
    s_branch L_G2
L_W7:
    s_setprio 0
    s_cmp_eq_u32 s55, 0
    s_cbranch_scc1 PR23
    s_setprio 2
PR23:
L_W7X:
    s_mul_i32 s10, s2, 10240
    s_cmp_eq_u32 s55, 1
    s_mov_b32 s11, 100864
    s_cselect_b32 s11, s11, 147968
    s_cbranch_scc0 IG24
    s_mov_b32 s32, s60
    s_and_b32 s33, s61, 0xffff
    s_mov_b32 s34, 2211840
    s_mov_b32 s35, 0x00020000
    v_lshrrev_b32 v3, 3, v0
    v_mul_u32_u24 v3, 1280, v3
    v_and_b32 v4, 7, v0
    v_lshl_add_u32 v3, v4, 4, v3
    s_waitcnt vmcnt(48)
    s_add_u32 m0, s11, 0
    s_nop 0
    buffer_load_dwordx4 v3, s[32:35], s10 offen offset:0  lds
    s_add_u32 m0, s11, 896
    s_nop 0
    buffer_load_dwordx4 v3, s[32:35], s10 offen offset:128  lds
    s_add_u32 m0, s11, 1792
    s_nop 0
    buffer_load_dwordx4 v3, s[32:35], s10 offen offset:256  lds
    s_add_u32 m0, s11, 2688
    s_nop 0
    buffer_load_dwordx4 v3, s[32:35], s10 offen offset:384  lds
    s_add_u32 m0, s11, 3584
    s_nop 0
    buffer_load_dwordx4 v3, s[32:35], s10 offen offset:512  lds
    s_add_u32 m0, s11, 4480
    s_nop 0
    buffer_load_dwordx4 v3, s[32:35], s10 offen offset:640  lds
    s_add_u32 m0, s11, 5376
    s_nop 0
    buffer_load_dwordx4 v3, s[32:35], s10 offen offset:768  lds
    s_add_u32 m0, s11, 6272
    s_nop 0
    buffer_load_dwordx4 v3, s[32:35], s10 offen offset:896  lds
    s_add_u32 m0, s11, 7168
    s_nop 0
    buffer_load_dwordx4 v3, s[32:35], s10 offen offset:1024  lds
    s_add_u32 m0, s11, 8064
    s_nop 0
    buffer_load_dwordx4 v3, s[32:35], s10 offen offset:1152  lds
IG24:
    s_mov_b32 s16, s66
    s_and_b32 s17, s67, 0xffff
    s_mov_b32 s18, 19529728
    s_mov_b32 s19, 0x00020000
    s_add_u32 s24, s66, 3145728
    s_addc_u32 s25, s67, 0
    s_and_b32 s25, s25, 0xffff
    s_mov_b32 s26, 2211840
    s_mov_b32 s27, 0x00020000
    v_mov_b32 v8, 161280
    v_lshlrev_b32 v7, 3, v0
    v_bfe_u32 v4, v0, 2, 2
    v_lshlrev_b32 v4, 7, v4
    v_lshrrev_b32 v5, 4, v0
    v_lshl_add_u32 v4, v5, 5, v4
    v_and_b32 v5, 3, v0
    v_lshl_add_u32 v4, v5, 3, v4
    v_add_u32 v4, s11, v4
    v_lshlrev_b32 v5, 4, v0
    v_bfe_u32 v60, v0, 2, 2
    v_lshlrev_b32 v60, 7, v60
    v_lshrrev_b32 v61, 5, v0
    v_lshl_add_u32 v60, v61, 6, v60
    v_and_b32 v61, 3, v0
    v_lshl_add_u32 v60, v61, 4, v60
    v_bfe_u32 v61, v0, 4, 1
    v_lshl_add_u32 v60, v61, 3, v60
    v_add_u32 v60, s11, v60
    v_cmp_gt_u32 vcc, 32, v0
    s_nop 1
    v_cndmask_b32 v61, v60, v4, vcc
    v_cndmask_b32 v62, v4, v60, vcc
    s_cmp_eq_u32 s55, 0
    s_cbranch_scc1 L_W7Y
    s_mov_b32 s36, s64
    s_and_b32 s37, s65, 0xffff
    s_mov_b32 s38, 256
    s_mov_b32 s39, 0x00020000
    buffer_load_dword v9, off, s[36:39], 0 sc1
    s_waitcnt vmcnt(0)
    v_readfirstlane_b32 s54, v9
    s_cmp_lg_u32 s54, 0
    s_cbranch_scc1 TKD26
    s_mov_b32 s83, 12500
TKP25:
    buffer_load_dword v9, off, s[36:39], 0 sc1
    s_waitcnt vmcnt(0)
    v_readfirstlane_b32 s54, v9
    s_sub_u32 s83, s83, 1
    s_cselect_b32 s54, 1, s54
    s_cmp_eq_u32 s54, 0
    s_cbranch_scc1 TKP25
TKD26:
    s_branch L_W7Z
L_W7Y:
    v_lshlrev_b32 v6, 2, v0
    v_add_u32 v6, 159744, v6
    s_lshl_b32 s13, s71, 4
    s_add_u32 s13, s13, s70
    s_lshl_b32 s13, s13, 11
    s_add_u32 s13, s13, 18874368
    v_mov_b32 v43, s54
    v_mov_b32 v27, s54
    s_mov_b32 s83, 200000
SPL27:
    ds_read_b32 v12, v8 offset:16
    s_waitcnt lgkmcnt(0)
    s_nop 0
    v_readfirstlane_b32 s82, v12
    s_sub_u32 s83, s83, 1
    s_cselect_b32 s82, -1, s82
    s_cmp_ge_u32 s82, 4
    s_cbranch_scc1 SPD28
    s_sleep 1
    s_branch SPL27
SPD28:
    ds_read2st64_b32 v[40:41], v6 offset0:0 offset1:1
    ds_read_b32 v42, v6 offset:512
    ds_read_b32 v26, v6 offset:768
    s_waitcnt lgkmcnt(0)
    buffer_store_dwordx4 v[40:43], v5, s[16:19], s13 offen sc1
    buffer_store_dwordx2 v[26:27], v7, s[16:19], s13 offen offset:1024 sc1
    s_mov_b32 s83, 200000
SPL29:
    ds_read_b32 v12, v8 offset:120
    s_waitcnt lgkmcnt(0)
    s_nop 0
    v_readfirstlane_b32 s82, v12
    s_sub_u32 s83, s83, 1
    s_cselect_b32 s82, -1, s82
    s_cmp_ge_u32 s82, 1
    s_cbranch_scc1 SPD30
    s_sleep 1
    s_branch SPL29
SPD30:
L_W7Z:
    ds_read_b64_tr_b16 v[64:65], v60 offset:0
    ds_read_b64_tr_b16 v[66:67], v60 offset:512
    ds_read_b64_tr_b16 v[68:69], v61 offset:1024
    ds_read_b64_tr_b16 v[70:71], v61 offset:1536
    ds_read_b64_tr_b16 v[72:73], v60 offset:2048
    ds_read_b64_tr_b16 v[74:75], v60 offset:2560
    ds_read_b64_tr_b16 v[76:77], v62 offset:3072
    ds_read_b64_tr_b16 v[78:79], v62 offset:3584
    ds_read_b64_tr_b16 v[80:81], v60 offset:4096
    ds_read_b64_tr_b16 v[82:83], v60 offset:4608
    ds_read_b64_tr_b16 v[84:85], v60 offset:5120
    ds_read_b64_tr_b16 v[86:87], v60 offset:5632
    ds_read_b64_tr_b16 v[88:89], v61 offset:6144
    ds_read_b64_tr_b16 v[90:91], v61 offset:6656
    ds_read_b64_tr_b16 v[92:93], v60 offset:7168
    s_waitcnt lgkmcnt(14)
    ds_read_b64_tr_b16 v[94:95], v60 offset:7680
    s_waitcnt lgkmcnt(14)
    ds_read_b64_tr_b16 v[96:97], v62 offset:8192
    s_waitcnt lgkmcnt(14)
    ds_read_b64_tr_b16 v[98:99], v62 offset:8704
    s_waitcnt lgkmcnt(14)
    ds_read_b64_tr_b16 v[100:101], v60 offset:9216
    s_waitcnt lgkmcnt(14)
    ds_read_b64_tr_b16 v[102:103], v60 offset:9728
    s_cmp_eq_u32 s55, 1
    s_cbranch_scc1 L_NA2
    s_lshl_b32 s77, s2, 8
    s_add_u32 s77, s77, 19366016
    s_waitcnt vmcnt(2)
    s_mov_b64 exec, 1
    buffer_store_dword v43, off, s[16:19], s77 sc1
    s_mov_b64 exec, -1
L_NA2:
    s_add_u32 s77, s10, 0
    buffer_store_dwordx4 v[64:67], v5, s[24:27], s77 offen offset:0 sc1
    buffer_store_dwordx4 v[68:71], v5, s[24:27], s77 offen offset:1024 sc1
    s_waitcnt lgkmcnt(14)
    buffer_store_dwordx4 v[72:75], v5, s[24:27], s77 offen offset:2048 sc1
    s_waitcnt lgkmcnt(12)
    buffer_store_dwordx4 v[76:79], v5, s[24:27], s77 offen offset:3072 sc1
    s_waitcnt lgkmcnt(10)
    s_add_u32 s77, s10, 4096
    buffer_store_dwordx4 v[80:83], v5, s[24:27], s77 offen offset:0 sc1
    s_waitcnt lgkmcnt(8)
    buffer_store_dwordx4 v[84:87], v5, s[24:27], s77 offen offset:1024 sc1
    s_waitcnt lgkmcnt(6)
    buffer_store_dwordx4 v[88:91], v5, s[24:27], s77 offen offset:2048 sc1
    s_waitcnt lgkmcnt(4)
    buffer_store_dwordx4 v[92:95], v5, s[24:27], s77 offen offset:3072 sc1
    s_waitcnt lgkmcnt(2)
    s_add_u32 s77, s10, 8192
    buffer_store_dwordx4 v[96:99], v5, s[24:27], s77 offen offset:0 sc1
    s_waitcnt lgkmcnt(0)
    buffer_store_dwordx4 v[100:103], v5, s[24:27], s77 offen offset:1024 sc1
    s_cmp_eq_u32 s55, 1
    s_cbranch_scc1 L_W7B
L_W7B:
    v_mov_b32 v9, s54
    s_lshl_b32 s77, s2, 7
    s_add_u32 s77, s77, 19431424
    s_setprio 0
    s_waitcnt vmcnt(0)
    s_mov_b64 exec, 1
    buffer_store_dword v9, off, s[16:19], s77 sc1
    s_cmp_eq_u32 s55, 0
    s_cbranch_scc1 NC31
    s_mov_b64 exec, -1
    s_sub_u32 s12, s2, 224
    s_lshl_b32 s13, s12, 10
    s_add_u32 s13, s13, 19431424
    v_and_b32 v3, 7, v0
    v_lshlrev_b32 v3, 7, v3
    s_mov_b32 s83, 12500
SPG32:
    buffer_load_dword v4, v3, s[16:19], s13 offen sc1
    s_waitcnt vmcnt(0)
    v_cmp_ne_u32 vcc, s54, v4
    s_sub_u32 s83, s83, 1
    s_cbranch_scc1 SPE33
    s_cmp_eq_u64 vcc, 0
    s_cbranch_scc1 SPE33
    s_sleep 2
    s_branch SPG32
SPE33:
    s_lshl_b32 s13, s12, 7
    s_add_u32 s13, s13, 19468288
    s_mov_b64 exec, 1
    buffer_store_dword v9, off, s[16:19], s13 sc1
NC31:
    s_mov_b64 exec, -1
    s_cmp_eq_u32 s55, 1
    s_cbranch_scc1 L_PF
    s_branch L_EXP
L_W7C:
    v_mov_b32 v8, 161280
    v_lshlrev_b32 v7, 3, v0
    v_lshlrev_b32 v5, 4, v0
    s_lshl_b32 s13, s71, 11
    s_add_u32 s13, s13, 19333120
    s_mov_b32 s12, 12500
L_CFL:
    buffer_load_dwordx4 v[64:67], v5, s[16:19], s13 offen sc1
    buffer_load_dwordx2 v[68:69], v7, s[16:19], s13 offen offset:1024 sc1
    s_waitcnt vmcnt(0)
    v_xor_b32 v67, s54, v67
    v_xor_b32 v69, s54, v69
    v_or_b32 v67, v67, v69
    v_cmp_ne_u32 vcc, 0, v67
    s_sub_u32 s12, s12, 1
    s_cbranch_scc1 L_CSW
    s_cbranch_vccz L_CSW
    s_sleep 3
    s_branch L_CFL
L_CSC:
    v_mov_b32 v8, 161280
    v_lshlrev_b32 v7, 3, v0
    v_lshlrev_b32 v5, 4, v0
    v_and_b32 v3, 15, v0
    v_lshlrev_b32 v3, 11, v3
    s_lshl_b32 s13, s71, 15
    s_add_u32 s13, s13, 18874368
    s_mov_b32 s83, 12500
SPG34:
    buffer_load_dword v4, v3, s[16:19], s13 offen offset:1532 sc1
    s_waitcnt vmcnt(0)
    v_cmp_ne_u32 vcc, s54, v4
    s_sub_u32 s83, s83, 1
    s_cbranch_scc1 SPE35
    s_cmp_eq_u64 vcc, 0
    s_cbranch_scc1 SPE35
    s_sleep 3
    s_branch SPG34
SPE35:
    s_mov_b32 s12, 3125
L_CSL:
    s_mov_b32 s78, s13
    buffer_load_dwordx4 v[64:67], v5, s[16:19], s78 offen offset:0 sc1
    buffer_load_dwordx2 v[68:69], v7, s[16:19], s78 offen offset:1024 sc1
    buffer_load_dwordx4 v[70:73], v5, s[16:19], s78 offen offset:2048 sc1
    buffer_load_dwordx2 v[74:75], v7, s[16:19], s78 offen offset:3072 sc1
    s_add_u32 s78, s78, 4096
    buffer_load_dwordx4 v[76:79], v5, s[16:19], s78 offen offset:0 sc1
    buffer_load_dwordx2 v[80:81], v7, s[16:19], s78 offen offset:1024 sc1
    buffer_load_dwordx4 v[82:85], v5, s[16:19], s78 offen offset:2048 sc1
    buffer_load_dwordx2 v[86:87], v7, s[16:19], s78 offen offset:3072 sc1
    s_add_u32 s78, s78, 4096
    buffer_load_dwordx4 v[88:91], v5, s[16:19], s78 offen offset:0 sc1
    buffer_load_dwordx2 v[92:93], v7, s[16:19], s78 offen offset:1024 sc1
    buffer_load_dwordx4 v[94:97], v5, s[16:19], s78 offen offset:2048 sc1
    buffer_load_dwordx2 v[98:99], v7, s[16:19], s78 offen offset:3072 sc1
    s_add_u32 s78, s78, 4096
    buffer_load_dwordx4 v[100:103], v5, s[16:19], s78 offen offset:0 sc1
    buffer_load_dwordx2 v[104:105], v7, s[16:19], s78 offen offset:1024 sc1
    buffer_load_dwordx4 v[106:109], v5, s[16:19], s78 offen offset:2048 sc1
    buffer_load_dwordx2 v[110:111], v7, s[16:19], s78 offen offset:3072 sc1
    s_add_u32 s78, s78, 4096
    buffer_load_dwordx4 v[112:115], v5, s[16:19], s78 offen offset:0 sc1
    buffer_load_dwordx2 v[116:117], v7, s[16:19], s78 offen offset:1024 sc1
    buffer_load_dwordx4 v[118:121], v5, s[16:19], s78 offen offset:2048 sc1
    buffer_load_dwordx2 v[122:123], v7, s[16:19], s78 offen offset:3072 sc1
    s_add_u32 s78, s78, 4096
    buffer_load_dwordx4 v[124:127], v5, s[16:19], s78 offen offset:0 sc1
    buffer_load_dwordx2 v[128:129], v7, s[16:19], s78 offen offset:1024 sc1
    buffer_load_dwordx4 v[130:133], v5, s[16:19], s78 offen offset:2048 sc1
    buffer_load_dwordx2 v[134:135], v7, s[16:19], s78 offen offset:3072 sc1
    s_add_u32 s78, s78, 4096
    buffer_load_dwordx4 v[136:139], v5, s[16:19], s78 offen offset:0 sc1
    buffer_load_dwordx2 v[140:141], v7, s[16:19], s78 offen offset:1024 sc1
    buffer_load_dwordx4 v[142:145], v5, s[16:19], s78 offen offset:2048 sc1
    buffer_load_dwordx2 v[146:147], v7, s[16:19], s78 offen offset:3072 sc1
    s_add_u32 s78, s78, 4096
    buffer_load_dwordx4 v[148:151], v5, s[16:19], s78 offen offset:0 sc1
    buffer_load_dwordx2 v[152:153], v7, s[16:19], s78 offen offset:1024 sc1
    buffer_load_dwordx4 v[154:157], v5, s[16:19], s78 offen offset:2048 sc1
    buffer_load_dwordx2 v[158:159], v7, s[16:19], s78 offen offset:3072 sc1
    v_mov_b32 v9, 0
    s_waitcnt vmcnt(30)
    v_xor_b32 v67, s54, v67
    v_xor_b32 v69, s54, v69
    v_or3_b32 v9, v9, v67, v69
    s_waitcnt vmcnt(28)
    v_xor_b32 v73, s54, v73
    v_xor_b32 v75, s54, v75
    v_add_f32 v64, v64, v70
    v_add_f32 v65, v65, v71
    v_add_f32 v66, v66, v72
    v_add_f32 v68, v68, v74
    v_or3_b32 v9, v9, v73, v75
    s_waitcnt vmcnt(26)
    v_xor_b32 v79, s54, v79
    v_xor_b32 v81, s54, v81
    v_add_f32 v64, v64, v76
    v_add_f32 v65, v65, v77
    v_add_f32 v66, v66, v78
    v_add_f32 v68, v68, v80
    v_or3_b32 v9, v9, v79, v81
    s_waitcnt vmcnt(24)
    v_xor_b32 v85, s54, v85
    v_xor_b32 v87, s54, v87
    v_add_f32 v64, v64, v82
    v_add_f32 v65, v65, v83
    v_add_f32 v66, v66, v84
    v_add_f32 v68, v68, v86
    v_or3_b32 v9, v9, v85, v87
    s_waitcnt vmcnt(22)
    v_xor_b32 v91, s54, v91
    v_xor_b32 v93, s54, v93
    v_add_f32 v64, v64, v88
    v_add_f32 v65, v65, v89
    v_add_f32 v66, v66, v90
    v_add_f32 v68, v68, v92
    v_or3_b32 v9, v9, v91, v93
    s_waitcnt vmcnt(20)
    v_xor_b32 v97, s54, v97
    v_xor_b32 v99, s54, v99
    v_add_f32 v64, v64, v94
    v_add_f32 v65, v65, v95
    v_add_f32 v66, v66, v96
    v_add_f32 v68, v68, v98
    v_or3_b32 v9, v9, v97, v99
    s_waitcnt vmcnt(18)
    v_xor_b32 v103, s54, v103
    v_xor_b32 v105, s54, v105
    v_add_f32 v64, v64, v100
    v_add_f32 v65, v65, v101
    v_add_f32 v66, v66, v102
    v_add_f32 v68, v68, v104
    v_or3_b32 v9, v9, v103, v105
    s_waitcnt vmcnt(16)
    v_xor_b32 v109, s54, v109
    v_xor_b32 v111, s54, v111
    v_add_f32 v64, v64, v106
    v_add_f32 v65, v65, v107
    v_add_f32 v66, v66, v108
    v_add_f32 v68, v68, v110
    v_or3_b32 v9, v9, v109, v111
    s_waitcnt vmcnt(14)
    v_xor_b32 v115, s54, v115
    v_xor_b32 v117, s54, v117
    v_add_f32 v64, v64, v112
    v_add_f32 v65, v65, v113
    v_add_f32 v66, v66, v114
    v_add_f32 v68, v68, v116
    v_or3_b32 v9, v9, v115, v117
    s_waitcnt vmcnt(12)
    v_xor_b32 v121, s54, v121
    v_xor_b32 v123, s54, v123
    v_add_f32 v64, v64, v118
    v_add_f32 v65, v65, v119
    v_add_f32 v66, v66, v120
    v_add_f32 v68, v68, v122
    v_or3_b32 v9, v9, v121, v123
    s_waitcnt vmcnt(10)
    v_xor_b32 v127, s54, v127
    v_xor_b32 v129, s54, v129
    v_add_f32 v64, v64, v124
    v_add_f32 v65, v65, v125
    v_add_f32 v66, v66, v126
    v_add_f32 v68, v68, v128
    v_or3_b32 v9, v9, v127, v129
    s_waitcnt vmcnt(8)
    v_xor_b32 v133, s54, v133
    v_xor_b32 v135, s54, v135
    v_add_f32 v64, v64, v130
    v_add_f32 v65, v65, v131
    v_add_f32 v66, v66, v132
    v_add_f32 v68, v68, v134
    v_or3_b32 v9, v9, v133, v135
    s_waitcnt vmcnt(6)
    v_xor_b32 v139, s54, v139
    v_xor_b32 v141, s54, v141
    v_add_f32 v64, v64, v136
    v_add_f32 v65, v65, v137
    v_add_f32 v66, v66, v138
    v_add_f32 v68, v68, v140
    v_or3_b32 v9, v9, v139, v141
    s_waitcnt vmcnt(4)
    v_xor_b32 v145, s54, v145
    v_xor_b32 v147, s54, v147
    v_add_f32 v64, v64, v142
    v_add_f32 v65, v65, v143
    v_add_f32 v66, v66, v144
    v_add_f32 v68, v68, v146
    v_or3_b32 v9, v9, v145, v147
    s_waitcnt vmcnt(2)
    v_xor_b32 v151, s54, v151
    v_xor_b32 v153, s54, v153
    v_add_f32 v64, v64, v148
    v_add_f32 v65, v65, v149
    v_add_f32 v66, v66, v150
    v_add_f32 v68, v68, v152
    v_or3_b32 v9, v9, v151, v153
    s_waitcnt vmcnt(0)
    v_xor_b32 v157, s54, v157
    v_xor_b32 v159, s54, v159
    v_add_f32 v64, v64, v154
    v_add_f32 v65, v65, v155
    v_add_f32 v66, v66, v156
    v_add_f32 v68, v68, v158
    v_or3_b32 v9, v9, v157, v159
    v_cmp_ne_u32 vcc, 0, v9
    s_sub_u32 s12, s12, 1
    s_cbranch_scc1 L_CSD
    s_cbranch_vccnz L_CSL
L_CSD:
    s_lshl_b32 s13, s71, 11
    s_add_u32 s13, s13, 19333120
    v_mov_b32 v67, s54
    v_mov_b32 v69, s54
    buffer_store_dwordx4 v[64:67], v5, s[16:19], s13 offen sc1
    buffer_store_dwordx2 v[68:69], v7, s[16:19], s13 offen offset:1024 sc1
    s_branch L_CONVH
L_CSW:
    v_lshlrev_b32 v5, 2, v0
    v_add_u32 v5, 159744, v5
    ds_write2st64_b32 v5, v64, v65 offset0:0 offset1:1
    ds_write2st64_b32 v5, v66, v68 offset0:2 offset1:3
    s_waitcnt lgkmcnt(0)
    v_mov_b32 v1, 161280
    v_mov_b32 v3, 1
    s_mov_b64 exec, 1
    ds_add_u32 v1, v3 offset:40
    s_mov_b64 exec, -1
L_W7D:
    v_and_b32 v3, 31, v0
    v_lshlrev_b32 v3, 7, v3
    s_mov_b32 s13, 19468288
    s_mov_b32 s83, 12500
SPG36:
    buffer_load_dword v4, v3, s[16:19], s13 offen sc1
    s_waitcnt vmcnt(0)
    v_cmp_ne_u32 vcc, s54, v4
    s_sub_u32 s83, s83, 1
    s_cbranch_scc1 SPE37
    s_cmp_eq_u64 vcc, 0
    s_cbranch_scc1 SPE37
    s_sleep 2
    s_branch SPG36
SPE37:
    v_mov_b32 v4, s54
    v_mov_b32 v8, 161280
    ds_write_b32 v8, v4 offset:32
    s_branch L_WA
L_CK:
    s_lshr_b32 s77, s3, 1
    s_mul_i32 s15, s77, 22528
    s_add_u32 s15, s15, 114688
    s_and_b32 s12, s3, 1
    s_add_u32 s13, s12, 1
    s_lshl_b32 s10, s3, 12
    s_add_u32 s10, s10, 32768
    s_mul_i32 s33, s12, 3072
    s_add_u32 s33, s33, s15
    s_add_u32 s33, s33, 4294966784
    s_and_b32 s28, s3, 1
    s_lshr_b32 s29, s3, 1
    v_mov_b32 v15, 161280
    v_mov_b32 v14, 0
    s_mov_b32 s4, 3
    s_mov_b32 s5, 0x24800000
    s_mov_b32 s30, 4294934528
    s_add_u32 s20, s66, 6291456
    s_addc_u32 s21, s67, 0
    s_and_b32 s21, s21, 0xffff
    s_mov_b32 s22, 7077888
    s_mov_b32 s23, 0x00020000
    s_lshl_b32 s77, s70, 1
    s_add_u32 s77, s77, s29
    s_mul_i32 s26, s77, 28
    s_lshl_b32 s78, s71, 1
    s_add_u32 s26, s26, s78
    s_add_u32 s26, s26, s28
    s_lshl_b32 s26, s26, 7
    s_add_u32 s26, s26, 16842752
    s_add_u32 s27, s78, s28
    s_lshl_b32 s27, s27, 18
    s_lshl_b32 s77, s77, 12
    s_add_u32 s27, s27, s77
    s_branch L_KGEN
L_HELPK:
    s_mul_i32 s15, s3, 22528
    s_add_u32 s77, s15, 24576
    s_cmp_ge_u32 s3, 4
    s_cselect_b32 s15, s77, s15
    s_add_u32 s10, s15, 7680
    s_mov_b32 s33, s10
    s_mov_b32 s12, 0
    s_mov_b32 s13, 2
L_KGEN:
    s_mov_b32 s16, s66
    s_and_b32 s17, s67, 0xffff
    s_mov_b32 s18, 19529728
    s_mov_b32 s19, 0x00020000
    s_mov_b32 s11, 1069066811
    v_and_b32 v1, 31, v0
    v_lshrrev_b32 v3, 5, v0
    v_mul_u32_u24 v59, 48, v1
    s_mov_b32 s79, 1536
    v_mad_u32_u24 v59, v3, s79, v59
    v_add_u32 v59, s33, v59
    v_lshlrev_b32 v57, 6, v1
    v_lshl_add_u32 v57, v3, 11, v57
    v_bfe_u32 v2, v0, 1, 2
    v_lshl_add_u32 v57, v2, 4, v57
    v_add_u32 v57, s10, v57
    v_xor_b32 v61, 16, v57
    v_xor_b32 v62, 32, v57
    v_xor_b32 v63, 48, v57
    v_bfe_u32 v2, v0, 2, 2
    v_lshl_add_u32 v1, v3, 2, v2
    v_bfe_u32 v2, v0, 4, 1
    v_lshlrev_b32 v2, 5, v2
    v_and_b32 v4, 3, v0
    v_lshl_add_u32 v2, v4, 3, v2
    v_mad_u32_u24 v60, v1, 48, v2
    v_add_u32 v60, s33, v60
    v_bfe_u32 v4, v1, 1, 2
    v_lshlrev_b32 v4, 4, v4
    v_xor_b32 v2, v2, v4
    v_lshl_add_u32 v58, v1, 6, v2
    v_add_u32 v58, s10, v58
    v_and_b32 v1, 31, v0
    v_lshrrev_b32 v2, 5, v0
    s_mul_i32 s77, s12, 3072
    s_add_u32 s77, s15, s77
    s_add_u32 s77, s77, 4608
    v_lshlrev_b32 v3, 5, v1
    v_lshl_add_u32 v3, v2, 4, v3
    v_add_u32 v16, s77, v3
    v_cmp_eq_u32 vcc, 0, v2
    v_lshlrev_b32 v3, 4, v1
    v_lshlrev_b32 v4, 3, v1
    v_add_u32 v17, 1024, v3
    v_add_u32 v18, 1536, v4
    v_cndmask_b32 v17, v18, v17, vcc
    v_add_u32 v17, s77, v17
    v_add_u32 v18, 8, v17
    v_add_u32 v19, 256, v17
    v_cndmask_b32 v18, v19, v18, vcc
    v_lshlrev_b32 v3, 2, v1
    v_lshl_add_u32 v3, v2, 9, v3
    v_add_u32 v19, s77, v3
    v_add_u32 v19, 2048, v19
    s_waitcnt vmcnt(0)
    v_lshlrev_b32 v56, 16, v56
    v_mul_f32 v56, s11, v56
    v_exp_f32 v56, v56
    s_nop 0
    v_cvt_pk_bf16_f32 v56, v56, v56
    v_lshlrev_b32 v56, 16, v56
L_KCHUNK:
    s_lshl_b32 s77, s12, 4
    v_lshrrev_b32 v1, s77, v52
    v_lshlrev_b32 v1, 16, v1
    v_lshrrev_b32 v2, s77, v53
    v_lshlrev_b32 v2, 16, v2
    v_lshrrev_b32 v128, s77, v54
    v_lshlrev_b32 v128, 16, v128
    v_lshrrev_b32 v130, s77, v55
    v_lshlrev_b32 v130, 16, v130
    v_mul_f32 v1, s11, v1
    v_exp_f32 v1, v1
    v_mul_f32 v2, v2, v56
    v_cvt_pk_bf16_f32 v1, v1, v1
    v_lshlrev_b32 v1, 16, v1
    v_mul_f32 v1, v1, v56
    v_mul_f32 v1, 0xbfb8aa3b, v1
    v_mul_f32 v2, 0x3e22f983, v2
    v_add_f32 v3, v56, v56
    v_mul_f32 v128, v128, v3
    v_mul_f32 v130, v130, v3
    v_mul_f32 v4, 0x41000000, v1
    v_mul_f32 v5, 0x41000000, v2
    v_mul_f32 v6, 0x3f800000, v1
    v_mul_f32 v7, 0x3f800000, v2
    v_mul_f32 v8, 0x43000000, v1
    v_mul_f32 v9, 0x43000000, v2
    v_mul_f32 v10, 0x43800000, v1
    v_mul_f32 v11, 0x43800000, v2
    v_exp_f32 v4, v4
    v_fract_f32 v5, v5
    v_exp_f32 v6, v6
    v_fract_f32 v7, v7
    v_exp_f32 v8, v8
    v_fract_f32 v9, v9
    v_exp_f32 v10, v10
    v_fract_f32 v11, v11
    v_cos_f32 v65, v5
    v_sin_f32 v97, v5
    v_cos_f32 v180, v7
    v_sin_f32 v182, v7
    v_cos_f32 v80, v9
    v_sin_f32 v112, v9
    v_cos_f32 v192, v11
    v_sin_f32 v194, v11
    v_mov_b32 v64, 1.0
    v_mov_b32 v96, 0
    v_mul_f32 v65, v65, v4
    v_mul_f32 v97, v97, v4
    v_mul_f32 v180, v180, v6
    v_mul_f32 v182, v182, v6
    v_mul_f32 v80, v80, v8
    v_mul_f32 v112, v112, v8
    v_mul_f32 v192, v192, v10
    v_mul_f32 v194, v194, v10
    v_mul_f32 v198, v65, v65
    v_mul_f32 v200, v180, v180
    v_mov_b32 v193, v192
    v_mul_f32 v199, v65, v97
    v_mul_f32 v201, v180, v182
    v_mov_b32 v195, v194
    v_fma_f32 v188, -v97, v97, v198
    v_fma_f32 v184, -v182, v182, v200
    v_mov_b32 v181, v180
    v_fma_f32 v190, v97, v65, v199
    v_fma_f32 v186, v182, v180, v201
    v_mov_b32 v183, v182
    v_mul_f32 v198, v80, v65
    v_mul_f32 v200, v184, v184
    v_mul_f32 v199, v80, v97
    v_mul_f32 v201, v184, v186
    v_fma_f32 v81, -v112, v97, v198
    v_fma_f32 v196, -v186, v186, v200
    v_fma_f32 v113, v112, v65, v199
    v_fma_f32 v197, v186, v184, v201
    v_mul_f32 v200, v128, v196
    v_mul_f32 v201, v128, v197
    v_fma_f32 v129, -v130, v197, v200
    v_fma_f32 v131, v130, v196, v201
    v_mov_b32 v189, v188
    v_mov_b32 v191, v190
    v_mov_b32 v185, v184
    v_mov_b32 v187, v186
    v_pk_mul_f32 v[4:5], v[64:65], v[188:189]
    v_pk_mul_f32 v[8:9], v[80:81], v[188:189]
    v_pk_mul_f32 v[198:199], v[128:129], v[192:193]
    v_pk_mul_f32 v[202:203], v[128:129], v[184:185]
    v_pk_mul_f32 v[6:7], v[64:65], v[190:191]
    v_pk_mul_f32 v[10:11], v[80:81], v[190:191]
    v_pk_mul_f32 v[200:201], v[128:129], v[194:195]
    v_pk_mul_f32 v[204:205], v[128:129], v[186:187]
    v_pk_fma_f32 v[66:67], v[96:97], v[190:191], v[4:5] neg_lo:[1,0,0] neg_hi:[1,0,0]
    v_pk_fma_f32 v[82:83], v[112:113], v[190:191], v[8:9] neg_lo:[1,0,0] neg_hi:[1,0,0]
    v_pk_fma_f32 v[144:145], v[130:131], v[194:195], v[198:199] neg_lo:[1,0,0] neg_hi:[1,0,0]
    v_pk_fma_f32 v[132:133], v[130:131], v[186:187], v[202:203] neg_lo:[1,0,0] neg_hi:[1,0,0]
    v_pk_fma_f32 v[98:99], v[96:97], v[188:189], v[6:7]
    v_pk_fma_f32 v[114:115], v[112:113], v[188:189], v[10:11]
    v_pk_fma_f32 v[146:147], v[130:131], v[192:193], v[200:201]
    v_pk_fma_f32 v[134:135], v[130:131], v[184:185], v[204:205]
    v_pk_mul_f32 v[4:5], v[66:67], v[188:189]
    v_pk_mul_f32 v[8:9], v[82:83], v[188:189]
    v_pk_mul_f32 v[198:199], v[144:145], v[192:193]
    v_pk_mul_f32 v[202:203], v[128:129], v[180:181]
    v_pk_mul_f32 v[6:7], v[66:67], v[190:191]
    v_pk_mul_f32 v[10:11], v[82:83], v[190:191]
    v_pk_mul_f32 v[200:201], v[144:145], v[194:195]
    v_pk_mul_f32 v[204:205], v[128:129], v[182:183]
    v_pk_fma_f32 v[68:69], v[98:99], v[190:191], v[4:5] neg_lo:[1,0,0] neg_hi:[1,0,0]
    v_pk_fma_f32 v[84:85], v[114:115], v[190:191], v[8:9] neg_lo:[1,0,0] neg_hi:[1,0,0]
    v_pk_fma_f32 v[152:153], v[146:147], v[194:195], v[198:199] neg_lo:[1,0,0] neg_hi:[1,0,0]
    v_pk_fma_f32 v[136:137], v[130:131], v[182:183], v[202:203] neg_lo:[1,0,0] neg_hi:[1,0,0]
    v_pk_fma_f32 v[100:101], v[98:99], v[188:189], v[6:7]
    v_pk_fma_f32 v[116:117], v[114:115], v[188:189], v[10:11]
    v_pk_fma_f32 v[154:155], v[146:147], v[192:193], v[200:201]
    v_pk_fma_f32 v[138:139], v[130:131], v[180:181], v[204:205]
    v_pk_mul_f32 v[4:5], v[68:69], v[188:189]
    v_pk_mul_f32 v[8:9], v[84:85], v[188:189]
    v_pk_mul_f32 v[198:199], v[152:153], v[192:193]
    v_pk_mul_f32 v[202:203], v[132:133], v[180:181]
    v_pk_mul_f32 v[6:7], v[68:69], v[190:191]
    v_pk_mul_f32 v[10:11], v[84:85], v[190:191]
    v_pk_mul_f32 v[200:201], v[152:153], v[194:195]
    v_pk_mul_f32 v[204:205], v[132:133], v[182:183]
    v_pk_fma_f32 v[70:71], v[100:101], v[190:191], v[4:5] neg_lo:[1,0,0] neg_hi:[1,0,0]
    v_pk_fma_f32 v[86:87], v[116:117], v[190:191], v[8:9] neg_lo:[1,0,0] neg_hi:[1,0,0]
    v_pk_fma_f32 v[156:157], v[154:155], v[194:195], v[198:199] neg_lo:[1,0,0] neg_hi:[1,0,0]
    v_pk_fma_f32 v[140:141], v[134:135], v[182:183], v[202:203] neg_lo:[1,0,0] neg_hi:[1,0,0]
    v_pk_fma_f32 v[102:103], v[100:101], v[188:189], v[6:7]
    v_pk_fma_f32 v[118:119], v[116:117], v[188:189], v[10:11]
    v_pk_fma_f32 v[158:159], v[154:155], v[192:193], v[200:201]
    v_pk_fma_f32 v[142:143], v[134:135], v[180:181], v[204:205]
    v_pk_mul_f32 v[4:5], v[70:71], v[188:189]
    v_pk_mul_f32 v[8:9], v[86:87], v[188:189]
    v_pk_mul_f32 v[198:199], v[156:157], v[192:193]
    v_pk_mul_f32 v[202:203], v[132:133], v[192:193]
    v_pk_mul_f32 v[6:7], v[70:71], v[190:191]
    v_pk_mul_f32 v[10:11], v[86:87], v[190:191]
    v_pk_mul_f32 v[200:201], v[156:157], v[194:195]
    v_pk_mul_f32 v[204:205], v[132:133], v[194:195]
    v_pk_fma_f32 v[72:73], v[102:103], v[190:191], v[4:5] neg_lo:[1,0,0] neg_hi:[1,0,0]
    v_pk_fma_f32 v[88:89], v[118:119], v[190:191], v[8:9] neg_lo:[1,0,0] neg_hi:[1,0,0]
    v_pk_fma_f32 v[160:161], v[158:159], v[194:195], v[198:199] neg_lo:[1,0,0] neg_hi:[1,0,0]
    v_pk_fma_f32 v[148:149], v[134:135], v[194:195], v[202:203] neg_lo:[1,0,0] neg_hi:[1,0,0]
    v_pk_fma_f32 v[104:105], v[102:103], v[188:189], v[6:7]
    v_pk_fma_f32 v[120:121], v[118:119], v[188:189], v[10:11]
    v_pk_fma_f32 v[162:163], v[158:159], v[192:193], v[200:201]
    v_pk_fma_f32 v[150:151], v[134:135], v[192:193], v[204:205]
    v_pk_mul_f32 v[4:5], v[72:73], v[188:189]
    v_pk_mul_f32 v[8:9], v[88:89], v[188:189]
    v_pk_mul_f32 v[198:199], v[160:161], v[192:193]
    v_pk_mul_f32 v[6:7], v[72:73], v[190:191]
    v_pk_mul_f32 v[10:11], v[88:89], v[190:191]
    v_pk_mul_f32 v[200:201], v[160:161], v[194:195]
    v_pk_fma_f32 v[74:75], v[104:105], v[190:191], v[4:5] neg_lo:[1,0,0] neg_hi:[1,0,0]
    v_pk_fma_f32 v[90:91], v[120:121], v[190:191], v[8:9] neg_lo:[1,0,0] neg_hi:[1,0,0]
    v_pk_fma_f32 v[164:165], v[162:163], v[194:195], v[198:199] neg_lo:[1,0,0] neg_hi:[1,0,0]
    v_pk_fma_f32 v[106:107], v[104:105], v[188:189], v[6:7]
    v_pk_fma_f32 v[122:123], v[120:121], v[188:189], v[10:11]
    v_pk_fma_f32 v[166:167], v[162:163], v[192:193], v[200:201]
    v_pk_mul_f32 v[4:5], v[74:75], v[188:189]
    v_pk_mul_f32 v[8:9], v[90:91], v[188:189]
    v_pk_mul_f32 v[198:199], v[164:165], v[192:193]
    v_pk_mul_f32 v[6:7], v[74:75], v[190:191]
    v_pk_mul_f32 v[10:11], v[90:91], v[190:191]
    v_pk_mul_f32 v[200:201], v[164:165], v[194:195]
    v_pk_fma_f32 v[76:77], v[106:107], v[190:191], v[4:5] neg_lo:[1,0,0] neg_hi:[1,0,0]
    v_pk_fma_f32 v[92:93], v[122:123], v[190:191], v[8:9] neg_lo:[1,0,0] neg_hi:[1,0,0]
    v_pk_fma_f32 v[168:169], v[166:167], v[194:195], v[198:199] neg_lo:[1,0,0] neg_hi:[1,0,0]
    v_pk_fma_f32 v[108:109], v[106:107], v[188:189], v[6:7]
    v_pk_fma_f32 v[124:125], v[122:123], v[188:189], v[10:11]
    v_pk_fma_f32 v[170:171], v[166:167], v[192:193], v[200:201]
    v_pk_mul_f32 v[4:5], v[76:77], v[188:189]
    v_pk_mul_f32 v[8:9], v[92:93], v[188:189]
    v_pk_mul_f32 v[198:199], v[168:169], v[192:193]
    v_pk_mul_f32 v[6:7], v[76:77], v[190:191]
    v_pk_mul_f32 v[10:11], v[92:93], v[190:191]
    v_pk_mul_f32 v[200:201], v[168:169], v[194:195]
    v_pk_fma_f32 v[78:79], v[108:109], v[190:191], v[4:5] neg_lo:[1,0,0] neg_hi:[1,0,0]
    v_pk_fma_f32 v[94:95], v[124:125], v[190:191], v[8:9] neg_lo:[1,0,0] neg_hi:[1,0,0]
    v_pk_fma_f32 v[172:173], v[170:171], v[194:195], v[198:199] neg_lo:[1,0,0] neg_hi:[1,0,0]
    v_pk_fma_f32 v[110:111], v[108:109], v[188:189], v[6:7]
    v_pk_fma_f32 v[126:127], v[124:125], v[188:189], v[10:11]
    v_pk_fma_f32 v[174:175], v[170:171], v[192:193], v[200:201]
    v_pk_mul_f32 v[198:199], v[172:173], v[192:193]
    v_pk_mul_f32 v[200:201], v[172:173], v[194:195]
    v_pk_fma_f32 v[176:177], v[174:175], v[194:195], v[198:199] neg_lo:[1,0,0] neg_hi:[1,0,0]
    v_pk_fma_f32 v[178:179], v[174:175], v[192:193], v[200:201]
    v_cvt_pk_bf16_f32 v24, v128, v136
    v_cvt_pk_bf16_f32 v25, v132, v140
    v_cvt_pk_bf16_f32 v26, v129, v137
    v_cvt_pk_bf16_f32 v27, v133, v141
    v_cvt_pk_bf16_f32 v36, -v130, -v138
    v_cvt_pk_bf16_f32 v37, -v134, -v142
    v_cvt_pk_bf16_f32 v38, -v131, -v139
    v_cvt_pk_bf16_f32 v39, -v135, -v143
    v_cvt_pk_bf16_f32 v28, v144, v148
    v_cvt_pk_bf16_f32 v29, v145, v149
    v_cvt_pk_bf16_f32 v30, v152, v153
    v_cvt_pk_bf16_f32 v31, v156, v157
    v_cvt_pk_bf16_f32 v40, -v146, -v150
    v_cvt_pk_bf16_f32 v41, -v147, -v151
    v_cvt_pk_bf16_f32 v42, -v154, -v155
    v_cvt_pk_bf16_f32 v43, -v158, -v159
    v_permlane32_swap_b32 v24, v36
    v_permlane32_swap_b32 v25, v37
    v_permlane32_swap_b32 v26, v38
    v_permlane32_swap_b32 v27, v39
    ds_write_b128 v59, v[24:27] offset:5120
    v_cvt_pk_bf16_f32 v32, v160, v164
    v_cvt_pk_bf16_f32 v33, v168, v172
    v_cvt_pk_bf16_f32 v34, v176, 0
    v_mov_b32 v35, 0
    v_cvt_pk_bf16_f32 v44, -v162, -v166
    v_cvt_pk_bf16_f32 v45, -v170, -v174
    v_cvt_pk_bf16_f32 v46, -v178, 0
    v_mov_b32 v47, 0
    v_permlane32_swap_b32 v28, v40
    v_permlane32_swap_b32 v29, v41
    v_permlane32_swap_b32 v30, v42
    v_permlane32_swap_b32 v31, v43
    ds_write_b128 v59, v[28:31] offset:5136
    v_cvt_pk_bf16_f32 v128, v64, v65
    v_cvt_pk_bf16_f32 v129, v66, v67
    v_cvt_pk_bf16_f32 v130, v68, v69
    v_cvt_pk_bf16_f32 v131, v70, v71
    v_cvt_pk_bf16_f32 v144, v96, v97
    v_cvt_pk_bf16_f32 v145, v98, v99
    v_cvt_pk_bf16_f32 v146, v100, v101
    v_cvt_pk_bf16_f32 v147, v102, v103
    v_permlane32_swap_b32 v32, v44
    v_permlane32_swap_b32 v33, v45
    v_permlane32_swap_b32 v34, v46
    v_permlane32_swap_b32 v35, v47
    ds_write_b128 v59, v[32:35] offset:5152
    v_cvt_pk_bf16_f32 v132, v72, v73
    v_cvt_pk_bf16_f32 v133, v74, v75
    v_cvt_pk_bf16_f32 v134, v76, v77
    v_cvt_pk_bf16_f32 v135, v78, v79
    v_cvt_pk_bf16_f32 v148, v104, v105
    v_cvt_pk_bf16_f32 v149, v106, v107
    v_cvt_pk_bf16_f32 v150, v108, v109
    v_cvt_pk_bf16_f32 v151, v110, v111
    v_permlane32_swap_b32 v128, v144
    v_permlane32_swap_b32 v129, v145
    v_permlane32_swap_b32 v130, v146
    v_permlane32_swap_b32 v131, v147
    ds_write_b128 v57, v[128:131]
    v_cvt_pk_bf16_f32 v136, v80, v81
    v_cvt_pk_bf16_f32 v137, v82, v83
    v_cvt_pk_bf16_f32 v138, v84, v85
    v_cvt_pk_bf16_f32 v139, v86, v87
    v_cvt_pk_bf16_f32 v152, v112, v113
    v_cvt_pk_bf16_f32 v153, v114, v115
    v_cvt_pk_bf16_f32 v154, v116, v117
    v_cvt_pk_bf16_f32 v155, v118, v119
    v_permlane32_swap_b32 v132, v148
    v_permlane32_swap_b32 v133, v149
    v_permlane32_swap_b32 v134, v150
    v_permlane32_swap_b32 v135, v151
    ds_write_b128 v61, v[132:135]
    v_cvt_pk_bf16_f32 v140, v88, v89
    v_cvt_pk_bf16_f32 v141, v90, v91
    v_cvt_pk_bf16_f32 v142, v92, v93
    v_cvt_pk_bf16_f32 v143, v94, v95
    v_cvt_pk_bf16_f32 v156, v120, v121
    v_cvt_pk_bf16_f32 v157, v122, v123
    v_cvt_pk_bf16_f32 v158, v124, v125
    v_cvt_pk_bf16_f32 v159, v126, v127
    v_permlane32_swap_b32 v136, v152
    v_permlane32_swap_b32 v137, v153
    v_permlane32_swap_b32 v138, v154
    v_permlane32_swap_b32 v139, v155
    ds_write_b128 v62, v[136:139]
    s_nop 1
    v_permlane32_swap_b32 v140, v156
    v_permlane32_swap_b32 v141, v157
    v_permlane32_swap_b32 v142, v158
    v_permlane32_swap_b32 v143, v159
    ds_write_b128 v63, v[140:143]
    ds_read_b64_tr_b16 v[208:209], v60 offset:5120
    ds_read_b64_tr_b16 v[210:211], v60 offset:6656
    ds_read_b64_tr_b16 v[212:213], v58 offset:0
    ds_read_b64_tr_b16 v[214:215], v58 offset:2048
    ds_read_b64_tr_b16 v[216:217], v60 offset:5504
    ds_read_b64_tr_b16 v[218:219], v60 offset:7040
    ds_read_b64_tr_b16 v[220:221], v58 offset:512
    ds_read_b64_tr_b16 v[222:223], v58 offset:2560
    s_waitcnt lgkmcnt(14)
    ds_read_b64_tr_b16 v[224:225], v60 offset:5888
    s_waitcnt lgkmcnt(14)
    ds_read_b64_tr_b16 v[226:227], v60 offset:7424
    s_waitcnt lgkmcnt(14)
    ds_read_b64_tr_b16 v[228:229], v58 offset:1024
    s_waitcnt lgkmcnt(14)
    ds_read_b64_tr_b16 v[230:231], v58 offset:3072
    s_waitcnt lgkmcnt(14)
    ds_read_b64_tr_b16 v[232:233], v60 offset:6272
    s_waitcnt lgkmcnt(14)
    ds_read_b64_tr_b16 v[234:235], v60 offset:7808
    s_waitcnt lgkmcnt(14)
    ds_read_b64_tr_b16 v[236:237], v58 offset:1536
    s_waitcnt lgkmcnt(14)
    ds_read_b64_tr_b16 v[238:239], v58 offset:3584
    s_waitcnt lgkmcnt(14)
    ds_write_b128 v59, v[36:39] offset:5120
    s_waitcnt lgkmcnt(14)
    ds_write_b128 v59, v[40:43] offset:5136
    s_waitcnt lgkmcnt(14)
    ds_write_b128 v59, v[44:47] offset:5152
    v_mfma_f32_32x32x16_bf16 v[240:255], v[208:211], v[212:215], 0
    s_waitcnt lgkmcnt(14)
    ds_write_b128 v57, v[144:147]
    s_waitcnt lgkmcnt(14)
    ds_write_b128 v61, v[148:151]
    v_lshrrev_b32 v1, 4, v0
    v_bfe_u32 v2, v0, 2, 2
    v_and_b32 v3, 1, v1
    v_lshl_or_b32 v3, v3, 2, v2
    v_lshlrev_b32 v5, 11, v1
    v_lshl_add_u32 v5, v2, 8, v5
    s_waitcnt lgkmcnt(13)
    v_mfma_f32_32x32x16_bf16 v[240:255], v[216:219], v[220:223], v[240:255]
    ds_write_b128 v62, v[152:155]
    ds_write_b128 v63, v[156:159]
    v_and_b32 v2, 3, v0
    v_lshl_add_u32 v5, v2, 3, v5
    v_add_u32 v5, 49152, v5
    s_lshl_b32 s24, s28, 2
    s_add_u32 s25, s24, 0
    v_xor_b32 v6, s25, v3
    s_waitcnt lgkmcnt(11)
    v_mfma_f32_32x32x16_bf16 v[240:255], v[224:227], v[228:231], v[240:255]
    ds_read_b64_tr_b16 v[64:65], v60 offset:5120
    ds_read_b64_tr_b16 v[66:67], v60 offset:6656
    ds_read_b64_tr_b16 v[68:69], v58 offset:0
    ds_read_b64_tr_b16 v[70:71], v58 offset:2048
    s_waitcnt lgkmcnt(14)
    ds_read_b64_tr_b16 v[72:73], v60 offset:5504
    s_waitcnt lgkmcnt(14)
    ds_read_b64_tr_b16 v[74:75], v60 offset:7040
    s_waitcnt lgkmcnt(14)
    ds_read_b64_tr_b16 v[76:77], v58 offset:512
    s_waitcnt lgkmcnt(14)
    ds_read_b64_tr_b16 v[78:79], v58 offset:2560
    v_lshl_add_u32 v112, v6, 5, v5
    s_add_u32 s25, s24, 1
    v_xor_b32 v6, s25, v3
    v_lshl_add_u32 v113, v6, 5, v5
    s_add_u32 s25, s24, 2
    v_xor_b32 v6, s25, v3
    v_mfma_f32_32x32x16_bf16 v[240:255], v[232:235], v[236:239], v[240:255]
    s_waitcnt lgkmcnt(14)
    ds_read_b64_tr_b16 v[80:81], v60 offset:5888
    s_waitcnt lgkmcnt(14)
    ds_read_b64_tr_b16 v[82:83], v60 offset:7424
    s_waitcnt lgkmcnt(14)
    ds_read_b64_tr_b16 v[84:85], v58 offset:1024
    s_waitcnt lgkmcnt(14)
    ds_read_b64_tr_b16 v[86:87], v58 offset:3072
    s_waitcnt lgkmcnt(14)
    ds_read_b64_tr_b16 v[88:89], v60 offset:6272
    s_waitcnt lgkmcnt(14)
    ds_read_b64_tr_b16 v[90:91], v60 offset:7808
    s_waitcnt lgkmcnt(14)
    ds_read_b64_tr_b16 v[92:93], v58 offset:1536
    s_waitcnt lgkmcnt(14)
    ds_read_b64_tr_b16 v[94:95], v58 offset:3584
    v_lshl_add_u32 v114, v6, 5, v5
    s_add_u32 s25, s24, 3
    v_xor_b32 v6, s25, v3
    v_lshl_add_u32 v115, v6, 5, v5
    v_and_b32 v2, 15, v0
    v_bfe_u32 v3, v0, 1, 3
    s_waitcnt lgkmcnt(12)
    v_mfma_f32_32x32x16_bf16 v[240:255], v[64:67], v[68:71], v[240:255]
    v_xor_b32 v3, v3, v1
    v_lshlrev_b32 v3, 4, v3
    v_lshl_add_u32 v3, v2, 7, v3
    s_lshl_b32 s24, s29, 13
    v_add_u32 v116, s24, v3
    v_xor_b32 v117, 64, v116
    s_waitcnt lgkmcnt(8)
    v_mfma_f32_32x32x16_bf16 v[240:255], v[72:75], v[76:79], v[240:255]
    s_lshl_b32 s24, s3, 2
    s_add_u32 s24, s24, 161280
    v_mov_b32 v118, s24
    v_lshrrev_b32 v3, 5, v0
    v_mul_u32_u24 v119, 260, v3
    v_add_u32 v119, 161408, v119
    s_waitcnt lgkmcnt(4)
    v_mfma_f32_32x32x16_bf16 v[240:255], v[80:83], v[84:87], v[240:255]
    s_lshl_b32 s24, s28, 8
    s_add_u32 s24, s24, 159744
    v_lshl_add_u32 v11, v1, 4, s24
    v_mov_b64 v[120:121], 0
    v_mov_b64 v[122:123], 0
    v_mov_b32 v124, 0x3f803f80
    s_waitcnt lgkmcnt(0)
    v_mfma_f32_32x32x16_bf16 v[240:255], v[88:91], v[92:95], v[240:255]
    v_mov_b32 v125, 0x3f803f80
    v_mov_b32 v126, 0x3f803f80
    v_mov_b32 v127, 0x3f803f80
    s_and_b32 s31, s70, 7
    s_add_u32 s12, s12, 1
    s_nop 7
    ds_write_b128 v16, v[240:243]
    ds_write_b64 v17, v[244:245]
    ds_write_b64 v18, v[246:247]
    ds_write2_b32 v19, v248, v249 offset0:0 offset1:32
    ds_write2_b32 v19, v250, v251 offset0:64 offset1:96
    v_add_u32 v16, 3072, v16
    v_add_u32 v17, 3072, v17
    v_add_u32 v18, 3072, v18
    v_add_u32 v19, 3072, v19
    s_cmp_lt_u32 s12, s13
    s_cbranch_scc1 L_KCHUNK
    s_cmp_eq_u32 s55, 1
    s_cbranch_scc1 L_EXP2
    v_mov_b32 v1, 161280
    v_mov_b32 v3, 1
    s_mov_b64 exec, 1
    ds_add_u32 v1, v3 offset:104
    s_mov_b64 exec, -1
    s_branch L_C
L_EXP:
    v_mov_b32 v8, 161280
    s_mov_b32 s83, 200000
SPL38:
    ds_read_b32 v12, v8 offset:104
    s_waitcnt lgkmcnt(0)
    s_nop 0
    v_readfirstlane_b32 s82, v12
    s_sub_u32 s83, s83, 1
    s_cselect_b32 s82, -1, s82
    s_cmp_ge_u32 s82, 4
    s_cbranch_scc1 SPD39
    s_sleep 2
    s_branch SPL38
SPD39:
    s_branch L_EXP3
L_EXP2:
    s_add_u32 s77, s15, 4294903808
    s_add_u32 s78, s15, 4608
    v_lshlrev_b32 v5, 3, v0
    v_add_u32 v5, s15, v5
    v_mov_b64 v[6:7], 0
    ds_write_b64 v5, v[6:7]
    v_lshlrev_b32 v1, 3, v0
    v_sub_u32 v1, 2048, v1
    v_cvt_f32_u32 v2, v1
    v_add_f32 v3, 0x3f800000, v2
    v_add_f32 v4, 0x80000000, v2
    v_cvt_pk_bf16_f32 v5, v3, v4
    v_and_b32 v6, 0xffff, v5
    v_lshrrev_b32 v5, 16, v5
    v_lshl_add_u32 v212, v6, 2, s77
    v_lshl_add_u32 v213, v5, 2, s77
    v_add_f32 v7, 0xbf800000, v2
    v_add_f32 v8, 0xc0000000, v2
    v_cvt_pk_bf16_f32 v9, v7, v8
    v_and_b32 v10, 0xffff, v9
    v_lshrrev_b32 v9, 16, v9
    v_lshl_add_u32 v214, v10, 2, s77
    v_lshl_add_u32 v215, v9, 2, s77
    v_add_f32 v3, 0xc0400000, v2
    v_add_f32 v4, 0xc0800000, v2
    v_cvt_pk_bf16_f32 v5, v3, v4
    v_and_b32 v6, 0xffff, v5
    v_lshrrev_b32 v5, 16, v5
    v_lshl_add_u32 v216, v6, 2, s77
    v_lshl_add_u32 v217, v5, 2, s77
    v_add_f32 v7, 0xc0a00000, v2
    v_add_f32 v8, 0xc0c00000, v2
    v_cvt_pk_bf16_f32 v9, v7, v8
    v_and_b32 v10, 0xffff, v9
    v_lshrrev_b32 v9, 16, v9
    v_lshl_add_u32 v218, v10, 2, s77
    v_lshl_add_u32 v219, v9, 2, s77
    v_add_f32 v3, 0xc0e00000, v2
    v_add_f32 v4, 0xc3ff8000, v2
    v_cvt_pk_bf16_f32 v5, v3, v4
    v_and_b32 v6, 0xffff, v5
    v_lshrrev_b32 v5, 16, v5
    v_lshl_add_u32 v220, v6, 2, s77
    v_lshl_add_u32 v221, v5, 2, s77
    v_add_f32 v7, 0xc4000000, v2
    v_add_f32 v8, 0xc4004000, v2
    v_cvt_pk_bf16_f32 v9, v7, v8
    v_and_b32 v10, 0xffff, v9
    v_lshrrev_b32 v9, 16, v9
    v_lshl_add_u32 v222, v10, 2, s77
    v_lshl_add_u32 v223, v9, 2, s77
    v_add_f32 v3, 0xc4008000, v2
    v_add_f32 v4, 0xc400c000, v2
    v_cvt_pk_bf16_f32 v5, v3, v4
    v_and_b32 v6, 0xffff, v5
    v_lshrrev_b32 v5, 16, v5
    v_lshl_add_u32 v224, v6, 2, s77
    v_lshl_add_u32 v225, v5, 2, s77
    v_add_f32 v7, 0xc4010000, v2
    v_add_f32 v8, 0xc4014000, v2
    v_cvt_pk_bf16_f32 v9, v7, v8
    v_and_b32 v10, 0xffff, v9
    v_lshrrev_b32 v9, 16, v9
    v_lshl_add_u32 v226, v10, 2, s77
    v_lshl_add_u32 v227, v9, 2, s77
    v_add_f32 v3, 0xc4018000, v2
    v_add_f32 v4, 0xc401c000, v2
    v_cvt_pk_bf16_f32 v5, v3, v4
    v_and_b32 v6, 0xffff, v5
    v_lshrrev_b32 v5, 16, v5
    v_lshl_add_u32 v228, v6, 2, s77
    v_lshl_add_u32 v229, v5, 2, s77
    v_add_f32 v7, 0xc47fc000, v2
    v_add_f32 v8, 0xc4800000, v2
    v_cvt_pk_bf16_f32 v9, v7, v8
    v_and_b32 v10, 0xffff, v9
    v_lshrrev_b32 v9, 16, v9
    v_lshl_add_u32 v230, v10, 2, s77
    v_lshl_add_u32 v231, v9, 2, s77
    v_add_f32 v3, 0xc4802000, v2
    v_add_f32 v4, 0xc4804000, v2
    v_cvt_pk_bf16_f32 v5, v3, v4
    v_and_b32 v6, 0xffff, v5
    v_lshrrev_b32 v5, 16, v5
    v_lshl_add_u32 v232, v6, 2, s77
    v_lshl_add_u32 v233, v5, 2, s77
    v_add_f32 v7, 0xc4806000, v2
    v_add_f32 v8, 0xc4808000, v2
    v_cvt_pk_bf16_f32 v9, v7, v8
    v_and_b32 v10, 0xffff, v9
    v_lshrrev_b32 v9, 16, v9
    v_lshl_add_u32 v234, v10, 2, s77
    v_lshl_add_u32 v235, v9, 2, s77
    v_add_f32 v3, 0xc480a000, v2
    v_add_f32 v4, 0xc480c000, v2
    v_cvt_pk_bf16_f32 v5, v3, v4
    v_and_b32 v6, 0xffff, v5
    v_lshrrev_b32 v5, 16, v5
    v_lshl_add_u32 v236, v6, 2, s77
    v_lshl_add_u32 v237, v5, 2, s77
    v_add_f32 v7, 0xc480e000, v2
    v_add_f32 v8, 0xc4bfe000, v2
    v_cvt_pk_bf16_f32 v9, v7, v8
    v_and_b32 v10, 0xffff, v9
    v_lshrrev_b32 v9, 16, v9
    v_lshl_add_u32 v238, v10, 2, s77
    v_lshl_add_u32 v239, v9, 2, s77
    v_subrev_u32 v7, 1535, v1
    v_min_u32 v7, 128, v7
    v_lshl_add_u32 v7, v7, 2, s78
    v_max_i32 v239, v239, v7
    v_add_f32 v3, 0xc4c00000, v2
    v_add_f32 v4, 0xc4c02000, v2
    v_cvt_pk_bf16_f32 v5, v3, v4
    v_and_b32 v6, 0xffff, v5
    v_lshrrev_b32 v5, 16, v5
    v_lshl_add_u32 v240, v6, 2, s77
    v_lshl_add_u32 v241, v5, 2, s77
    v_subrev_u32 v3, 1536, v1
    v_min_u32 v3, 128, v3
    v_lshl_add_u32 v3, v3, 2, s78
    v_max_i32 v240, v240, v3
    v_subrev_u32 v3, 1537, v1
    v_min_u32 v3, 128, v3
    v_lshl_add_u32 v3, v3, 2, s78
    v_max_i32 v241, v241, v3
    v_add_f32 v7, 0xc4c04000, v2
    v_add_f32 v8, 0xc4c06000, v2
    v_cvt_pk_bf16_f32 v9, v7, v8
    v_and_b32 v10, 0xffff, v9
    v_lshrrev_b32 v9, 16, v9
    v_lshl_add_u32 v242, v10, 2, s77
    v_lshl_add_u32 v243, v9, 2, s77
    v_subrev_u32 v7, 1538, v1
    v_min_u32 v7, 128, v7
    v_lshl_add_u32 v7, v7, 2, s78
    v_max_i32 v242, v242, v7
    v_subrev_u32 v7, 1539, v1
    v_min_u32 v7, 128, v7
    v_lshl_add_u32 v7, v7, 2, s78
    v_max_i32 v243, v243, v7
    v_add_f32 v3, 0xc4c08000, v2
    v_add_f32 v4, 0xc4c0a000, v2
    v_cvt_pk_bf16_f32 v5, v3, v4
    v_and_b32 v6, 0xffff, v5
    v_lshrrev_b32 v5, 16, v5
    v_lshl_add_u32 v244, v6, 2, s77
    v_lshl_add_u32 v245, v5, 2, s77
    v_subrev_u32 v3, 1540, v1
    v_min_u32 v3, 128, v3
    v_lshl_add_u32 v3, v3, 2, s78
    v_max_i32 v244, v244, v3
    v_subrev_u32 v3, 1541, v1
    v_min_u32 v3, 128, v3
    v_lshl_add_u32 v3, v3, 2, s78
    v_max_i32 v245, v245, v3
    v_add_f32 v7, 0xc4c0c000, v2
    v_add_f32 v8, 0xc4c0e000, v2
    v_cvt_pk_bf16_f32 v9, v7, v8
    v_and_b32 v10, 0xffff, v9
    v_lshrrev_b32 v9, 16, v9
    v_lshl_add_u32 v246, v10, 2, s77
    v_lshl_add_u32 v247, v9, 2, s77
    v_subrev_u32 v7, 1542, v1
    v_min_u32 v7, 128, v7
    v_lshl_add_u32 v7, v7, 2, s78
    v_max_i32 v246, v246, v7
    v_subrev_u32 v7, 1543, v1
    v_min_u32 v7, 128, v7
    v_lshl_add_u32 v7, v7, 2, s78
    v_max_i32 v247, v247, v7
    s_cmp_ge_u32 s3, 6
    s_cbranch_scc1 L_AUXD
L_EXP3:
    s_add_u32 s78, s15, 4608
    s_add_u32 s79, s15, 13696
    s_sub_u32 s8, s14, s75
    s_lshl_b32 s8, s8, 2
    s_add_u32 s8, s8, 161280
    v_mov_b32 v4, s78
    ds_read_b64 v[60:61], v4
    ds_read_b64 v[62:63], v4 offset:3072
    s_waitcnt lgkmcnt(14)
    ds_read2st64_b32 v[64:65], v212 offset0:0 offset1:12
    s_waitcnt lgkmcnt(14)
    ds_read2st64_b32 v[66:67], v213 offset0:0 offset1:12
    s_waitcnt lgkmcnt(14)
    ds_read2st64_b32 v[68:69], v214 offset0:0 offset1:12
    s_waitcnt lgkmcnt(14)
    ds_read2st64_b32 v[70:71], v215 offset0:0 offset1:12
    s_waitcnt lgkmcnt(14)
    ds_read2st64_b32 v[72:73], v216 offset0:0 offset1:12
    s_waitcnt lgkmcnt(14)
    ds_read2st64_b32 v[74:75], v217 offset0:0 offset1:12
    s_waitcnt lgkmcnt(14)
    ds_read2st64_b32 v[76:77], v218 offset0:0 offset1:12
    s_waitcnt lgkmcnt(14)
    ds_read2st64_b32 v[78:79], v219 offset0:0 offset1:12
    s_waitcnt lgkmcnt(14)
    ds_read2st64_b32 v[80:81], v220 offset0:0 offset1:12
    s_waitcnt lgkmcnt(14)
    ds_read2st64_b32 v[82:83], v221 offset0:0 offset1:12
    s_waitcnt lgkmcnt(14)
    ds_read2st64_b32 v[84:85], v222 offset0:0 offset1:12
    s_waitcnt lgkmcnt(14)
    ds_read2st64_b32 v[86:87], v223 offset0:0 offset1:12
    v_lshlrev_b32 v5, 4, v0
    v_add_u32 v5, s79, v5
    v_cmp_eq_u32 vcc, 0, v0
    v_lshlrev_b32 v4, 2, v0
    v_add_u32 v4, s79, v4
    s_waitcnt lgkmcnt(12)
    v_add_f32 v60, v60, v62
    v_add_f32 v61, v61, v63
    v_mov_b32 v62, 0
    v_cvt_pk_bf16_f32 v2, v60, v62
    v_cvt_pk_bf16_f32 v3, v61, v60
    v_cndmask_b32 v2, 0, v2, vcc
    v_cndmask_b32 v3, 0, v3, vcc
    s_waitcnt lgkmcnt(3)
    v_add_f32 v64, v64, v65
    ds_read2st64_b32 v[88:89], v224 offset0:0 offset1:12
    v_add_f32 v66, v66, v67
    ds_read2st64_b32 v[90:91], v225 offset0:0 offset1:12
    v_add_f32 v68, v68, v69
    ds_read2st64_b32 v[92:93], v226 offset0:0 offset1:12
    v_add_f32 v70, v70, v71
    ds_read2st64_b32 v[94:95], v227 offset0:0 offset1:12
    v_add_f32 v72, v72, v73
    ds_read2st64_b32 v[96:97], v228 offset0:0 offset1:12
    v_add_f32 v74, v74, v75
    ds_read2st64_b32 v[98:99], v229 offset0:0 offset1:12
    v_add_f32 v76, v76, v77
    ds_read2st64_b32 v[100:101], v230 offset0:0 offset1:12
    v_add_f32 v78, v78, v79
    ds_read2st64_b32 v[102:103], v231 offset0:0 offset1:12
    v_add_f32 v80, v80, v81
    ds_read2st64_b32 v[104:105], v232 offset0:0 offset1:12
    v_cvt_pk_bf16_f32 v160, v66, v68
    v_cvt_pk_bf16_f32 v161, v70, v72
    v_cvt_pk_bf16_f32 v162, v74, v76
    v_cvt_pk_bf16_f32 v163, v78, v80
    v_cvt_pk_bf16_f32 v164, v64, v66
    v_cvt_pk_bf16_f32 v165, v68, v70
    v_cvt_pk_bf16_f32 v166, v72, v74
    v_cvt_pk_bf16_f32 v167, v76, v78
    s_waitcnt lgkmcnt(3)
    v_add_f32 v82, v82, v83
    ds_read2st64_b32 v[106:107], v233 offset0:0 offset1:12
    v_add_f32 v84, v84, v85
    ds_read2st64_b32 v[108:109], v234 offset0:0 offset1:12
    v_add_f32 v86, v86, v87
    ds_read2st64_b32 v[110:111], v235 offset0:0 offset1:12
    v_add_f32 v88, v88, v89
    ds_read2st64_b32 v[112:113], v236 offset0:0 offset1:12
    v_add_f32 v90, v90, v91
    ds_read2st64_b32 v[114:115], v237 offset0:0 offset1:12
    v_add_f32 v92, v92, v93
    ds_read2st64_b32 v[116:117], v238 offset0:0 offset1:12
    v_add_f32 v94, v94, v95
    ds_read2st64_b32 v[118:119], v239 offset0:0 offset1:12
    v_add_f32 v96, v96, v97
    ds_read2st64_b32 v[120:121], v240 offset0:0 offset1:12
    v_add_f32 v98, v98, v99
    ds_read2st64_b32 v[122:123], v241 offset0:0 offset1:12
    v_cvt_pk_bf16_f32 v168, v84, v86
    v_cvt_pk_bf16_f32 v169, v88, v90
    v_cvt_pk_bf16_f32 v170, v92, v94
    v_cvt_pk_bf16_f32 v171, v96, v98
    v_cvt_pk_bf16_f32 v172, v82, v84
    v_cvt_pk_bf16_f32 v173, v86, v88
    v_cvt_pk_bf16_f32 v174, v90, v92
    v_cvt_pk_bf16_f32 v175, v94, v96
    s_waitcnt lgkmcnt(3)
    v_add_f32 v100, v100, v101
    ds_read2st64_b32 v[124:125], v242 offset0:0 offset1:12
    v_add_f32 v102, v102, v103
    ds_read2st64_b32 v[126:127], v243 offset0:0 offset1:12
    v_add_f32 v104, v104, v105
    ds_read2st64_b32 v[128:129], v244 offset0:0 offset1:12
    v_add_f32 v106, v106, v107
    ds_read2st64_b32 v[130:131], v245 offset0:0 offset1:12
    v_add_f32 v108, v108, v109
    ds_read2st64_b32 v[132:133], v246 offset0:0 offset1:12
    v_add_f32 v110, v110, v111
    ds_read2st64_b32 v[134:135], v247 offset0:0 offset1:12
    v_add_f32 v112, v112, v113
    v_add_f32 v114, v114, v115
    v_add_f32 v116, v116, v117
    v_cvt_pk_bf16_f32 v176, v102, v104
    v_cvt_pk_bf16_f32 v177, v106, v108
    v_cvt_pk_bf16_f32 v178, v110, v112
    v_cvt_pk_bf16_f32 v179, v114, v116
    v_cvt_pk_bf16_f32 v180, v100, v102
    v_cvt_pk_bf16_f32 v181, v104, v106
    v_cvt_pk_bf16_f32 v182, v108, v110
    v_cvt_pk_bf16_f32 v183, v112, v114
    s_waitcnt lgkmcnt(0)
    v_add_f32 v118, v118, v119
    v_add_f32 v120, v120, v121
    v_add_f32 v122, v122, v123
    v_add_f32 v124, v124, v125
    v_add_f32 v126, v126, v127
    v_add_f32 v128, v128, v129
    v_add_f32 v130, v130, v131
    v_add_f32 v132, v132, v133
    v_add_f32 v134, v134, v135
    v_cvt_pk_bf16_f32 v184, v120, v122
    v_cvt_pk_bf16_f32 v185, v124, v126
    v_cvt_pk_bf16_f32 v186, v128, v130
    v_cvt_pk_bf16_f32 v187, v132, v134
    v_cvt_pk_bf16_f32 v188, v118, v120
    v_cvt_pk_bf16_f32 v189, v122, v124
    v_cvt_pk_bf16_f32 v190, v126, v128
    v_cvt_pk_bf16_f32 v191, v130, v132
    ds_write_b128 v5, v[160:163] offset:0
    ds_write_b128 v5, v[164:167] offset:4416
    ds_write_b128 v5, v[168:171] offset:1024
    ds_write_b128 v5, v[172:175] offset:5440
    ds_write_b128 v5, v[176:179] offset:2048
    ds_write_b128 v5, v[180:183] offset:6464
    ds_write_b128 v5, v[184:187] offset:3072
    ds_write_b128 v5, v[188:191] offset:7488
    ds_write_b32 v4, v2 offset:4096
    ds_write_b32 v4, v3 offset:8512
    s_waitcnt lgkmcnt(0)
    v_mov_b32 v1, s8
    v_mov_b32 v3, 1
    s_mov_b64 exec, 1
    ds_add_u32 v1, v3 offset:56
    s_mov_b64 exec, -1
L_EXE:
    s_cmp_lt_u32 s3, 6
    s_cbranch_scc1 L_EXD
    s_cmp_eq_u32 s3, 6
    s_cbranch_scc1 L_G2
    s_branch L_W7C
L_EXD:
    s_sub_u32 s71, s2, 224
    s_lshl_b32 s77, s3, 5
    s_add_u32 s77, s77, s71
    s_cmp_ge_u32 s77, 14
    s_cbranch_scc1 L_EXD2
    v_mov_b32 v8, 161280
    s_mov_b32 s83, 200000
SPL40:
    ds_read_b32 v12, v8 offset:20
    s_waitcnt lgkmcnt(0)
    s_nop 0
    v_readfirstlane_b32 s82, v12
    s_sub_u32 s83, s83, 1
    s_cselect_b32 s82, -1, s82
    s_cmp_ge_u32 s82, 1
    s_cbranch_scc1 SPD41
    s_sleep 2
    s_branch SPL40
SPD41:
    s_mov_b32 s54, s82
    s_branch L_CSC
L_EXD2:
    s_cmp_lt_u32 s3, 4
    s_cbranch_scc1 L_CONVH
    s_branch L_G2
L_WA:
    v_and_b32 v3, 31, v0
    v_lshlrev_b32 v3, 7, v3
    s_mov_b32 s13, 19464192
    s_mov_b32 s83, 12500
SPG42:
    buffer_load_dword v4, v3, s[16:19], s13 offen sc1
    s_waitcnt vmcnt(0)
    v_cmp_ne_u32 vcc, s54, v4
    s_sub_u32 s83, s83, 1
    s_cbranch_scc1 SPE43
    s_cmp_eq_u64 vcc, 0
    s_cbranch_scc1 SPE43
    s_sleep 2
    s_branch SPG42
SPE43:
    v_mov_b32 v4, s54
    v_mov_b32 v8, 161280
    ds_write_b32 v8, v4 offset:36
L_WA2:
    s_lshl_b32 s12, s75, 4
    s_add_u32 s12, s12, 0
    s_cmp_eq_u32 s55, 1
    s_cbranch_scc1 L_UG6
    v_lshrrev_b32 v1, 1, v0
    v_and_b32 v2, 1, v0
    v_mul_u32_u24 v5, 22528, v2
    v_add_u32 v5, 115200, v5
    v_lshl_add_u32 v5, v1, 4, v5
    v_mul_u32_u24 v1, 10240, v1
    v_lshl_add_u32 v1, v2, 4, v1
    buffer_load_dwordx4 v[64:67], v1, s[16:19], s12 offen sc1
    s_add_u32 s12, s12, 327680
    buffer_load_dwordx4 v[68:71], v1, s[16:19], s12 offen sc1
    s_add_u32 s12, s12, 327680
    buffer_load_dwordx4 v[72:75], v1, s[16:19], s12 offen sc1
    s_add_u32 s12, s12, 327680
    buffer_load_dwordx4 v[76:79], v1, s[16:19], s12 offen sc1
    s_add_u32 s12, s12, 327680
    buffer_load_dwordx4 v[80:83], v1, s[16:19], s12 offen sc1
    s_add_u32 s12, s12, 327680
    buffer_load_dwordx4 v[84:87], v1, s[16:19], s12 offen sc1
    s_add_u32 s12, s12, 327680
    buffer_load_dwordx4 v[88:91], v1, s[16:19], s12 offen sc1
    s_add_u32 s12, s12, 327680
    buffer_load_dwordx4 v[92:95], v1, s[16:19], s12 offen sc1
    s_add_u32 s12, s12, 327680
    s_waitcnt vmcnt(7)
    ds_write_b128 v5, v[64:67] offset:0
    s_waitcnt vmcnt(6)
    ds_write_b128 v5, v[68:71] offset:512
    s_waitcnt vmcnt(5)
    ds_write_b128 v5, v[72:75] offset:1024
    s_waitcnt vmcnt(4)
    ds_write_b128 v5, v[76:79] offset:1536
    s_waitcnt vmcnt(3)
    ds_write_b128 v5, v[80:83] offset:2048
    s_waitcnt vmcnt(2)
    ds_write_b128 v5, v[84:87] offset:2560
    s_waitcnt vmcnt(1)
    ds_write_b128 v5, v[88:91] offset:3072
    s_waitcnt vmcnt(0)
    ds_write_b128 v5, v[92:95] offset:3584
    s_mov_b64 exec, -1
    s_branch L_UGD
L_UG6:
    v_mul_u32_u24 v1, 43, v0
    v_lshrrev_b32 v1, 8, v1
    v_mul_u32_u24 v2, 6, v1
    v_sub_u32 v2, v0, v2
    v_cmp_le_u32 vcc, 4, v2
    v_mul_u32_u24 v5, 22528, v2
    v_mov_b32 v6, 24576
    v_cndmask_b32 v6, 0, v6, vcc
    v_add_u32 v5, v5, v6
    v_add_u32 v5, 512, v5
    v_lshl_add_u32 v5, v1, 4, v5
    v_mul_u32_u24 v1, 10240, v1
    v_lshl_add_u32 v1, v2, 4, v1
    s_mov_b32 exec_hi, 0xfffffff
    buffer_load_dwordx4 v[64:67], v1, s[16:19], s12 offen sc1
    s_add_u32 s12, s12, 102400
    buffer_load_dwordx4 v[68:71], v1, s[16:19], s12 offen sc1
    s_add_u32 s12, s12, 102400
    buffer_load_dwordx4 v[72:75], v1, s[16:19], s12 offen sc1
    s_add_u32 s12, s12, 102400
    buffer_load_dwordx4 v[76:79], v1, s[16:19], s12 offen sc1
    s_add_u32 s12, s12, 102400
    buffer_load_dwordx4 v[80:83], v1, s[16:19], s12 offen sc1
    s_add_u32 s12, s12, 102400
    buffer_load_dwordx4 v[84:87], v1, s[16:19], s12 offen sc1
    s_add_u32 s12, s12, 102400
    buffer_load_dwordx4 v[88:91], v1, s[16:19], s12 offen sc1
    s_add_u32 s12, s12, 102400
    buffer_load_dwordx4 v[92:95], v1, s[16:19], s12 offen sc1
    s_add_u32 s12, s12, 102400
    buffer_load_dwordx4 v[96:99], v1, s[16:19], s12 offen sc1
    s_add_u32 s12, s12, 102400
    buffer_load_dwordx4 v[100:103], v1, s[16:19], s12 offen sc1
    s_add_u32 s12, s12, 102400
    buffer_load_dwordx4 v[104:107], v1, s[16:19], s12 offen sc1
    s_add_u32 s12, s12, 102400
    buffer_load_dwordx4 v[108:111], v1, s[16:19], s12 offen sc1
    s_add_u32 s12, s12, 102400
    buffer_load_dwordx4 v[112:115], v1, s[16:19], s12 offen sc1
    s_add_u32 s12, s12, 102400
    buffer_load_dwordx4 v[116:119], v1, s[16:19], s12 offen sc1
    s_add_u32 s12, s12, 102400
    buffer_load_dwordx4 v[120:123], v1, s[16:19], s12 offen sc1
    s_add_u32 s12, s12, 102400
    buffer_load_dwordx4 v[124:127], v1, s[16:19], s12 offen sc1
    s_add_u32 s12, s12, 102400
    buffer_load_dwordx4 v[128:131], v1, s[16:19], s12 offen sc1
    s_add_u32 s12, s12, 102400
    buffer_load_dwordx4 v[132:135], v1, s[16:19], s12 offen sc1
    s_add_u32 s12, s12, 102400
    buffer_load_dwordx4 v[136:139], v1, s[16:19], s12 offen sc1
    s_add_u32 s12, s12, 102400
    buffer_load_dwordx4 v[140:143], v1, s[16:19], s12 offen sc1
    s_add_u32 s12, s12, 102400
    buffer_load_dwordx4 v[144:147], v1, s[16:19], s12 offen sc1
    s_add_u32 s12, s12, 102400
    buffer_load_dwordx4 v[148:151], v1, s[16:19], s12 offen sc1
    s_add_u32 s12, s12, 102400
    buffer_load_dwordx4 v[152:155], v1, s[16:19], s12 offen sc1
    s_add_u32 s12, s12, 102400
    buffer_load_dwordx4 v[156:159], v1, s[16:19], s12 offen sc1
    s_add_u32 s12, s12, 102400
    buffer_load_dwordx4 v[160:163], v1, s[16:19], s12 offen sc1
    s_add_u32 s12, s12, 102400
    s_mov_b32 exec_hi, 0xf
    buffer_load_dwordx4 v[164:167], v1, s[16:19], s12 offen sc1
    s_add_u32 s12, s12, 102400
    s_mov_b32 exec_hi, 0xfffffff
    s_waitcnt vmcnt(25)
    ds_write_b128 v5, v[64:67] offset:0
    s_waitcnt vmcnt(24)
    ds_write_b128 v5, v[68:71] offset:160
    s_waitcnt vmcnt(23)
    ds_write_b128 v5, v[72:75] offset:320
    s_waitcnt vmcnt(22)
    ds_write_b128 v5, v[76:79] offset:480
    s_waitcnt vmcnt(21)
    ds_write_b128 v5, v[80:83] offset:640
    s_waitcnt vmcnt(20)
    ds_write_b128 v5, v[84:87] offset:800
    s_waitcnt vmcnt(19)
    ds_write_b128 v5, v[88:91] offset:960
    s_waitcnt vmcnt(18)
    ds_write_b128 v5, v[92:95] offset:1120
    s_waitcnt vmcnt(17)
    ds_write_b128 v5, v[96:99] offset:1280
    s_waitcnt vmcnt(16)
    ds_write_b128 v5, v[100:103] offset:1440
    s_waitcnt vmcnt(15)
    ds_write_b128 v5, v[104:107] offset:1600
    s_waitcnt vmcnt(14)
    ds_write_b128 v5, v[108:111] offset:1760
    s_waitcnt vmcnt(13)
    ds_write_b128 v5, v[112:115] offset:1920
    s_waitcnt vmcnt(12)
    ds_write_b128 v5, v[116:119] offset:2080
    s_waitcnt vmcnt(11)
    s_waitcnt lgkmcnt(14)
    ds_write_b128 v5, v[120:123] offset:2240
    s_waitcnt vmcnt(10)
    s_waitcnt lgkmcnt(14)
    ds_write_b128 v5, v[124:127] offset:2400
    s_waitcnt vmcnt(9)
    s_waitcnt lgkmcnt(14)
    ds_write_b128 v5, v[128:131] offset:2560
    s_waitcnt vmcnt(8)
    s_waitcnt lgkmcnt(14)
    ds_write_b128 v5, v[132:135] offset:2720
    s_waitcnt vmcnt(7)
    s_waitcnt lgkmcnt(14)
    ds_write_b128 v5, v[136:139] offset:2880
    s_waitcnt vmcnt(6)
    s_waitcnt lgkmcnt(14)
    ds_write_b128 v5, v[140:143] offset:3040
    s_waitcnt vmcnt(5)
    s_waitcnt lgkmcnt(14)
    ds_write_b128 v5, v[144:147] offset:3200
    s_waitcnt vmcnt(4)
    s_waitcnt lgkmcnt(14)
    ds_write_b128 v5, v[148:151] offset:3360
    s_waitcnt vmcnt(3)
    s_waitcnt lgkmcnt(14)
    ds_write_b128 v5, v[152:155] offset:3520
    s_waitcnt vmcnt(2)
    s_waitcnt lgkmcnt(14)
    ds_write_b128 v5, v[156:159] offset:3680
    s_waitcnt vmcnt(1)
    s_waitcnt lgkmcnt(14)
    ds_write_b128 v5, v[160:163] offset:3840
    s_mov_b32 exec_hi, 0xf
    s_waitcnt vmcnt(0)
    s_waitcnt lgkmcnt(14)
    ds_write_b128 v5, v[164:167] offset:4000
    s_mov_b64 exec, -1
L_UGD:
    v_lshlrev_b32 v1, 2, v0
    v_add_u32 v1, 161336, v1
    v_mov_b32 v3, 1
    s_waitcnt lgkmcnt(0)
    s_mov_b64 exec, 0x3f
    ds_add_u32 v1, v3
    s_mov_b64 exec, -1
    s_cmp_eq_u32 s55, 1
    s_cbranch_scc1 L_PF
    s_branch L_G2
L_G2:
    s_add_u32 s20, s66, 6291456
    s_addc_u32 s21, s67, 0
    s_and_b32 s21, s21, 0xffff
    s_mov_b32 s22, 7077888
    s_mov_b32 s23, 0x00020000
    s_add_u32 s24, s66, 3145728
    s_addc_u32 s25, s67, 0
    s_and_b32 s25, s25, 0xffff
    s_mov_b32 s26, 2211840
    s_mov_b32 s27, 0x00020000
    s_mov_b32 s28, s62
    s_and_b32 s29, s63, 0xffff
    s_mov_b32 s30, 2621440
    s_mov_b32 s31, 0x00020000
    s_sub_u32 s40, s3, 4
    v_lshrrev_b32 v3, 4, v0
    v_and_b32 v4, 15, v0
    v_mul_u32_u24 v5, 10240, v3
    v_lshl_add_u32 v5, v4, 4, v5
    v_lshlrev_b32 v6, 4, v0
    s_add_u32 s77, s40, 1
    s_and_b32 s77, s77, 3
    s_lshl_b32 s77, s77, 10
    v_add_u32 v1, s77, v6
    s_add_u32 s77, s40, 2
    s_and_b32 s77, s77, 3
    s_lshl_b32 s77, s77, 10
    v_add_u32 v2, s77, v6
    s_add_u32 s77, s40, 3
    s_and_b32 s77, s77, 3
    s_lshl_b32 s77, s77, 10
    v_add_u32 v3, s77, v6
    s_add_u32 s77, s40, 4
    s_and_b32 s77, s77, 3
    s_lshl_b32 s77, s77, 10
    v_add_u32 v6, s77, v6
    s_mul_i32 s41, s40, 573440
    s_mul_i32 s77, s73, 1280
    s_add_u32 s41, s41, s77
    s_and_b32 s77, s73, 1
    s_mul_i32 s32, s77, 1280
    s_sub_u32 s32, 1024, s32
    s_lshl_b32 s77, s77, 8
    s_add_u32 s41, s41, s77
    s_mul_i32 s42, s40, 1835008
    s_lshl_b32 s77, s72, 12
    s_add_u32 s42, s42, s77
    v_mov_b32 v8, 161280
    s_mov_b32 s83, 200000
SPL44:
    ds_read_b32 v12, v8 offset:32
    s_waitcnt lgkmcnt(0)
    s_nop 0
    v_readfirstlane_b32 s82, v12
    s_sub_u32 s83, s83, 1
    s_cselect_b32 s82, -1, s82
    s_cmp_ge_u32 s82, 1
    s_cbranch_scc1 SPD45
    s_sleep 4
    s_branch SPL44
SPD45:
    s_mov_b32 s54, s82
    s_mul_i32 s45, s73, 2
    s_and_b32 s77, s72, 3
    s_mul_i32 s77, s77, 1
    s_add_u32 s45, s45, s77
    s_mul_hi_u32 s77, s45, 613566757
    s_mul_i32 s77, s77, 7
    s_sub_u32 s45, s45, s77
    s_cmp_eq_u32 s40, 3
    s_cselect_b32 s44, 6, 7
    s_cmp_ge_u32 s45, s44
    s_cselect_b32 s45, 0, s45
    s_waitcnt vmcnt(30)
    s_add_u32 s77, s45, 0
    s_cmp_ge_u32 s77, s44
    s_cselect_b32 s78, s44, 0
    s_sub_u32 s77, s77, s78
    s_lshl1_add_u32 s77, s77, 0
    s_mul_i32 s77, s77, 40960
    s_add_u32 s77, s77, s41
    s_add_u32 s78, s77, s32
    buffer_load_dwordx4 v[16:19], v5, s[24:27], s77 offen offset:0 sc1
    buffer_load_dwordx4 v[20:23], v5, s[24:27], s77 offen offset:256 sc1
    buffer_load_dwordx4 v[24:27], v5, s[24:27], s77 offen offset:512 sc1
    buffer_load_dwordx4 v[28:31], v5, s[24:27], s77 offen offset:768 sc1
    buffer_load_dwordx4 v[32:35], v5, s[24:27], s78 offen sc1
    s_waitcnt vmcnt(7)
    s_add_u32 s77, s45, 1
    s_cmp_ge_u32 s77, s44
    s_cselect_b32 s78, s44, 0
    s_sub_u32 s77, s77, s78
    s_lshl1_add_u32 s77, s77, 0
    s_mul_i32 s77, s77, 40960
    s_add_u32 s77, s77, s41
    s_add_u32 s78, s77, s32
    buffer_load_dwordx4 v[36:39], v5, s[24:27], s77 offen offset:0 sc1
    buffer_load_dwordx4 v[40:43], v5, s[24:27], s77 offen offset:256 sc1
    buffer_load_dwordx4 v[44:47], v5, s[24:27], s77 offen offset:512 sc1
    buffer_load_dwordx4 v[48:51], v5, s[24:27], s77 offen offset:768 sc1
    buffer_load_dwordx4 v[52:55], v5, s[24:27], s78 offen sc1
    s_waitcnt vmcnt(7)
    s_add_u32 s77, s45, 2
    s_cmp_ge_u32 s77, s44
    s_cselect_b32 s78, s44, 0
    s_sub_u32 s77, s77, s78
    s_lshl1_add_u32 s77, s77, 0
    s_mul_i32 s77, s77, 40960
    s_add_u32 s77, s77, s41
    s_add_u32 s78, s77, s32
    buffer_load_dwordx4 v[56:59], v5, s[24:27], s77 offen offset:0 sc1
    buffer_load_dwordx4 v[60:63], v5, s[24:27], s77 offen offset:256 sc1
    buffer_load_dwordx4 v[64:67], v5, s[24:27], s77 offen offset:512 sc1
    buffer_load_dwordx4 v[68:71], v5, s[24:27], s77 offen offset:768 sc1
    buffer_load_dwordx4 v[72:75], v5, s[24:27], s78 offen sc1
    s_waitcnt vmcnt(7)
    s_add_u32 s77, s45, 3
    s_cmp_ge_u32 s77, s44
    s_cselect_b32 s78, s44, 0
    s_sub_u32 s77, s77, s78
    s_lshl1_add_u32 s77, s77, 0
    s_mul_i32 s77, s77, 40960
    s_add_u32 s77, s77, s41
    s_add_u32 s78, s77, s32
    buffer_load_dwordx4 v[76:79], v5, s[24:27], s77 offen offset:0 sc1
    buffer_load_dwordx4 v[80:83], v5, s[24:27], s77 offen offset:256 sc1
    buffer_load_dwordx4 v[84:87], v5, s[24:27], s77 offen offset:512 sc1
    buffer_load_dwordx4 v[88:91], v5, s[24:27], s77 offen offset:768 sc1
    buffer_load_dwordx4 v[92:95], v5, s[24:27], s78 offen sc1
    s_waitcnt vmcnt(7)
    s_add_u32 s77, s45, 4
    s_cmp_ge_u32 s77, s44
    s_cselect_b32 s78, s44, 0
    s_sub_u32 s77, s77, s78
    s_lshl1_add_u32 s77, s77, 0
    s_mul_i32 s77, s77, 40960
    s_add_u32 s77, s77, s41
    s_add_u32 s78, s77, s32
    buffer_load_dwordx4 v[96:99], v5, s[24:27], s77 offen offset:0 sc1
    buffer_load_dwordx4 v[100:103], v5, s[24:27], s77 offen offset:256 sc1
    buffer_load_dwordx4 v[104:107], v5, s[24:27], s77 offen offset:512 sc1
    buffer_load_dwordx4 v[108:111], v5, s[24:27], s77 offen offset:768 sc1
    buffer_load_dwordx4 v[112:115], v5, s[24:27], s78 offen sc1
    s_waitcnt vmcnt(7)
    s_add_u32 s77, s45, 5
    s_cmp_ge_u32 s77, s44
    s_cselect_b32 s78, s44, 0
    s_sub_u32 s77, s77, s78
    s_lshl1_add_u32 s77, s77, 0
    s_mul_i32 s77, s77, 40960
    s_add_u32 s77, s77, s41
    s_add_u32 s78, s77, s32
    buffer_load_dwordx4 v[116:119], v5, s[24:27], s77 offen offset:0 sc1
    buffer_load_dwordx4 v[120:123], v5, s[24:27], s77 offen offset:256 sc1
    buffer_load_dwordx4 v[124:127], v5, s[24:27], s77 offen offset:512 sc1
    buffer_load_dwordx4 v[128:131], v5, s[24:27], s77 offen offset:768 sc1
    buffer_load_dwordx4 v[132:135], v5, s[24:27], s78 offen sc1
    s_waitcnt vmcnt(7)
    v_lshlrev_b32 v10, 4, v4
    s_lshl_b32 s77, s72, 10
    s_lshl_b32 s78, s40, 8
    s_add_u32 s77, s77, s78
    s_add_u32 s39, s77, 16777220
    v_and_b32 v9, 7, v0
    v_min_u32 v9, 6, v9
    v_lshlrev_b32 v9, 7, v9
    v_bfe_u32 v11, v0, 3, 1
    v_lshl_add_u32 v9, v11, 2, v9
    s_mul_i32 s43, s72, 28
    s_mul_i32 s78, s40, 7
    s_add_u32 s43, s43, s78
    s_lshl_b32 s43, s43, 7
    s_add_u32 s43, s43, 16842752
    s_cmp_eq_u32 s55, 1
    s_mov_b32 s49, 5120
    s_cselect_b32 s49, 22528, s49
    s_mov_b32 s37, 20480
    s_cselect_b32 s37, 5120, s37
    s_cselect_b32 s38, 0, 16384
    s_mul_i32 s47, s40, s49
    s_add_u32 s47, s47, s38
    v_lshlrev_b32 v7, 4, v0
    s_add_u32 s36, s47, 81920
    s_cmp_eq_u32 s40, 3
    s_cselect_b32 s36, 0, s36
    s_mul_i32 s77, s40, 5120
    s_add_u32 s77, s77, 90112
    s_cmp_eq_u32 s55, 1
    s_cselect_b32 s36, s77, s36
    v_add_u32 v4, s36, v7
    v_add_u32 v7, s47, v7
    v_add_u32 v15, 61440, v7
    s_add_u32 s77, s40, 3
    s_and_b32 s77, s77, 3
    s_mul_i32 s77, s77, s49
    s_add_u32 s4, s77, s38
    s_add_u32 s77, s40, 2
    s_and_b32 s77, s77, 3
    s_mul_i32 s77, s77, s49
    s_add_u32 s5, s77, s38
    s_mul_i32 s78, s37, 1
    s_add_u32 s5, s5, s78
    s_add_u32 s77, s40, 1
    s_and_b32 s77, s77, 3
    s_mul_i32 s77, s77, s49
    s_add_u32 s6, s77, s38
    s_mul_i32 s78, s37, 2
    s_add_u32 s6, s6, s78
    s_mul_i32 s7, s40, 2560
    s_add_u32 s7, s7, 114688
    s_lshl_b32 s77, s72, 2
    s_add_u32 s77, s77, s40
    s_mul_i32 s8, s77, 20480
    s_mul_i32 s77, s73, 160
    s_add_u32 s8, s8, s77
    s_and_b32 s77, s73, 1
    s_cselect_b32 s78, 0, 128
    s_lshl_b32 s77, s77, 5
    s_add_u32 s9, s8, s78
    s_add_u32 s8, s8, s77
    s_mov_b32 s10, 0xffff0000
    s_getpc_b64 s[50:51]
    v_mov_b32 v14, 0
    s_cmp_eq_u32 s55, 1
    s_cbranch_scc1 L_G2H
    s_cmp_eq_u32 s3, 7
    s_cbranch_scc1 L_G2S
    s_mov_b32 s83, 200000
SPL46:
    ds_read_b128 v[160:163], v8 offset:0
    s_waitcnt lgkmcnt(0)
    v_min_u32 v160, v160, v161
    v_min3_u32 v160, v160, v162, v163
    s_nop 0
    v_readfirstlane_b32 s82, v160
    s_sub_u32 s83, s83, 1
    s_cselect_b32 s82, -1, s82
    s_cmp_ge_u32 s82, 18
    s_cbranch_scc1 SPD47
    s_sleep 2
    s_branch SPL46
SPD47:
    s_cmp_lt_u32 s3, 6
    s_cbranch_scc1 L_XJ0
    s_waitcnt vmcnt(7)
    s_cmp_ge_u32 s45, 1
    s_cselect_b32 s77, 4294967295, 6
    s_add_u32 s77, s77, s45
    s_lshl1_add_u32 s77, s77, 0
    s_mul_i32 s77, s77, 40960
    s_add_u32 s77, s77, s41
    s_add_u32 s78, s77, s32
    s_add_u32 m0, s47, 0
    s_nop 0
    buffer_load_dwordx4 v5, s[24:27], s77 offen offset:0 sc1 lds
    s_add_u32 m0, s47, 768
    s_nop 0
    buffer_load_dwordx4 v5, s[24:27], s77 offen offset:256 sc1 lds
    s_add_u32 m0, s47, 1536
    s_nop 0
    buffer_load_dwordx4 v5, s[24:27], s77 offen offset:512 sc1 lds
    global_load_dword v11, v14, s[50:51]
    s_add_u32 m0, s47, 2304
    s_nop 0
    buffer_load_dwordx4 v5, s[24:27], s77 offen offset:768 sc1 lds
    s_add_u32 m0, s47, 4096
    s_nop 0
    buffer_load_dwordx4 v5, s[24:27], s78 offen sc1 lds
L_XJ0:
    s_waitcnt vmcnt(7)
    s_cmp_ge_u32 s45, 7
    s_cselect_b32 s77, 4294967289, 0
    s_add_u32 s77, s77, s45
    s_lshl1_add_u32 s77, s77, 1
    s_mul_i32 s77, s77, 40960
    s_add_u32 s77, s77, s41
    s_add_u32 s78, s77, s32
    s_add_u32 m0, s47, 20480
    s_nop 0
    buffer_load_dwordx4 v5, s[24:27], s77 offen offset:0 sc1 lds
    global_load_dword v11, v14, s[50:51]
    s_add_u32 m0, s47, 21248
    s_nop 0
    buffer_load_dwordx4 v5, s[24:27], s77 offen offset:256 sc1 lds
    s_add_u32 m0, s47, 22016
    s_nop 0
    buffer_load_dwordx4 v5, s[24:27], s77 offen offset:512 sc1 lds
    s_add_u32 m0, s47, 22784
    s_nop 0
    buffer_load_dwordx4 v5, s[24:27], s77 offen offset:768 sc1 lds
    global_load_dword v11, v14, s[50:51]
    s_add_u32 m0, s47, 24576
    s_nop 0
    buffer_load_dwordx4 v5, s[24:27], s78 offen sc1 lds
    s_waitcnt vmcnt(7)
    s_cmp_ge_u32 s45, 6
    s_cselect_b32 s77, 4294967290, 1
    s_add_u32 s77, s77, s45
    s_lshl1_add_u32 s77, s77, 1
    s_mul_i32 s77, s77, 40960
    s_add_u32 s77, s77, s41
    s_add_u32 s78, s77, s32
    s_add_u32 m0, s47, 40960
    s_nop 0
    buffer_load_dwordx4 v5, s[24:27], s77 offen offset:0 sc1 lds
    s_add_u32 m0, s47, 41728
    s_nop 0
    buffer_load_dwordx4 v5, s[24:27], s77 offen offset:256 sc1 lds
    global_load_dword v11, v14, s[50:51]
    s_add_u32 m0, s47, 42496
    s_nop 0
    buffer_load_dwordx4 v5, s[24:27], s77 offen offset:512 sc1 lds
    s_add_u32 m0, s47, 43264
    s_nop 0
    buffer_load_dwordx4 v5, s[24:27], s77 offen offset:768 sc1 lds
    s_add_u32 m0, s47, 45056
    s_nop 0
    buffer_load_dwordx4 v5, s[24:27], s78 offen sc1 lds
    global_load_dword v11, v14, s[50:51]
    s_mov_b32 s83, 200000
SPL48:
    ds_read_b128 v[160:163], v8 offset:0
    s_waitcnt lgkmcnt(0)
    v_min_u32 v160, v160, v161
    v_min3_u32 v160, v160, v162, v163
    s_nop 0
    v_readfirstlane_b32 s82, v160
    s_sub_u32 s83, s83, 1
    s_cselect_b32 s82, -1, s82
    s_cmp_ge_u32 s82, 19
    s_cbranch_scc1 SPD49
    s_sleep 2
    s_branch SPL48
SPD49:
    s_cmp_lg_u32 s3, 6
    s_cbranch_scc1 L_XJ1
    s_waitcnt vmcnt(7)
    s_cmp_ge_u32 s45, 1
    s_cselect_b32 s77, 4294967295, 6
    s_add_u32 s77, s77, s45
    s_lshl1_add_u32 s77, s77, 0
    s_mul_i32 s77, s77, 40960
    s_add_u32 s77, s77, s41
    s_sub_u32 s77, s77, 1146880
    s_add_u32 s78, s77, s32
    s_add_u32 m0, s47, 4294957056
    s_nop 0
    buffer_load_dwordx4 v5, s[24:27], s77 offen offset:0 sc1 lds
    s_add_u32 m0, s47, 4294957824
    s_nop 0
    buffer_load_dwordx4 v5, s[24:27], s77 offen offset:256 sc1 lds
    s_add_u32 m0, s47, 4294958592
    s_nop 0
    buffer_load_dwordx4 v5, s[24:27], s77 offen offset:512 sc1 lds
    global_load_dword v11, v14, s[50:51]
    s_add_u32 m0, s47, 4294959360
    s_nop 0
    buffer_load_dwordx4 v5, s[24:27], s77 offen offset:768 sc1 lds
    s_add_u32 m0, s47, 4294961152
    s_nop 0
    buffer_load_dwordx4 v5, s[24:27], s78 offen sc1 lds
    s_waitcnt vmcnt(7)
    s_cmp_ge_u32 s45, 1
    s_cselect_b32 s77, 4294967295, 6
    s_add_u32 s77, s77, s45
    s_lshl1_add_u32 s77, s77, 0
    s_mul_i32 s77, s77, 40960
    s_add_u32 s77, s77, s41
    s_sub_u32 s77, s77, 573440
    s_add_u32 s78, s77, s32
    s_add_u32 m0, s47, 4294962176
    s_nop 0
    buffer_load_dwordx4 v5, s[24:27], s77 offen offset:0 sc1 lds
    s_add_u32 m0, s47, 4294962944
    s_nop 0
    buffer_load_dwordx4 v5, s[24:27], s77 offen offset:256 sc1 lds
    s_add_u32 m0, s47, 4294963712
    s_nop 0
    buffer_load_dwordx4 v5, s[24:27], s77 offen offset:512 sc1 lds
    global_load_dword v11, v14, s[50:51]
    s_add_u32 m0, s47, 4294964480
    s_nop 0
    buffer_load_dwordx4 v5, s[24:27], s77 offen offset:768 sc1 lds
    s_add_u32 m0, s47, 4294966272
    s_nop 0
    buffer_load_dwordx4 v5, s[24:27], s78 offen sc1 lds
L_XJ1:
    s_waitcnt vmcnt(7)
    s_cmp_ge_u32 s45, 5
    s_cselect_b32 s77, 4294967291, 2
    s_add_u32 s77, s77, s45
    s_lshl1_add_u32 s77, s77, 1
    s_mul_i32 s77, s77, 40960
    s_add_u32 s77, s77, s41
    s_add_u32 s78, s77, s32
    s_add_u32 m0, s47, 61440
    s_nop 0
    buffer_load_dwordx4 v5, s[24:27], s77 offen offset:0 sc1 lds
    s_add_u32 m0, s47, 62208
    s_nop 0
    buffer_load_dwordx4 v5, s[24:27], s77 offen offset:256 sc1 lds
    s_add_u32 m0, s47, 62976
    s_nop 0
    buffer_load_dwordx4 v5, s[24:27], s77 offen offset:512 sc1 lds
    global_load_dword v11, v14, s[50:51]
    s_add_u32 m0, s47, 63744
    s_nop 0
    buffer_load_dwordx4 v5, s[24:27], s77 offen offset:768 sc1 lds
    s_add_u32 m0, s47, 65536
    s_nop 0
    buffer_load_dwordx4 v5, s[24:27], s78 offen sc1 lds
    s_mov_b32 s83, 200000
SPL50:
    ds_read_b32 v13, v8 offset:108
    s_waitcnt lgkmcnt(0)
    s_nop 0
    v_readfirstlane_b32 s82, v13
    s_sub_u32 s83, s83, 1
    s_cselect_b32 s82, -1, s82
    s_cmp_ge_u32 s82, 4
    s_cbranch_scc1 SPD51
    s_sleep 2
    s_branch SPL50
SPD51:
    s_waitcnt vmcnt(7)
    s_cmp_ge_u32 s45, 4
    s_cselect_b32 s77, 4294967292, 3
    s_add_u32 s77, s77, s45
    s_lshl1_add_u32 s77, s77, 1
    s_mul_i32 s77, s77, 40960
    s_add_u32 s77, s77, s41
    s_add_u32 s78, s77, s32
    s_add_u32 m0, s36, 0
    s_nop 0
    buffer_load_dwordx4 v5, s[24:27], s77 offen offset:0 sc1 lds
    global_load_dword v11, v14, s[50:51]
    s_add_u32 m0, s36, 768
    s_nop 0
    buffer_load_dwordx4 v5, s[24:27], s77 offen offset:256 sc1 lds
    s_add_u32 m0, s36, 1536
    s_nop 0
    buffer_load_dwordx4 v5, s[24:27], s77 offen offset:512 sc1 lds
    s_add_u32 m0, s36, 2304
    s_nop 0
    buffer_load_dwordx4 v5, s[24:27], s77 offen offset:768 sc1 lds
    global_load_dword v11, v14, s[50:51]
    s_add_u32 m0, s36, 4096
    s_nop 0
    buffer_load_dwordx4 v5, s[24:27], s78 offen sc1 lds
    s_mov_b32 s83, 200000
SPL52:
    ds_read_b32 v12, v8 offset:44
    s_waitcnt lgkmcnt(0)
    s_nop 0
    v_readfirstlane_b32 s82, v12
    s_sub_u32 s83, s83, 1
    s_cselect_b32 s82, -1, s82
    s_cmp_ge_u32 s82, 4
    s_cbranch_scc1 SPD53
    s_sleep 4
    s_branch SPL52
SPD53:
    s_mov_b32 s48, 0
    s_cmp_ge_u32 s45, 3
    s_cselect_b32 s77, 4294967293, 4
    s_add_u32 s77, s77, s45
    s_lshl1_add_u32 s77, s77, 1
    s_mul_i32 s77, s77, 40960
    s_add_u32 s11, s77, s41
    s_cmp_ge_u32 s45, 2
    s_cselect_b32 s77, 4294967294, 5
    s_add_u32 s77, s77, s45
    s_lshl1_add_u32 s77, s77, 1
    s_mul_i32 s77, s77, 40960
    s_add_u32 s12, s77, s41
    s_cmp_ge_u32 s45, 1
    s_cselect_b32 s77, 4294967295, 6
    s_add_u32 s77, s77, s45
    s_lshl1_add_u32 s77, s77, 1
    s_mul_i32 s77, s77, 40960
    s_add_u32 s13, s77, s41
    s_cmp_ge_u32 s45, 7
    s_cselect_b32 s77, 4294967289, 0
    s_add_u32 s77, s77, s45
    s_lshl_b32 s78, 1, s77
    s_andn2_b32 s79, s78, s48
    s_cbranch_scc1 FW54
FB55:
    s_lshl1_add_u32 s77, s77, 0
    s_cmp_lg_u32 s3, 6
    s_cbranch_scc1 L_XJ2
    v_mov_b32 v13, 1
    s_mov_b64 exec, 1
    ds_add_u32 v8, v13 offset:112
    s_mov_b64 exec, -1
L_XJ2:
    s_mul_i32 s46, s77, 131072
    s_add_u32 s46, s46, s42
    buffer_load_dwordx4 v[136:139], v1, s[20:23], s46 offen sc1
    buffer_load_dwordx4 v[140:143], v2, s[20:23], s46 offen sc1
    buffer_load_dwordx4 v[144:147], v3, s[20:23], s46 offen sc1
    buffer_load_dwordx4 v[148:151], v6, s[20:23], s46 offen sc1
    s_cmp_ge_u32 s45, 6
    s_cselect_b32 s77, 4294967290, 1
    s_add_u32 s77, s77, s45
    s_lshl_b32 s78, 1, s77
    s_andn2_b32 s79, s78, s48
    s_cbranch_scc1 FW56
FB57:
    s_lshl1_add_u32 s77, s77, 0
    buffer_load_dword v10, v10, s[16:19], s39 offen sc1
    s_mul_i32 s46, s77, 131072
    s_add_u32 s46, s46, s42
    buffer_load_dwordx4 v[152:155], v1, s[20:23], s46 offen sc1
    buffer_load_dwordx4 v[156:159], v2, s[20:23], s46 offen sc1
    buffer_load_dwordx4 v[160:163], v3, s[20:23], s46 offen sc1
    buffer_load_dwordx4 v[164:167], v6, s[20:23], s46 offen sc1
    s_cmp_ge_u32 s45, 5
    s_cselect_b32 s77, 4294967291, 2
    s_add_u32 s77, s77, s45
    s_lshl_b32 s78, 1, s77
    s_andn2_b32 s79, s78, s48
    s_cbranch_scc1 FW58
FB59:
    s_lshl1_add_u32 s77, s77, 0
    s_mul_i32 s46, s77, 131072
    s_add_u32 s46, s46, s42
    buffer_load_dwordx4 v[168:171], v1, s[20:23], s46 offen sc1
    buffer_load_dwordx4 v[172:175], v2, s[20:23], s46 offen sc1
    s_waitcnt vmcnt(10)
    v_mfma_f32_16x16x32_bf16 v[176:179], v[16:19], v[136:139], 0
    v_mfma_f32_16x16x32_bf16 v[180:183], v[20:23], v[136:139], 0
    v_mfma_f32_16x16x32_bf16 v[184:187], v[24:27], v[136:139], 0
    v_mfma_f32_16x16x32_bf16 v[188:191], v[28:31], v[136:139], 0
    v_mfma_f32_16x16x32_bf16 v[192:195], v[32:35], v[136:139], 0
    s_waitcnt vmcnt(9)
    v_mfma_f32_16x16x32_bf16 v[196:199], v[16:19], v[140:143], 0
    buffer_load_dwordx4 v[136:139], v3, s[20:23], s46 offen sc1
    v_mfma_f32_16x16x32_bf16 v[200:203], v[20:23], v[140:143], 0
    v_mfma_f32_16x16x32_bf16 v[204:207], v[24:27], v[140:143], 0
    v_mfma_f32_16x16x32_bf16 v[208:211], v[28:31], v[140:143], 0
    v_mfma_f32_16x16x32_bf16 v[212:215], v[32:35], v[140:143], 0
    s_waitcnt vmcnt(9)
    v_mfma_f32_16x16x32_bf16 v[216:219], v[16:19], v[144:147], 0
    buffer_load_dwordx4 v[140:143], v6, s[20:23], s46 offen sc1
    v_mfma_f32_16x16x32_bf16 v[220:223], v[20:23], v[144:147], 0
    v_mfma_f32_16x16x32_bf16 v[224:227], v[24:27], v[144:147], 0
    v_mfma_f32_16x16x32_bf16 v[228:231], v[28:31], v[144:147], 0
    v_mfma_f32_16x16x32_bf16 v[232:235], v[32:35], v[144:147], 0
    s_waitcnt vmcnt(9)
    v_mfma_f32_16x16x32_bf16 v[236:239], v[16:19], v[148:151], 0
    buffer_load_dwordx4 v[144:147], v5, s[24:27], s11 offen offset:0 sc1
    v_mfma_f32_16x16x32_bf16 v[240:243], v[20:23], v[148:151], 0
    v_mfma_f32_16x16x32_bf16 v[244:247], v[24:27], v[148:151], 0
    v_mfma_f32_16x16x32_bf16 v[248:251], v[28:31], v[148:151], 0
    v_mfma_f32_16x16x32_bf16 v[252:255], v[32:35], v[148:151], 0
    s_waitcnt vmcnt(8)
    v_mfma_f32_16x16x32_bf16 v[176:179], v[36:39], v[152:155], v[176:179]
    s_cmp_ge_u32 s45, 4
    s_cselect_b32 s77, 4294967292, 3
    s_add_u32 s77, s77, s45
    s_lshl_b32 s78, 1, s77
    s_andn2_b32 s79, s78, s48
    s_cbranch_scc1 FW60
FB61:
    s_lshl1_add_u32 s77, s77, 0
    s_mul_i32 s46, s77, 131072
    s_add_u32 s46, s46, s42
    v_mfma_f32_16x16x32_bf16 v[180:183], v[40:43], v[152:155], v[180:183]
    buffer_load_dwordx4 v[16:19], v1, s[20:23], s46 offen sc1
    v_mfma_f32_16x16x32_bf16 v[184:187], v[44:47], v[152:155], v[184:187]
    buffer_load_dwordx4 v[20:23], v2, s[20:23], s46 offen sc1
    v_mfma_f32_16x16x32_bf16 v[188:191], v[48:51], v[152:155], v[188:191]
    buffer_load_dwordx4 v[24:27], v5, s[24:27], s11 offen offset:256 sc1
    v_mfma_f32_16x16x32_bf16 v[192:195], v[52:55], v[152:155], v[192:195]
    s_waitcnt vmcnt(10)
    v_mfma_f32_16x16x32_bf16 v[196:199], v[36:39], v[156:159], v[196:199]
    buffer_load_dwordx4 v[28:31], v3, s[20:23], s46 offen sc1
    v_mfma_f32_16x16x32_bf16 v[200:203], v[40:43], v[156:159], v[200:203]
    buffer_load_dwordx4 v[32:35], v6, s[20:23], s46 offen sc1
    v_mfma_f32_16x16x32_bf16 v[204:207], v[44:47], v[156:159], v[204:207]
    buffer_load_dwordx4 v[148:151], v5, s[24:27], s11 offen offset:512 sc1
    v_mfma_f32_16x16x32_bf16 v[208:211], v[48:51], v[156:159], v[208:211]
    s_cmp_ge_u32 s45, 3
    s_cselect_b32 s77, 4294967293, 4
    s_add_u32 s77, s77, s45
    s_lshl_b32 s78, 1, s77
    s_andn2_b32 s79, s78, s48
    s_cbranch_scc1 FW62
FB63:
    s_lshl1_add_u32 s77, s77, 0
    s_mul_i32 s46, s77, 131072
    s_add_u32 s46, s46, s42
    v_mfma_f32_16x16x32_bf16 v[212:215], v[52:55], v[156:159], v[212:215]
    s_waitcnt vmcnt(12)
    v_mfma_f32_16x16x32_bf16 v[216:219], v[36:39], v[160:163], v[216:219]
    buffer_load_dwordx4 v[152:155], v1, s[20:23], s46 offen sc1
    v_mfma_f32_16x16x32_bf16 v[220:223], v[40:43], v[160:163], v[220:223]
    buffer_load_dwordx4 v[156:159], v2, s[20:23], s46 offen sc1
    v_mfma_f32_16x16x32_bf16 v[224:227], v[44:47], v[160:163], v[224:227]
    v_mfma_f32_16x16x32_bf16 v[228:231], v[48:51], v[160:163], v[228:231]
    v_mfma_f32_16x16x32_bf16 v[232:235], v[52:55], v[160:163], v[232:235]
    s_waitcnt vmcnt(13)
    v_mfma_f32_16x16x32_bf16 v[236:239], v[36:39], v[164:167], v[236:239]
    buffer_load_dwordx4 v[160:163], v5, s[24:27], s11 offen offset:768 sc1
    v_mfma_f32_16x16x32_bf16 v[240:243], v[40:43], v[164:167], v[240:243]
    v_mfma_f32_16x16x32_bf16 v[244:247], v[44:47], v[164:167], v[244:247]
    v_mfma_f32_16x16x32_bf16 v[248:251], v[48:51], v[164:167], v[248:251]
    v_mfma_f32_16x16x32_bf16 v[252:255], v[52:55], v[164:167], v[252:255]
    s_waitcnt vmcnt(13)
    v_mfma_f32_16x16x32_bf16 v[176:179], v[56:59], v[168:171], v[176:179]
    buffer_load_dwordx4 v[36:39], v3, s[20:23], s46 offen sc1
    v_mfma_f32_16x16x32_bf16 v[180:183], v[60:63], v[168:171], v[180:183]
    buffer_load_dwordx4 v[40:43], v6, s[20:23], s46 offen sc1
    v_mfma_f32_16x16x32_bf16 v[184:187], v[64:67], v[168:171], v[184:187]
    v_mfma_f32_16x16x32_bf16 v[188:191], v[68:71], v[168:171], v[188:191]
    v_mfma_f32_16x16x32_bf16 v[192:195], v[72:75], v[168:171], v[192:195]
    s_waitcnt vmcnt(14)
    v_mfma_f32_16x16x32_bf16 v[196:199], v[56:59], v[172:175], v[196:199]
    s_add_u32 s78, s11, s32
    buffer_load_dwordx4 v[44:47], v5, s[24:27], s78 offen sc1
    v_mfma_f32_16x16x32_bf16 v[200:203], v[60:63], v[172:175], v[200:203]
    s_cmp_ge_u32 s45, 2
    s_cselect_b32 s77, 4294967294, 5
    s_add_u32 s77, s77, s45
    s_lshl_b32 s78, 1, s77
    s_andn2_b32 s79, s78, s48
    s_cbranch_scc1 FW64
FB65:
    s_lshl1_add_u32 s77, s77, 0
    s_mul_i32 s46, s77, 131072
    s_add_u32 s46, s46, s42
    v_mfma_f32_16x16x32_bf16 v[204:207], v[64:67], v[172:175], v[204:207]
    buffer_load_dwordx4 v[48:51], v1, s[20:23], s46 offen sc1
    v_mfma_f32_16x16x32_bf16 v[208:211], v[68:71], v[172:175], v[208:211]
    v_mfma_f32_16x16x32_bf16 v[212:215], v[72:75], v[172:175], v[212:215]
    s_waitcnt vmcnt(15)
    v_mfma_f32_16x16x32_bf16 v[216:219], v[56:59], v[136:139], v[216:219]
    buffer_load_dwordx4 v[52:55], v2, s[20:23], s46 offen sc1
    v_mfma_f32_16x16x32_bf16 v[220:223], v[60:63], v[136:139], v[220:223]
    v_mfma_f32_16x16x32_bf16 v[224:227], v[64:67], v[136:139], v[224:227]
    v_mfma_f32_16x16x32_bf16 v[228:231], v[68:71], v[136:139], v[228:231]
    v_mfma_f32_16x16x32_bf16 v[232:235], v[72:75], v[136:139], v[232:235]
    ds_read_b32 v14, v8 offset:112
    s_waitcnt vmcnt(15)
    v_mfma_f32_16x16x32_bf16 v[236:239], v[56:59], v[140:143], v[236:239]
    buffer_load_dwordx4 v[164:167], v5, s[24:27], s12 offen offset:0 sc1
    v_mfma_f32_16x16x32_bf16 v[240:243], v[60:63], v[140:143], v[240:243]
    buffer_load_dwordx4 v[168:171], v3, s[20:23], s46 offen sc1
    v_mfma_f32_16x16x32_bf16 v[244:247], v[64:67], v[140:143], v[244:247]
    v_mfma_f32_16x16x32_bf16 v[248:251], v[68:71], v[140:143], v[248:251]
    v_mfma_f32_16x16x32_bf16 v[252:255], v[72:75], v[140:143], v[252:255]
    s_waitcnt vmcnt(15)
    v_mfma_f32_16x16x32_bf16 v[176:179], v[76:79], v[16:19], v[176:179]
    buffer_load_dwordx4 v[56:59], v6, s[20:23], s46 offen sc1
    v_mfma_f32_16x16x32_bf16 v[180:183], v[80:83], v[16:19], v[180:183]
    v_mfma_f32_16x16x32_bf16 v[184:187], v[84:87], v[16:19], v[184:187]
    v_mfma_f32_16x16x32_bf16 v[188:191], v[88:91], v[16:19], v[188:191]
    v_mfma_f32_16x16x32_bf16 v[192:195], v[92:95], v[16:19], v[192:195]
    s_waitcnt vmcnt(15)
    v_mfma_f32_16x16x32_bf16 v[196:199], v[76:79], v[20:23], v[196:199]
    buffer_load_dwordx4 v[60:63], v5, s[24:27], s12 offen offset:256 sc1
    v_mfma_f32_16x16x32_bf16 v[200:203], v[80:83], v[20:23], v[200:203]
    s_cmp_ge_u32 s45, 1
    s_cselect_b32 s77, 4294967295, 6
    s_add_u32 s77, s77, s45
    s_lshl_b32 s78, 1, s77
    s_andn2_b32 s79, s78, s48
    s_cbranch_scc1 FW66
FB67:
    s_lshl1_add_u32 s77, s77, 0
    s_mul_i32 s46, s77, 131072
    s_add_u32 s46, s46, s42
    v_mfma_f32_16x16x32_bf16 v[204:207], v[84:87], v[20:23], v[204:207]
    buffer_load_dwordx4 v[64:67], v1, s[20:23], s46 offen sc1
    v_mfma_f32_16x16x32_bf16 v[208:211], v[88:91], v[20:23], v[208:211]
    v_mfma_f32_16x16x32_bf16 v[212:215], v[92:95], v[20:23], v[212:215]
    s_waitcnt vmcnt(15)
    v_mfma_f32_16x16x32_bf16 v[216:219], v[76:79], v[28:31], v[216:219]
    buffer_load_dwordx4 v[68:71], v2, s[20:23], s46 offen sc1
    v_mfma_f32_16x16x32_bf16 v[220:223], v[80:83], v[28:31], v[220:223]
    v_mfma_f32_16x16x32_bf16 v[224:227], v[84:87], v[28:31], v[224:227]
    v_mfma_f32_16x16x32_bf16 v[228:231], v[88:91], v[28:31], v[228:231]
    v_mfma_f32_16x16x32_bf16 v[232:235], v[92:95], v[28:31], v[232:235]
    s_waitcnt vmcnt(15)
    v_mfma_f32_16x16x32_bf16 v[236:239], v[76:79], v[32:35], v[236:239]
    buffer_load_dwordx4 v[72:75], v5, s[24:27], s12 offen offset:512 sc1
    v_mfma_f32_16x16x32_bf16 v[240:243], v[80:83], v[32:35], v[240:243]
    buffer_load_dwordx4 v[172:175], v3, s[20:23], s46 offen sc1
    v_mfma_f32_16x16x32_bf16 v[244:247], v[84:87], v[32:35], v[244:247]
    v_mfma_f32_16x16x32_bf16 v[248:251], v[88:91], v[32:35], v[248:251]
    v_mfma_f32_16x16x32_bf16 v[252:255], v[92:95], v[32:35], v[252:255]
    s_waitcnt vmcnt(15)
    v_mfma_f32_16x16x32_bf16 v[176:179], v[96:99], v[152:155], v[176:179]
    buffer_load_dwordx4 v[76:79], v6, s[20:23], s46 offen sc1
    v_mfma_f32_16x16x32_bf16 v[180:183], v[100:103], v[152:155], v[180:183]
    v_mfma_f32_16x16x32_bf16 v[184:187], v[104:107], v[152:155], v[184:187]
    v_mfma_f32_16x16x32_bf16 v[188:191], v[108:111], v[152:155], v[188:191]
    v_mfma_f32_16x16x32_bf16 v[192:195], v[112:115], v[152:155], v[192:195]
    s_waitcnt vmcnt(15)
    v_mfma_f32_16x16x32_bf16 v[196:199], v[96:99], v[156:159], v[196:199]
    buffer_load_dwordx4 v[80:83], v5, s[24:27], s12 offen offset:768 sc1
    v_mfma_f32_16x16x32_bf16 v[200:203], v[100:103], v[156:159], v[200:203]
    s_cmp_ge_u32 s45, 7
    s_cselect_b32 s77, 4294967289, 0
    s_add_u32 s77, s77, s45
    s_lshl_b32 s78, 256, s77
    s_andn2_b32 s79, s78, s48
    s_cbranch_scc1 FW68
FB69:
    s_lshl1_add_u32 s77, s77, 1
    s_mul_i32 s46, s77, 131072
    s_add_u32 s46, s46, s42
    v_mfma_f32_16x16x32_bf16 v[204:207], v[104:107], v[156:159], v[204:207]
    buffer_load_dwordx4 v[84:87], v1, s[20:23], s46 offen sc1
    v_mfma_f32_16x16x32_bf16 v[208:211], v[108:111], v[156:159], v[208:211]
    v_mfma_f32_16x16x32_bf16 v[212:215], v[112:115], v[156:159], v[212:215]
    s_waitcnt vmcnt(15)
    v_mfma_f32_16x16x32_bf16 v[216:219], v[96:99], v[36:39], v[216:219]
    buffer_load_dwordx4 v[88:91], v2, s[20:23], s46 offen sc1
    v_mfma_f32_16x16x32_bf16 v[220:223], v[100:103], v[36:39], v[220:223]
    v_mfma_f32_16x16x32_bf16 v[224:227], v[104:107], v[36:39], v[224:227]
    v_mfma_f32_16x16x32_bf16 v[228:231], v[108:111], v[36:39], v[228:231]
    v_mfma_f32_16x16x32_bf16 v[232:235], v[112:115], v[36:39], v[232:235]
    s_waitcnt vmcnt(15)
    v_mfma_f32_16x16x32_bf16 v[236:239], v[96:99], v[40:43], v[236:239]
    s_add_u32 s78, s12, s32
    buffer_load_dwordx4 v[92:95], v5, s[24:27], s78 offen sc1
    v_mfma_f32_16x16x32_bf16 v[240:243], v[100:103], v[40:43], v[240:243]
    buffer_load_dwordx4 v[136:139], v3, s[20:23], s46 offen sc1
    v_mfma_f32_16x16x32_bf16 v[244:247], v[104:107], v[40:43], v[244:247]
    v_mfma_f32_16x16x32_bf16 v[248:251], v[108:111], v[40:43], v[248:251]
    v_mfma_f32_16x16x32_bf16 v[252:255], v[112:115], v[40:43], v[252:255]
    s_waitcnt vmcnt(15)
    v_mfma_f32_16x16x32_bf16 v[176:179], v[116:119], v[48:51], v[176:179]
    s_waitcnt lgkmcnt(0)
    v_cmp_eq_u32 vcc, 0, v14
    s_cbranch_vccnz L_XJS
L_XJB:
    v_mfma_f32_16x16x32_bf16 v[180:183], v[120:123], v[48:51], v[180:183]
    ds_read_b128 v[96:99], v7 offset:0
    v_mfma_f32_16x16x32_bf16 v[184:187], v[124:127], v[48:51], v[184:187]
    ds_read_b128 v[100:103], v7 offset:1024
    v_mfma_f32_16x16x32_bf16 v[188:191], v[128:131], v[48:51], v[188:191]
    ds_read_b128 v[104:107], v7 offset:2048
    v_mfma_f32_16x16x32_bf16 v[192:195], v[132:135], v[48:51], v[192:195]
    s_waitcnt vmcnt(14)
    v_mfma_f32_16x16x32_bf16 v[196:199], v[116:119], v[52:55], v[196:199]
    ds_read_b128 v[108:111], v7 offset:3072
    v_mfma_f32_16x16x32_bf16 v[200:203], v[120:123], v[52:55], v[200:203]
    ds_read_b128 v[112:115], v7 offset:4096
    v_mfma_f32_16x16x32_bf16 v[204:207], v[124:127], v[52:55], v[204:207]
    buffer_load_dwordx4 v[140:143], v6, s[20:23], s46 offen sc1
    v_mfma_f32_16x16x32_bf16 v[208:211], v[128:131], v[52:55], v[208:211]
    v_mov_b32 v13, 1
    s_mov_b64 exec, 1
    ds_add_u32 v8, v13 offset:24
    s_mov_b64 exec, -1
    v_mfma_f32_16x16x32_bf16 v[212:215], v[132:135], v[52:55], v[212:215]
    s_waitcnt vmcnt(13)
    v_mfma_f32_16x16x32_bf16 v[216:219], v[116:119], v[168:171], v[216:219]
    buffer_load_dwordx4 v[16:19], v5, s[24:27], s13 offen offset:0 sc1
    v_mfma_f32_16x16x32_bf16 v[220:223], v[120:123], v[168:171], v[220:223]
    s_cmp_ge_u32 s45, 6
    s_cselect_b32 s77, 4294967290, 1
    s_add_u32 s77, s77, s45
    s_lshl_b32 s78, 256, s77
    s_andn2_b32 s79, s78, s48
    s_cbranch_scc1 FW70
FB71:
    s_lshl1_add_u32 s77, s77, 1
    s_mul_i32 s46, s77, 131072
    s_add_u32 s46, s46, s42
    v_mfma_f32_16x16x32_bf16 v[224:227], v[124:127], v[168:171], v[224:227]
    buffer_load_dwordx4 v[20:23], v1, s[20:23], s46 offen sc1
    v_mfma_f32_16x16x32_bf16 v[228:231], v[128:131], v[168:171], v[228:231]
    buffer_load_dwordx4 v[28:31], v2, s[20:23], s46 offen sc1
    v_mfma_f32_16x16x32_bf16 v[232:235], v[132:135], v[168:171], v[232:235]
    s_waitcnt vmcnt(15)
    v_mfma_f32_16x16x32_bf16 v[236:239], v[116:119], v[56:59], v[236:239]
    buffer_load_dwordx4 v[32:35], v5, s[24:27], s13 offen offset:256 sc1
    v_mfma_f32_16x16x32_bf16 v[240:243], v[120:123], v[56:59], v[240:243]
    buffer_load_dwordx4 v[152:155], v3, s[20:23], s46 offen sc1
    v_mfma_f32_16x16x32_bf16 v[244:247], v[124:127], v[56:59], v[244:247]
    v_mfma_f32_16x16x32_bf16 v[248:251], v[128:131], v[56:59], v[248:251]
    v_mfma_f32_16x16x32_bf16 v[252:255], v[132:135], v[56:59], v[252:255]
    s_waitcnt lgkmcnt(1)
    s_waitcnt vmcnt(15)
    v_mfma_f32_16x16x32_bf16 v[176:179], v[96:99], v[64:67], v[176:179]
    v_mfma_f32_16x16x32_bf16 v[180:183], v[100:103], v[64:67], v[180:183]
    ds_read_b128 v[116:119], v7 offset:20480
    v_mfma_f32_16x16x32_bf16 v[184:187], v[104:107], v[64:67], v[184:187]
    ds_read_b128 v[120:123], v7 offset:21504
    v_mfma_f32_16x16x32_bf16 v[188:191], v[108:111], v[64:67], v[188:191]
    ds_read_b128 v[124:127], v7 offset:22528
    v_mfma_f32_16x16x32_bf16 v[192:195], v[112:115], v[64:67], v[192:195]
    s_waitcnt vmcnt(14)
    v_mfma_f32_16x16x32_bf16 v[196:199], v[96:99], v[68:71], v[196:199]
    ds_read_b128 v[128:131], v7 offset:23552
    v_mfma_f32_16x16x32_bf16 v[200:203], v[100:103], v[68:71], v[200:203]
    ds_read_b128 v[132:135], v7 offset:24576
    v_mfma_f32_16x16x32_bf16 v[204:207], v[104:107], v[68:71], v[204:207]
    buffer_load_dwordx4 v[156:159], v6, s[20:23], s46 offen sc1
    v_mfma_f32_16x16x32_bf16 v[208:211], v[108:111], v[68:71], v[208:211]
    buffer_load_dwordx4 v[36:39], v5, s[24:27], s13 offen offset:512 sc1
    v_mfma_f32_16x16x32_bf16 v[212:215], v[112:115], v[68:71], v[212:215]
    s_waitcnt vmcnt(14)
    v_mfma_f32_16x16x32_bf16 v[216:219], v[96:99], v[172:175], v[216:219]
    s_cmp_ge_u32 s45, 5
    s_cselect_b32 s77, 4294967291, 2
    s_add_u32 s77, s77, s45
    s_lshl_b32 s78, 256, s77
    s_andn2_b32 s79, s78, s48
    s_cbranch_scc1 FW72
FB73:
    s_lshl1_add_u32 s77, s77, 1
    s_mul_i32 s46, s77, 131072
    s_add_u32 s46, s46, s42
    v_mfma_f32_16x16x32_bf16 v[220:223], v[100:103], v[172:175], v[220:223]
    buffer_load_dwordx4 v[40:43], v1, s[20:23], s46 offen sc1
    v_mfma_f32_16x16x32_bf16 v[224:227], v[104:107], v[172:175], v[224:227]
    buffer_load_dwordx4 v[48:51], v2, s[20:23], s46 offen sc1
    v_mfma_f32_16x16x32_bf16 v[228:231], v[108:111], v[172:175], v[228:231]
    v_mfma_f32_16x16x32_bf16 v[232:235], v[112:115], v[172:175], v[232:235]
    s_waitcnt vmcnt(15)
    v_mfma_f32_16x16x32_bf16 v[236:239], v[96:99], v[76:79], v[236:239]
    buffer_load_dwordx4 v[52:55], v5, s[24:27], s13 offen offset:768 sc1
    v_mfma_f32_16x16x32_bf16 v[240:243], v[100:103], v[76:79], v[240:243]
    buffer_load_dwordx4 v[168:171], v3, s[20:23], s46 offen sc1
    v_mfma_f32_16x16x32_bf16 v[244:247], v[104:107], v[76:79], v[244:247]
    v_mfma_f32_16x16x32_bf16 v[248:251], v[108:111], v[76:79], v[248:251]
    v_mfma_f32_16x16x32_bf16 v[252:255], v[112:115], v[76:79], v[252:255]
    s_waitcnt lgkmcnt(0)
    s_waitcnt vmcnt(15)
    v_mfma_f32_16x16x32_bf16 v[176:179], v[116:119], v[84:87], v[176:179]
    v_mfma_f32_16x16x32_bf16 v[180:183], v[120:123], v[84:87], v[180:183]
    ds_read_b128 v[96:99], v7 offset:40960
    v_mfma_f32_16x16x32_bf16 v[184:187], v[124:127], v[84:87], v[184:187]
    ds_read_b128 v[100:103], v7 offset:41984
    v_mfma_f32_16x16x32_bf16 v[188:191], v[128:131], v[84:87], v[188:191]
    ds_read_b128 v[104:107], v7 offset:43008
    v_mfma_f32_16x16x32_bf16 v[192:195], v[132:135], v[84:87], v[192:195]
    s_waitcnt vmcnt(14)
    v_mfma_f32_16x16x32_bf16 v[196:199], v[116:119], v[88:91], v[196:199]
    ds_read_b128 v[108:111], v7 offset:44032
    v_mfma_f32_16x16x32_bf16 v[200:203], v[120:123], v[88:91], v[200:203]
    ds_read_b128 v[112:115], v7 offset:45056
    v_mfma_f32_16x16x32_bf16 v[204:207], v[124:127], v[88:91], v[204:207]
    buffer_load_dwordx4 v[56:59], v6, s[20:23], s46 offen sc1
    v_mfma_f32_16x16x32_bf16 v[208:211], v[128:131], v[88:91], v[208:211]
    s_add_u32 s78, s13, s32
    buffer_load_dwordx4 v[64:67], v5, s[24:27], s78 offen sc1
    v_mfma_f32_16x16x32_bf16 v[212:215], v[132:135], v[88:91], v[212:215]
    s_waitcnt vmcnt(14)
    v_mfma_f32_16x16x32_bf16 v[216:219], v[116:119], v[136:139], v[216:219]
    s_cmp_ge_u32 s45, 4
    s_cselect_b32 s77, 4294967292, 3
    s_add_u32 s77, s77, s45
    s_lshl_b32 s78, 256, s77
    s_andn2_b32 s79, s78, s48
    s_cbranch_scc1 FW74
FB75:
    s_lshl1_add_u32 s77, s77, 1
    s_mul_i32 s46, s77, 131072
    s_add_u32 s46, s46, s42
    v_mfma_f32_16x16x32_bf16 v[220:223], v[120:123], v[136:139], v[220:223]
    buffer_load_dwordx4 v[68:71], v1, s[20:23], s46 offen sc1
    v_mfma_f32_16x16x32_bf16 v[224:227], v[124:127], v[136:139], v[224:227]
    buffer_load_dwordx4 v[172:175], v2, s[20:23], s46 offen sc1
    v_mfma_f32_16x16x32_bf16 v[228:231], v[128:131], v[136:139], v[228:231]
    v_mfma_f32_16x16x32_bf16 v[232:235], v[132:135], v[136:139], v[232:235]
    s_waitcnt vmcnt(15)
    v_mfma_f32_16x16x32_bf16 v[236:239], v[116:119], v[140:143], v[236:239]
    buffer_load_dwordx4 v[76:79], v3, s[20:23], s46 offen sc1
    v_mfma_f32_16x16x32_bf16 v[240:243], v[120:123], v[140:143], v[240:243]
    v_mfma_f32_16x16x32_bf16 v[244:247], v[124:127], v[140:143], v[244:247]
    v_mfma_f32_16x16x32_bf16 v[248:251], v[128:131], v[140:143], v[248:251]
    v_mfma_f32_16x16x32_bf16 v[252:255], v[132:135], v[140:143], v[252:255]
    s_waitcnt lgkmcnt(0)
    s_waitcnt vmcnt(14)
    v_mfma_f32_16x16x32_bf16 v[176:179], v[96:99], v[20:23], v[176:179]
    v_mfma_f32_16x16x32_bf16 v[180:183], v[100:103], v[20:23], v[180:183]
    ds_read_b128 v[116:119], v15 offset:0
    v_mfma_f32_16x16x32_bf16 v[184:187], v[104:107], v[20:23], v[184:187]
    ds_read_b128 v[120:123], v15 offset:1024
    v_mfma_f32_16x16x32_bf16 v[188:191], v[108:111], v[20:23], v[188:191]
    ds_read_b128 v[124:127], v15 offset:2048
    v_mfma_f32_16x16x32_bf16 v[192:195], v[112:115], v[20:23], v[192:195]
    s_waitcnt vmcnt(13)
    v_mfma_f32_16x16x32_bf16 v[196:199], v[96:99], v[28:31], v[196:199]
    ds_read_b128 v[128:131], v15 offset:3072
    v_mfma_f32_16x16x32_bf16 v[200:203], v[100:103], v[28:31], v[200:203]
    ds_read_b128 v[132:135], v15 offset:4096
    v_mfma_f32_16x16x32_bf16 v[204:207], v[104:107], v[28:31], v[204:207]
    buffer_load_dwordx4 v[84:87], v6, s[20:23], s46 offen sc1
    v_mfma_f32_16x16x32_bf16 v[208:211], v[108:111], v[28:31], v[208:211]
    v_mov_b32 v13, 1
    s_mov_b64 exec, 1
    ds_add_u32 v8, v13 offset:28
    s_mov_b64 exec, -1
    v_mfma_f32_16x16x32_bf16 v[212:215], v[112:115], v[28:31], v[212:215]
    s_waitcnt vmcnt(12)
    v_mfma_f32_16x16x32_bf16 v[216:219], v[96:99], v[152:155], v[216:219]
    s_cmp_ge_u32 s45, 3
    s_cselect_b32 s77, 4294967293, 4
    s_add_u32 s77, s77, s45
    s_lshl_b32 s78, 256, s77
    s_andn2_b32 s79, s78, s48
    s_cbranch_scc1 FW76
FB77:
    s_lshl1_add_u32 s77, s77, 1
    s_mul_i32 s46, s77, 131072
    s_add_u32 s46, s46, s42
    v_mfma_f32_16x16x32_bf16 v[220:223], v[100:103], v[152:155], v[220:223]
    buffer_load_dwordx4 v[88:91], v1, s[20:23], s46 offen sc1
    v_mfma_f32_16x16x32_bf16 v[224:227], v[104:107], v[152:155], v[224:227]
    s_cmp_ge_u32 s45, 2
    s_cselect_b32 s77, 4294967294, 5
    s_add_u32 s77, s77, s45
    s_lshl_b32 s78, 256, s77
    s_andn2_b32 s79, s78, s48
    s_cbranch_scc1 FW78
FB79:
    s_lshl1_add_u32 s77, s77, 1
    s_mul_i32 s34, s77, 131072
    s_add_u32 s34, s34, s42
    v_mfma_f32_16x16x32_bf16 v[228:231], v[108:111], v[152:155], v[228:231]
    buffer_load_dwordx4 v[136:139], v1, s[20:23], s34 offen sc1
    v_mfma_f32_16x16x32_bf16 v[232:235], v[112:115], v[152:155], v[232:235]
    s_waitcnt vmcnt(13)
    v_mfma_f32_16x16x32_bf16 v[236:239], v[96:99], v[156:159], v[236:239]
    s_cmp_ge_u32 s45, 1
    s_cselect_b32 s77, 4294967295, 6
    s_add_u32 s77, s77, s45
    s_lshl_b32 s78, 256, s77
    s_andn2_b32 s79, s78, s48
    s_cbranch_scc1 FW80
FB81:
    s_lshl1_add_u32 s77, s77, 1
    s_mul_i32 s35, s77, 131072
    s_add_u32 s35, s35, s42
    v_mfma_f32_16x16x32_bf16 v[240:243], v[100:103], v[156:159], v[240:243]
    buffer_load_dwordx4 v[140:143], v1, s[20:23], s35 offen sc1
    v_mfma_f32_16x16x32_bf16 v[244:247], v[104:107], v[156:159], v[244:247]
    v_mfma_f32_16x16x32_bf16 v[248:251], v[108:111], v[156:159], v[248:251]
    v_mfma_f32_16x16x32_bf16 v[252:255], v[112:115], v[156:159], v[252:255]
    s_waitcnt lgkmcnt(1)
    s_waitcnt vmcnt(12)
    v_mfma_f32_16x16x32_bf16 v[176:179], v[116:119], v[40:43], v[176:179]
    v_mfma_f32_16x16x32_bf16 v[180:183], v[120:123], v[40:43], v[180:183]
    ds_read_b128 v[96:99], v4 offset:0
    v_mfma_f32_16x16x32_bf16 v[184:187], v[124:127], v[40:43], v[184:187]
    ds_read_b128 v[100:103], v4 offset:1024
    v_mfma_f32_16x16x32_bf16 v[188:191], v[128:131], v[40:43], v[188:191]
    ds_read_b128 v[104:107], v4 offset:2048
    v_mfma_f32_16x16x32_bf16 v[192:195], v[132:135], v[40:43], v[192:195]
    s_waitcnt vmcnt(11)
    v_mfma_f32_16x16x32_bf16 v[196:199], v[116:119], v[48:51], v[196:199]
    ds_read_b128 v[108:111], v4 offset:3072
    v_mfma_f32_16x16x32_bf16 v[200:203], v[120:123], v[48:51], v[200:203]
    ds_read_b128 v[112:115], v4 offset:4096
    v_mfma_f32_16x16x32_bf16 v[204:207], v[124:127], v[48:51], v[204:207]
    buffer_load_dwordx4 v[20:23], v2, s[20:23], s46 offen sc1
    v_mfma_f32_16x16x32_bf16 v[208:211], v[128:131], v[48:51], v[208:211]
    buffer_load_dwordx4 v[28:31], v2, s[20:23], s34 offen sc1
    v_mfma_f32_16x16x32_bf16 v[212:215], v[132:135], v[48:51], v[212:215]
    s_waitcnt vmcnt(11)
    v_mfma_f32_16x16x32_bf16 v[216:219], v[116:119], v[168:171], v[216:219]
    buffer_load_dwordx4 v[152:155], v2, s[20:23], s35 offen sc1
    v_mfma_f32_16x16x32_bf16 v[220:223], v[120:123], v[168:171], v[220:223]
    v_mfma_f32_16x16x32_bf16 v[224:227], v[124:127], v[168:171], v[224:227]
    v_mfma_f32_16x16x32_bf16 v[228:231], v[128:131], v[168:171], v[228:231]
    v_mfma_f32_16x16x32_bf16 v[232:235], v[132:135], v[168:171], v[232:235]
    s_waitcnt vmcnt(11)
    v_mfma_f32_16x16x32_bf16 v[236:239], v[116:119], v[56:59], v[236:239]
    buffer_load_dwordx4 v[156:159], v3, s[20:23], s46 offen sc1
    v_mfma_f32_16x16x32_bf16 v[240:243], v[120:123], v[56:59], v[240:243]
    v_mfma_f32_16x16x32_bf16 v[244:247], v[124:127], v[56:59], v[244:247]
    v_mfma_f32_16x16x32_bf16 v[248:251], v[128:131], v[56:59], v[248:251]
    v_mfma_f32_16x16x32_bf16 v[252:255], v[132:135], v[56:59], v[252:255]
    s_waitcnt lgkmcnt(0)
    s_waitcnt vmcnt(10)
    v_mfma_f32_16x16x32_bf16 v[176:179], v[96:99], v[68:71], v[176:179]
    buffer_load_dwordx4 v[116:119], v3, s[20:23], s34 offen sc1
    v_mfma_f32_16x16x32_bf16 v[180:183], v[100:103], v[68:71], v[180:183]
    v_mfma_f32_16x16x32_bf16 v[184:187], v[104:107], v[68:71], v[184:187]
    v_mfma_f32_16x16x32_bf16 v[188:191], v[108:111], v[68:71], v[188:191]
    v_mfma_f32_16x16x32_bf16 v[192:195], v[112:115], v[68:71], v[192:195]
    s_waitcnt vmcnt(10)
    v_mfma_f32_16x16x32_bf16 v[196:199], v[96:99], v[172:175], v[196:199]
    buffer_load_dwordx4 v[120:123], v3, s[20:23], s35 offen sc1
    v_mfma_f32_16x16x32_bf16 v[200:203], v[100:103], v[172:175], v[200:203]
    v_mfma_f32_16x16x32_bf16 v[204:207], v[104:107], v[172:175], v[204:207]
    v_mfma_f32_16x16x32_bf16 v[208:211], v[108:111], v[172:175], v[208:211]
    v_mfma_f32_16x16x32_bf16 v[212:215], v[112:115], v[172:175], v[212:215]
    s_waitcnt vmcnt(10)
    v_mfma_f32_16x16x32_bf16 v[216:219], v[96:99], v[76:79], v[216:219]
    buffer_load_dwordx4 v[124:127], v6, s[20:23], s46 offen sc1
    v_mfma_f32_16x16x32_bf16 v[220:223], v[100:103], v[76:79], v[220:223]
    v_mfma_f32_16x16x32_bf16 v[224:227], v[104:107], v[76:79], v[224:227]
    v_mfma_f32_16x16x32_bf16 v[228:231], v[108:111], v[76:79], v[228:231]
    v_mfma_f32_16x16x32_bf16 v[232:235], v[112:115], v[76:79], v[232:235]
    s_waitcnt vmcnt(10)
    v_mfma_f32_16x16x32_bf16 v[236:239], v[96:99], v[84:87], v[236:239]
    buffer_load_dwordx4 v[128:131], v6, s[20:23], s34 offen sc1
    v_mfma_f32_16x16x32_bf16 v[240:243], v[100:103], v[84:87], v[240:243]
    v_mfma_f32_16x16x32_bf16 v[244:247], v[104:107], v[84:87], v[244:247]
    v_mfma_f32_16x16x32_bf16 v[248:251], v[108:111], v[84:87], v[248:251]
    v_mfma_f32_16x16x32_bf16 v[252:255], v[112:115], v[84:87], v[252:255]
    s_waitcnt vmcnt(10)
    v_mfma_f32_16x16x32_bf16 v[176:179], v[144:147], v[88:91], v[176:179]
    buffer_load_dwordx4 v[96:99], v6, s[20:23], s35 offen sc1
    v_mfma_f32_16x16x32_bf16 v[180:183], v[24:27], v[88:91], v[180:183]
    v_mfma_f32_16x16x32_bf16 v[184:187], v[148:151], v[88:91], v[184:187]
    v_mfma_f32_16x16x32_bf16 v[188:191], v[160:163], v[88:91], v[188:191]
    v_mfma_f32_16x16x32_bf16 v[192:195], v[44:47], v[88:91], v[192:195]
    s_waitcnt vmcnt(10)
    v_mfma_f32_16x16x32_bf16 v[176:179], v[164:167], v[136:139], v[176:179]
    v_mfma_f32_16x16x32_bf16 v[180:183], v[60:63], v[136:139], v[180:183]
    v_mfma_f32_16x16x32_bf16 v[184:187], v[72:75], v[136:139], v[184:187]
    v_mfma_f32_16x16x32_bf16 v[188:191], v[80:83], v[136:139], v[188:191]
    v_mfma_f32_16x16x32_bf16 v[192:195], v[92:95], v[136:139], v[192:195]
    s_waitcnt vmcnt(9)
    v_mfma_f32_16x16x32_bf16 v[176:179], v[16:19], v[140:143], v[176:179]
    v_mfma_f32_16x16x32_bf16 v[180:183], v[32:35], v[140:143], v[180:183]
    v_mfma_f32_16x16x32_bf16 v[184:187], v[36:39], v[140:143], v[184:187]
    v_mfma_f32_16x16x32_bf16 v[188:191], v[52:55], v[140:143], v[188:191]
    v_mfma_f32_16x16x32_bf16 v[192:195], v[64:67], v[140:143], v[192:195]
    s_waitcnt vmcnt(8)
    v_mfma_f32_16x16x32_bf16 v[196:199], v[144:147], v[20:23], v[196:199]
    v_mfma_f32_16x16x32_bf16 v[200:203], v[24:27], v[20:23], v[200:203]
    v_mfma_f32_16x16x32_bf16 v[204:207], v[148:151], v[20:23], v[204:207]
    v_mfma_f32_16x16x32_bf16 v[208:211], v[160:163], v[20:23], v[208:211]
    v_mfma_f32_16x16x32_bf16 v[212:215], v[44:47], v[20:23], v[212:215]
    s_waitcnt vmcnt(7)
    v_mfma_f32_16x16x32_bf16 v[196:199], v[164:167], v[28:31], v[196:199]
    ds_write_b128 v7, v[176:179] offset:0
    v_mfma_f32_16x16x32_bf16 v[200:203], v[60:63], v[28:31], v[200:203]
    ds_write_b128 v7, v[180:183] offset:1024
    v_mfma_f32_16x16x32_bf16 v[204:207], v[72:75], v[28:31], v[204:207]
    v_mfma_f32_16x16x32_bf16 v[208:211], v[80:83], v[28:31], v[208:211]
    v_mfma_f32_16x16x32_bf16 v[212:215], v[92:95], v[28:31], v[212:215]
    s_waitcnt vmcnt(6)
    v_mfma_f32_16x16x32_bf16 v[196:199], v[16:19], v[152:155], v[196:199]
    ds_write_b128 v7, v[184:187] offset:2048
    v_mfma_f32_16x16x32_bf16 v[200:203], v[32:35], v[152:155], v[200:203]
    ds_write_b128 v7, v[188:191] offset:3072
    v_mfma_f32_16x16x32_bf16 v[204:207], v[36:39], v[152:155], v[204:207]
    v_mfma_f32_16x16x32_bf16 v[208:211], v[52:55], v[152:155], v[208:211]
    v_mfma_f32_16x16x32_bf16 v[212:215], v[64:67], v[152:155], v[212:215]
    s_waitcnt vmcnt(5)
    v_mfma_f32_16x16x32_bf16 v[216:219], v[144:147], v[156:159], v[216:219]
    ds_write_b128 v7, v[192:195] offset:4096
    v_mfma_f32_16x16x32_bf16 v[220:223], v[24:27], v[156:159], v[220:223]
    v_mfma_f32_16x16x32_bf16 v[224:227], v[148:151], v[156:159], v[224:227]
    v_mfma_f32_16x16x32_bf16 v[228:231], v[160:163], v[156:159], v[228:231]
    v_mfma_f32_16x16x32_bf16 v[232:235], v[44:47], v[156:159], v[232:235]
    s_waitcnt vmcnt(4)
    v_mfma_f32_16x16x32_bf16 v[216:219], v[164:167], v[116:119], v[216:219]
    ds_write_b128 v7, v[196:199] offset:20480
    v_mfma_f32_16x16x32_bf16 v[220:223], v[60:63], v[116:119], v[220:223]
    ds_write_b128 v7, v[200:203] offset:21504
    v_mfma_f32_16x16x32_bf16 v[224:227], v[72:75], v[116:119], v[224:227]
    v_mfma_f32_16x16x32_bf16 v[228:231], v[80:83], v[116:119], v[228:231]
    v_mfma_f32_16x16x32_bf16 v[232:235], v[92:95], v[116:119], v[232:235]
    ds_write_b128 v7, v[204:207] offset:22528
    ds_write_b128 v7, v[208:211] offset:23552
    s_waitcnt vmcnt(3)
    v_mfma_f32_16x16x32_bf16 v[216:219], v[16:19], v[120:123], v[216:219]
    v_mbcnt_lo_u32_b32 v9, -1, 0
    v_mbcnt_hi_u32_b32 v9, -1, v9
    v_lshlrev_b32 v3, 4, v9
    v_add_u32 v1, s4, v3
    v_mfma_f32_16x16x32_bf16 v[220:223], v[32:35], v[120:123], v[220:223]
    v_add_u32 v2, s5, v3
    v_add_u32 v3, s6, v3
    v_lshlrev_b32 v5, 3, v9
    v_add_u32 v5, s7, v5
    v_mfma_f32_16x16x32_bf16 v[224:227], v[36:39], v[120:123], v[224:227]
    v_and_b32 v6, 15, v9
    v_mul_u32_u24 v6, 1280, v6
    v_lshrrev_b32 v9, 4, v9
    v_lshl_add_u32 v4, v9, 4, v6
    v_mfma_f32_16x16x32_bf16 v[228:231], v[52:55], v[120:123], v[228:231]
    v_lshl_add_u32 v6, v9, 3, v6
    v_mul_f32 v10, v10, v10
    v_mov_b32 v13, 1
    v_mov_b32 v11, v10
    v_mfma_f32_16x16x32_bf16 v[232:235], v[64:67], v[120:123], v[232:235]
    ds_write_b128 v7, v[212:215] offset:24576
    s_waitcnt vmcnt(2)
    v_mfma_f32_16x16x32_bf16 v[236:239], v[144:147], v[124:127], v[236:239]
    ds_write_b128 v7, v[216:219] offset:40960
    v_mfma_f32_16x16x32_bf16 v[240:243], v[24:27], v[124:127], v[240:243]
    ds_write_b128 v7, v[220:223] offset:41984
    v_mfma_f32_16x16x32_bf16 v[244:247], v[148:151], v[124:127], v[244:247]
    ds_write_b128 v7, v[224:227] offset:43008
    v_mfma_f32_16x16x32_bf16 v[248:251], v[160:163], v[124:127], v[248:251]
    ds_write_b128 v7, v[228:231] offset:44032
    v_mfma_f32_16x16x32_bf16 v[252:255], v[44:47], v[124:127], v[252:255]
    ds_write_b128 v7, v[232:235] offset:45056
    s_mov_b64 exec, 1
    s_waitcnt lgkmcnt(14)
    ds_add_rtn_u32 v12, v8, v13 offset:88
    s_mov_b64 exec, -1
    s_waitcnt vmcnt(1)
    v_mfma_f32_16x16x32_bf16 v[236:239], v[164:167], v[128:131], v[236:239]
    s_waitcnt lgkmcnt(14)
    ds_read_b128 v[144:147], v1 offset:0
    s_waitcnt lgkmcnt(14)
    ds_read_b128 v[24:27], v2 offset:0
    s_waitcnt lgkmcnt(14)
    ds_read_b128 v[148:151], v3 offset:0
    v_mfma_f32_16x16x32_bf16 v[240:243], v[60:63], v[128:131], v[240:243]
    s_waitcnt lgkmcnt(14)
    ds_read_b128 v[160:163], v1 offset:1024
    s_waitcnt lgkmcnt(14)
    ds_read_b128 v[44:47], v2 offset:1024
    s_waitcnt lgkmcnt(14)
    ds_read_b128 v[100:103], v3 offset:1024
    v_mfma_f32_16x16x32_bf16 v[244:247], v[72:75], v[128:131], v[244:247]
    s_waitcnt lgkmcnt(14)
    ds_read_b128 v[104:107], v1 offset:2048
    s_waitcnt lgkmcnt(14)
    ds_read_b128 v[108:111], v2 offset:2048
    s_waitcnt lgkmcnt(14)
    ds_read_b128 v[112:115], v3 offset:2048
    v_mfma_f32_16x16x32_bf16 v[248:251], v[80:83], v[128:131], v[248:251]
    s_waitcnt lgkmcnt(14)
    ds_read_b128 v[132:135], v1 offset:3072
    s_waitcnt lgkmcnt(14)
    ds_read_b128 v[40:43], v2 offset:3072
    s_waitcnt lgkmcnt(14)
    ds_read_b128 v[48:51], v3 offset:3072
    v_mfma_f32_16x16x32_bf16 v[252:255], v[92:95], v[128:131], v[252:255]
    s_waitcnt lgkmcnt(14)
    ds_read_b128 v[168:171], v1 offset:4096
    s_waitcnt lgkmcnt(14)
    ds_read_b128 v[56:59], v2 offset:4096
    s_waitcnt lgkmcnt(14)
    ds_read_b128 v[68:71], v3 offset:4096
    s_waitcnt vmcnt(0)
    v_mfma_f32_16x16x32_bf16 v[236:239], v[16:19], v[96:99], v[236:239]
    s_waitcnt lgkmcnt(14)
    ds_read_b32 v14, v8 offset:92
    s_waitcnt lgkmcnt(14)
    ds_read_b64 v[172:173], v5 offset:0
    v_mfma_f32_16x16x32_bf16 v[240:243], v[32:35], v[96:99], v[240:243]
    s_waitcnt lgkmcnt(14)
    ds_read_b64 v[174:175], v5 offset:512
    s_waitcnt lgkmcnt(14)
    ds_read_b64 v[76:77], v5 offset:1024
    v_mfma_f32_16x16x32_bf16 v[244:247], v[36:39], v[96:99], v[244:247]
    s_waitcnt lgkmcnt(14)
    ds_read_b64 v[78:79], v5 offset:1536
    s_waitcnt lgkmcnt(14)
    ds_read_b64 v[84:85], v5 offset:2048
    v_mfma_f32_16x16x32_bf16 v[248:251], v[52:55], v[96:99], v[248:251]
    v_mfma_f32_16x16x32_bf16 v[252:255], v[64:67], v[96:99], v[252:255]
    v_readfirstlane_b32 s77, v12
    s_cmp_lt_u32 s77, 3
    s_cbranch_scc1 RS82
RB83:
    v_pk_add_f32 v[24:25], v[24:25], v[148:149]
    v_pk_add_f32 v[26:27], v[26:27], v[150:151]
    v_pk_add_f32 v[144:145], v[144:145], v[24:25]
    v_pk_add_f32 v[146:147], v[146:147], v[26:27]
    v_pk_add_f32 v[44:45], v[44:45], v[100:101]
    v_pk_add_f32 v[46:47], v[46:47], v[102:103]
    v_pk_add_f32 v[160:161], v[160:161], v[44:45]
    v_pk_add_f32 v[162:163], v[162:163], v[46:47]
    s_waitcnt lgkmcnt(12)
    v_pk_add_f32 v[108:109], v[108:109], v[112:113]
    v_pk_add_f32 v[110:111], v[110:111], v[114:115]
    v_pk_add_f32 v[104:105], v[104:105], v[108:109]
    v_pk_add_f32 v[106:107], v[106:107], v[110:111]
    s_waitcnt lgkmcnt(9)
    v_pk_add_f32 v[40:41], v[40:41], v[48:49]
    v_pk_add_f32 v[42:43], v[42:43], v[50:51]
    v_pk_add_f32 v[132:133], v[132:133], v[40:41]
    v_pk_add_f32 v[134:135], v[134:135], v[42:43]
    s_waitcnt lgkmcnt(6)
    v_pk_add_f32 v[56:57], v[56:57], v[68:69]
    v_pk_add_f32 v[58:59], v[58:59], v[70:71]
    v_pk_add_f32 v[168:169], v[168:169], v[56:57]
    v_pk_add_f32 v[170:171], v[170:171], v[58:59]
    s_nop 0
    v_pk_add_f32 v[236:237], v[236:237], v[144:145]
    v_pk_add_f32 v[238:239], v[238:239], v[146:147]
    v_pk_mul_f32 v[236:237], v[236:237], v[10:11]
    v_pk_mul_f32 v[238:239], v[238:239], v[10:11]
    v_cvt_pk_bf16_f32 v236, v236, v237
    v_cvt_pk_bf16_f32 v238, v238, v239
    v_pk_add_f32 v[240:241], v[240:241], v[160:161]
    v_pk_add_f32 v[242:243], v[242:243], v[162:163]
    v_pk_mul_f32 v[240:241], v[240:241], v[10:11]
    v_pk_mul_f32 v[242:243], v[242:243], v[10:11]
    v_cvt_pk_bf16_f32 v240, v240, v241
    v_cvt_pk_bf16_f32 v242, v242, v243
    v_pk_add_f32 v[244:245], v[244:245], v[104:105]
    v_pk_add_f32 v[246:247], v[246:247], v[106:107]
    v_pk_mul_f32 v[244:245], v[244:245], v[10:11]
    v_pk_mul_f32 v[246:247], v[246:247], v[10:11]
    v_cvt_pk_bf16_f32 v244, v244, v245
    v_cvt_pk_bf16_f32 v246, v246, v247
    v_pk_add_f32 v[248:249], v[248:249], v[132:133]
    v_pk_add_f32 v[250:251], v[250:251], v[134:135]
    v_pk_mul_f32 v[248:249], v[248:249], v[10:11]
    v_pk_mul_f32 v[250:251], v[250:251], v[10:11]
    v_cvt_pk_bf16_f32 v248, v248, v249
    v_cvt_pk_bf16_f32 v250, v250, v251
    v_pk_add_f32 v[252:253], v[252:253], v[168:169]
    v_pk_add_f32 v[254:255], v[254:255], v[170:171]
    v_pk_mul_f32 v[252:253], v[252:253], v[10:11]
    v_pk_mul_f32 v[254:255], v[254:255], v[10:11]
    v_cvt_pk_bf16_f32 v252, v252, v253
    v_cvt_pk_bf16_f32 v254, v254, v255
    s_waitcnt lgkmcnt(0)
    v_cmp_gt_u32 vcc, 4, v14
    s_cbranch_vccnz TS84
TB85:
    v_and_b32 v145, s10, v236
    v_lshlrev_b32 v144, 16, v236
    v_and_b32 v25, s10, v172
    v_lshlrev_b32 v24, 16, v172
    v_and_b32 v147, s10, v238
    v_lshlrev_b32 v146, 16, v238
    v_and_b32 v27, s10, v173
    v_lshlrev_b32 v26, 16, v173
    v_pk_add_f32 v[144:145], v[144:145], v[24:25]
    v_pk_add_f32 v[146:147], v[146:147], v[26:27]
    v_cvt_pk_bf16_f32 v236, v144, v145
    v_cvt_pk_bf16_f32 v237, v146, v147
    v_and_b32 v161, s10, v240
    v_lshlrev_b32 v160, 16, v240
    v_and_b32 v45, s10, v174
    v_lshlrev_b32 v44, 16, v174
    v_and_b32 v163, s10, v242
    v_lshlrev_b32 v162, 16, v242
    v_and_b32 v47, s10, v175
    v_lshlrev_b32 v46, 16, v175
    v_pk_add_f32 v[160:161], v[160:161], v[44:45]
    v_pk_add_f32 v[162:163], v[162:163], v[46:47]
    v_cvt_pk_bf16_f32 v238, v160, v161
    v_cvt_pk_bf16_f32 v239, v162, v163
    buffer_store_dwordx4 v[236:239], v4, s[28:31], s8 offen offset:0 sc1
    v_and_b32 v105, s10, v244
    v_lshlrev_b32 v104, 16, v244
    v_and_b32 v109, s10, v76
    v_lshlrev_b32 v108, 16, v76
    v_and_b32 v107, s10, v246
    v_lshlrev_b32 v106, 16, v246
    v_and_b32 v111, s10, v77
    v_lshlrev_b32 v110, 16, v77
    v_pk_add_f32 v[104:105], v[104:105], v[108:109]
    v_pk_add_f32 v[106:107], v[106:107], v[110:111]
    v_cvt_pk_bf16_f32 v244, v104, v105
    v_cvt_pk_bf16_f32 v245, v106, v107
    v_and_b32 v133, s10, v248
    v_lshlrev_b32 v132, 16, v248
    v_and_b32 v41, s10, v78
    v_lshlrev_b32 v40, 16, v78
    v_and_b32 v135, s10, v250
    v_lshlrev_b32 v134, 16, v250
    v_and_b32 v43, s10, v79
    v_lshlrev_b32 v42, 16, v79
    v_pk_add_f32 v[132:133], v[132:133], v[40:41]
    v_pk_add_f32 v[134:135], v[134:135], v[42:43]
    v_cvt_pk_bf16_f32 v246, v132, v133
    v_cvt_pk_bf16_f32 v247, v134, v135
    buffer_store_dwordx4 v[244:247], v4, s[28:31], s8 offen offset:64 sc1
    v_and_b32 v169, s10, v252
    v_lshlrev_b32 v168, 16, v252
    v_and_b32 v57, s10, v84
    v_lshlrev_b32 v56, 16, v84
    v_and_b32 v171, s10, v254
    v_lshlrev_b32 v170, 16, v254
    v_and_b32 v59, s10, v85
    v_lshlrev_b32 v58, 16, v85
    v_pk_add_f32 v[168:169], v[168:169], v[56:57]
    v_pk_add_f32 v[170:171], v[170:171], v[58:59]
    v_cvt_pk_bf16_f32 v252, v168, v169
    v_cvt_pk_bf16_f32 v253, v170, v171
    buffer_store_dwordx2 v[252:253], v6, s[28:31], s9 offen sc1
    s_endpgm
RS82:
    s_mov_b32 s83, 200000
SPL86:
    ds_read_b32 v12, v8 offset:88
    s_waitcnt lgkmcnt(0)
    s_nop 0
    v_readfirstlane_b32 s82, v12
    s_sub_u32 s83, s83, 1
    s_cselect_b32 s82, -1, s82
    s_cmp_ge_u32 s82, 4
    s_cbranch_scc1 SPD87
    s_branch SPL86
SPD87:
    ds_read_b128 v[144:147], v1 offset:0
    ds_read_b128 v[24:27], v2 offset:0
    ds_read_b128 v[148:151], v3 offset:0
    ds_read_b128 v[160:163], v1 offset:1024
    ds_read_b128 v[44:47], v2 offset:1024
    ds_read_b128 v[100:103], v3 offset:1024
    ds_read_b128 v[104:107], v1 offset:2048
    ds_read_b128 v[108:111], v2 offset:2048
    ds_read_b128 v[112:115], v3 offset:2048
    ds_read_b128 v[132:135], v1 offset:3072
    ds_read_b128 v[40:43], v2 offset:3072
    ds_read_b128 v[48:51], v3 offset:3072
    ds_read_b128 v[168:171], v1 offset:4096
    ds_read_b128 v[56:59], v2 offset:4096
    ds_read_b128 v[68:71], v3 offset:4096
    s_waitcnt lgkmcnt(14)
    ds_read_b32 v14, v8 offset:92
    s_waitcnt lgkmcnt(0)
    ds_read_b64 v[172:173], v5 offset:0
    ds_read_b64 v[174:175], v5 offset:512
    ds_read_b64 v[76:77], v5 offset:1024
    ds_read_b64 v[78:79], v5 offset:1536
    ds_read_b64 v[84:85], v5 offset:2048
    s_branch RB83
TS84:
    s_mov_b32 s83, 200000
SPL88:
    ds_read_b32 v14, v8 offset:92
    s_waitcnt lgkmcnt(0)
    s_nop 0
    v_readfirstlane_b32 s82, v14
    s_sub_u32 s83, s83, 1
    s_cselect_b32 s82, -1, s82
    s_cmp_ge_u32 s82, 4
    s_cbranch_scc1 SPD89
    s_branch SPL88
SPD89:
    ds_read_b64 v[172:173], v5 offset:0
    ds_read_b64 v[174:175], v5 offset:512
    ds_read_b64 v[76:77], v5 offset:1024
    ds_read_b64 v[78:79], v5 offset:1536
    ds_read_b64 v[84:85], v5 offset:2048
    s_waitcnt lgkmcnt(0)
    s_branch TB85
L_G2S:
    s_mov_b32 s83, 200000
SPL90:
    ds_read_b128 v[160:163], v8 offset:0
    s_waitcnt lgkmcnt(0)
    v_min_u32 v160, v160, v161
    v_min3_u32 v160, v160, v162, v163
    s_nop 0
    v_readfirstlane_b32 s82, v160
    s_sub_u32 s83, s83, 1
    s_cselect_b32 s82, -1, s82
    s_cmp_ge_u32 s82, 18
    s_cbranch_scc1 SPD91
    s_sleep 2
    s_branch SPL90
SPD91:
    s_cmp_ge_u32 s45, 6
    s_cselect_b32 s77, 4294967290, 0
    s_add_u32 s77, s77, s45
    s_lshl1_add_u32 s77, s77, 1
    s_mul_i32 s77, s77, 40960
    s_add_u32 s77, s77, s41
    s_add_u32 s78, s77, s32
    s_add_u32 m0, s47, 0
    s_nop 0
    buffer_load_dwordx4 v5, s[24:27], s77 offen offset:0 sc1 lds
    s_add_u32 m0, s47, 768
    s_nop 0
    buffer_load_dwordx4 v5, s[24:27], s77 offen offset:256 sc1 lds
    s_add_u32 m0, s47, 1536
    s_nop 0
    buffer_load_dwordx4 v5, s[24:27], s77 offen offset:512 sc1 lds
    global_load_dword v11, v14, s[50:51]
    s_add_u32 m0, s47, 2304
    s_nop 0
    buffer_load_dwordx4 v5, s[24:27], s77 offen offset:768 sc1 lds
    s_add_u32 m0, s47, 4096
    s_nop 0
    buffer_load_dwordx4 v5, s[24:27], s78 offen sc1 lds
    s_waitcnt vmcnt(7)
    s_cmp_ge_u32 s45, 5
    s_cselect_b32 s77, 4294967291, 1
    s_add_u32 s77, s77, s45
    s_lshl1_add_u32 s77, s77, 1
    s_mul_i32 s77, s77, 40960
    s_add_u32 s77, s77, s41
    s_add_u32 s78, s77, s32
    s_add_u32 m0, s47, 20480
    s_nop 0
    buffer_load_dwordx4 v5, s[24:27], s77 offen offset:0 sc1 lds
    global_load_dword v11, v14, s[50:51]
    s_add_u32 m0, s47, 21248
    s_nop 0
    buffer_load_dwordx4 v5, s[24:27], s77 offen offset:256 sc1 lds
    s_add_u32 m0, s47, 22016
    s_nop 0
    buffer_load_dwordx4 v5, s[24:27], s77 offen offset:512 sc1 lds
    s_add_u32 m0, s47, 22784
    s_nop 0
    buffer_load_dwordx4 v5, s[24:27], s77 offen offset:768 sc1 lds
    global_load_dword v11, v14, s[50:51]
    s_add_u32 m0, s47, 24576
    s_nop 0
    buffer_load_dwordx4 v5, s[24:27], s78 offen sc1 lds
    s_waitcnt vmcnt(7)
    s_cmp_ge_u32 s45, 4
    s_cselect_b32 s77, 4294967292, 2
    s_add_u32 s77, s77, s45
    s_lshl1_add_u32 s77, s77, 1
    s_mul_i32 s77, s77, 40960
    s_add_u32 s77, s77, s41
    s_add_u32 s78, s77, s32
    s_add_u32 m0, s47, 40960
    s_nop 0
    buffer_load_dwordx4 v5, s[24:27], s77 offen offset:0 sc1 lds
    s_add_u32 m0, s47, 41728
    s_nop 0
    buffer_load_dwordx4 v5, s[24:27], s77 offen offset:256 sc1 lds
    global_load_dword v11, v14, s[50:51]
    s_add_u32 m0, s47, 42496
    s_nop 0
    buffer_load_dwordx4 v5, s[24:27], s77 offen offset:512 sc1 lds
    s_add_u32 m0, s47, 43264
    s_nop 0
    buffer_load_dwordx4 v5, s[24:27], s77 offen offset:768 sc1 lds
    s_add_u32 m0, s47, 45056
    s_nop 0
    buffer_load_dwordx4 v5, s[24:27], s78 offen sc1 lds
    global_load_dword v11, v14, s[50:51]
    s_mov_b32 s83, 200000
SPL92:
    ds_read_b128 v[160:163], v8 offset:0
    s_waitcnt lgkmcnt(0)
    v_min_u32 v160, v160, v161
    v_min3_u32 v160, v160, v162, v163
    s_nop 0
    v_readfirstlane_b32 s82, v160
    s_sub_u32 s83, s83, 1
    s_cselect_b32 s82, -1, s82
    s_cmp_ge_u32 s82, 19
    s_cbranch_scc1 SPD93
    s_sleep 2
    s_branch SPL92
SPD93:
    s_waitcnt vmcnt(7)
    s_cmp_ge_u32 s45, 3
    s_cselect_b32 s77, 4294967293, 3
    s_add_u32 s77, s77, s45
    s_lshl1_add_u32 s77, s77, 1
    s_mul_i32 s77, s77, 40960
    s_add_u32 s77, s77, s41
    s_add_u32 s78, s77, s32
    s_add_u32 m0, s47, 61440
    s_nop 0
    buffer_load_dwordx4 v5, s[24:27], s77 offen offset:0 sc1 lds
    s_add_u32 m0, s47, 62208
    s_nop 0
    buffer_load_dwordx4 v5, s[24:27], s77 offen offset:256 sc1 lds
    s_add_u32 m0, s47, 62976
    s_nop 0
    buffer_load_dwordx4 v5, s[24:27], s77 offen offset:512 sc1 lds
    global_load_dword v11, v14, s[50:51]
    s_add_u32 m0, s47, 63744
    s_nop 0
    buffer_load_dwordx4 v5, s[24:27], s77 offen offset:768 sc1 lds
    s_add_u32 m0, s47, 65536
    s_nop 0
    buffer_load_dwordx4 v5, s[24:27], s78 offen sc1 lds
    s_mov_b32 s83, 200000
SPL94:
    ds_read_b32 v13, v8 offset:108
    s_waitcnt lgkmcnt(0)
    s_nop 0
    v_readfirstlane_b32 s82, v13
    s_sub_u32 s83, s83, 1
    s_cselect_b32 s82, -1, s82
    s_cmp_ge_u32 s82, 4
    s_cbranch_scc1 SPD95
    s_sleep 2
    s_branch SPL94
SPD95:
    s_waitcnt vmcnt(7)
    s_cmp_ge_u32 s45, 2
    s_cselect_b32 s77, 4294967294, 4
    s_add_u32 s77, s77, s45
    s_lshl1_add_u32 s77, s77, 1
    s_mul_i32 s77, s77, 40960
    s_add_u32 s77, s77, s41
    s_add_u32 s78, s77, s32
    s_add_u32 m0, s36, 0
    s_nop 0
    buffer_load_dwordx4 v5, s[24:27], s77 offen offset:0 sc1 lds
    global_load_dword v11, v14, s[50:51]
    s_add_u32 m0, s36, 768
    s_nop 0
    buffer_load_dwordx4 v5, s[24:27], s77 offen offset:256 sc1 lds
    s_add_u32 m0, s36, 1536
    s_nop 0
    buffer_load_dwordx4 v5, s[24:27], s77 offen offset:512 sc1 lds
    s_add_u32 m0, s36, 2304
    s_nop 0
    buffer_load_dwordx4 v5, s[24:27], s77 offen offset:768 sc1 lds
    global_load_dword v11, v14, s[50:51]
    s_add_u32 m0, s36, 4096
    s_nop 0
    buffer_load_dwordx4 v5, s[24:27], s78 offen sc1 lds
    s_mov_b32 s83, 200000
SPL96:
    ds_read_b32 v12, v8 offset:44
    s_waitcnt lgkmcnt(0)
    s_nop 0
    v_readfirstlane_b32 s82, v12
    s_sub_u32 s83, s83, 1
    s_cselect_b32 s82, -1, s82
    s_cmp_ge_u32 s82, 4
    s_cbranch_scc1 SPD97
    s_sleep 4
    s_branch SPL96
SPD97:
    s_mov_b32 s48, 0
    s_cmp_ge_u32 s45, 1
    s_cselect_b32 s77, 4294967295, 5
    s_add_u32 s77, s77, s45
    s_lshl1_add_u32 s77, s77, 1
    s_mul_i32 s77, s77, 40960
    s_add_u32 s11, s77, s41
    s_cmp_ge_u32 s45, 6
    s_cselect_b32 s77, 4294967290, 0
    s_add_u32 s77, s77, s45
    s_lshl_b32 s78, 1, s77
    s_andn2_b32 s79, s78, s48
    s_cbranch_scc1 FW98
FB99:
    s_lshl1_add_u32 s77, s77, 0
    s_mul_i32 s46, s77, 131072
    s_add_u32 s46, s46, s42
    buffer_load_dwordx4 v[136:139], v1, s[20:23], s46 offen sc1
    buffer_load_dwordx4 v[140:143], v2, s[20:23], s46 offen sc1
    buffer_load_dwordx4 v[144:147], v3, s[20:23], s46 offen sc1
    buffer_load_dwordx4 v[148:151], v6, s[20:23], s46 offen sc1
    s_cmp_ge_u32 s45, 5
    s_cselect_b32 s77, 4294967291, 1
    s_add_u32 s77, s77, s45
    s_lshl_b32 s78, 1, s77
    s_andn2_b32 s79, s78, s48
    s_cbranch_scc1 FW100
FB101:
    s_lshl1_add_u32 s77, s77, 0
    buffer_load_dword v10, v10, s[16:19], s39 offen sc1
    s_mul_i32 s46, s77, 131072
    s_add_u32 s46, s46, s42
    buffer_load_dwordx4 v[152:155], v1, s[20:23], s46 offen sc1
    buffer_load_dwordx4 v[156:159], v2, s[20:23], s46 offen sc1
    buffer_load_dwordx4 v[160:163], v3, s[20:23], s46 offen sc1
    buffer_load_dwordx4 v[164:167], v6, s[20:23], s46 offen sc1
    s_cmp_ge_u32 s45, 4
    s_cselect_b32 s77, 4294967292, 2
    s_add_u32 s77, s77, s45
    s_lshl_b32 s78, 1, s77
    s_andn2_b32 s79, s78, s48
    s_cbranch_scc1 FW102
FB103:
    s_lshl1_add_u32 s77, s77, 0
    s_mul_i32 s46, s77, 131072
    s_add_u32 s46, s46, s42
    buffer_load_dwordx4 v[168:171], v1, s[20:23], s46 offen sc1
    buffer_load_dwordx4 v[172:175], v2, s[20:23], s46 offen sc1
    s_waitcnt vmcnt(10)
    v_mfma_f32_16x16x32_bf16 v[176:179], v[16:19], v[136:139], 0
    v_mfma_f32_16x16x32_bf16 v[180:183], v[20:23], v[136:139], 0
    v_mfma_f32_16x16x32_bf16 v[184:187], v[24:27], v[136:139], 0
    v_mfma_f32_16x16x32_bf16 v[188:191], v[28:31], v[136:139], 0
    v_mfma_f32_16x16x32_bf16 v[192:195], v[32:35], v[136:139], 0
    s_waitcnt vmcnt(9)
    v_mfma_f32_16x16x32_bf16 v[196:199], v[16:19], v[140:143], 0
    buffer_load_dwordx4 v[136:139], v3, s[20:23], s46 offen sc1
    v_mfma_f32_16x16x32_bf16 v[200:203], v[20:23], v[140:143], 0
    v_mfma_f32_16x16x32_bf16 v[204:207], v[24:27], v[140:143], 0
    v_mfma_f32_16x16x32_bf16 v[208:211], v[28:31], v[140:143], 0
    v_mfma_f32_16x16x32_bf16 v[212:215], v[32:35], v[140:143], 0
    s_waitcnt vmcnt(9)
    v_mfma_f32_16x16x32_bf16 v[216:219], v[16:19], v[144:147], 0
    buffer_load_dwordx4 v[140:143], v6, s[20:23], s46 offen sc1
    v_mfma_f32_16x16x32_bf16 v[220:223], v[20:23], v[144:147], 0
    v_mfma_f32_16x16x32_bf16 v[224:227], v[24:27], v[144:147], 0
    v_mfma_f32_16x16x32_bf16 v[228:231], v[28:31], v[144:147], 0
    v_mfma_f32_16x16x32_bf16 v[232:235], v[32:35], v[144:147], 0
    s_waitcnt vmcnt(9)
    v_mfma_f32_16x16x32_bf16 v[236:239], v[16:19], v[148:151], 0
    buffer_load_dwordx4 v[144:147], v5, s[24:27], s11 offen offset:0 sc1
    v_mfma_f32_16x16x32_bf16 v[240:243], v[20:23], v[148:151], 0
    v_mfma_f32_16x16x32_bf16 v[244:247], v[24:27], v[148:151], 0
    v_mfma_f32_16x16x32_bf16 v[248:251], v[28:31], v[148:151], 0
    v_mfma_f32_16x16x32_bf16 v[252:255], v[32:35], v[148:151], 0
    s_waitcnt vmcnt(8)
    v_mfma_f32_16x16x32_bf16 v[176:179], v[36:39], v[152:155], v[176:179]
    s_cmp_ge_u32 s45, 3
    s_cselect_b32 s77, 4294967293, 3
    s_add_u32 s77, s77, s45
    s_lshl_b32 s78, 1, s77
    s_andn2_b32 s79, s78, s48
    s_cbranch_scc1 FW104
FB105:
    s_lshl1_add_u32 s77, s77, 0
    s_mul_i32 s46, s77, 131072
    s_add_u32 s46, s46, s42
    v_mfma_f32_16x16x32_bf16 v[180:183], v[40:43], v[152:155], v[180:183]
    buffer_load_dwordx4 v[16:19], v1, s[20:23], s46 offen sc1
    v_mfma_f32_16x16x32_bf16 v[184:187], v[44:47], v[152:155], v[184:187]
    buffer_load_dwordx4 v[20:23], v2, s[20:23], s46 offen sc1
    v_mfma_f32_16x16x32_bf16 v[188:191], v[48:51], v[152:155], v[188:191]
    buffer_load_dwordx4 v[24:27], v3, s[20:23], s46 offen sc1
    v_mfma_f32_16x16x32_bf16 v[192:195], v[52:55], v[152:155], v[192:195]
    s_waitcnt vmcnt(10)
    v_mfma_f32_16x16x32_bf16 v[196:199], v[36:39], v[156:159], v[196:199]
    buffer_load_dwordx4 v[28:31], v6, s[20:23], s46 offen sc1
    v_mfma_f32_16x16x32_bf16 v[200:203], v[40:43], v[156:159], v[200:203]
    s_cmp_ge_u32 s45, 2
    s_cselect_b32 s77, 4294967294, 4
    s_add_u32 s77, s77, s45
    s_lshl_b32 s78, 1, s77
    s_andn2_b32 s79, s78, s48
    s_cbranch_scc1 FW106
FB107:
    s_lshl1_add_u32 s77, s77, 0
    s_mul_i32 s46, s77, 131072
    s_add_u32 s46, s46, s42
    v_mfma_f32_16x16x32_bf16 v[204:207], v[44:47], v[156:159], v[204:207]
    buffer_load_dwordx4 v[32:35], v1, s[20:23], s46 offen sc1
    v_mfma_f32_16x16x32_bf16 v[208:211], v[48:51], v[156:159], v[208:211]
    v_mfma_f32_16x16x32_bf16 v[212:215], v[52:55], v[156:159], v[212:215]
    s_waitcnt vmcnt(11)
    v_mfma_f32_16x16x32_bf16 v[216:219], v[36:39], v[160:163], v[216:219]
    buffer_load_dwordx4 v[148:151], v5, s[24:27], s11 offen offset:256 sc1
    v_mfma_f32_16x16x32_bf16 v[220:223], v[40:43], v[160:163], v[220:223]
    buffer_load_dwordx4 v[152:155], v2, s[20:23], s46 offen sc1
    v_mfma_f32_16x16x32_bf16 v[224:227], v[44:47], v[160:163], v[224:227]
    v_mfma_f32_16x16x32_bf16 v[228:231], v[48:51], v[160:163], v[228:231]
    v_mfma_f32_16x16x32_bf16 v[232:235], v[52:55], v[160:163], v[232:235]
    s_waitcnt vmcnt(12)
    v_mfma_f32_16x16x32_bf16 v[236:239], v[36:39], v[164:167], v[236:239]
    buffer_load_dwordx4 v[156:159], v3, s[20:23], s46 offen sc1
    v_mfma_f32_16x16x32_bf16 v[240:243], v[40:43], v[164:167], v[240:243]
    v_mfma_f32_16x16x32_bf16 v[244:247], v[44:47], v[164:167], v[244:247]
    v_mfma_f32_16x16x32_bf16 v[248:251], v[48:51], v[164:167], v[248:251]
    v_mfma_f32_16x16x32_bf16 v[252:255], v[52:55], v[164:167], v[252:255]
    s_waitcnt vmcnt(12)
    v_mfma_f32_16x16x32_bf16 v[176:179], v[56:59], v[168:171], v[176:179]
    buffer_load_dwordx4 v[36:39], v6, s[20:23], s46 offen sc1
    v_mfma_f32_16x16x32_bf16 v[180:183], v[60:63], v[168:171], v[180:183]
    v_mfma_f32_16x16x32_bf16 v[184:187], v[64:67], v[168:171], v[184:187]
    v_mfma_f32_16x16x32_bf16 v[188:191], v[68:71], v[168:171], v[188:191]
    v_mfma_f32_16x16x32_bf16 v[192:195], v[72:75], v[168:171], v[192:195]
    s_waitcnt vmcnt(12)
    v_mfma_f32_16x16x32_bf16 v[196:199], v[56:59], v[172:175], v[196:199]
    s_cmp_ge_u32 s45, 1
    s_cselect_b32 s77, 4294967295, 5
    s_add_u32 s77, s77, s45
    s_lshl_b32 s78, 1, s77
    s_andn2_b32 s79, s78, s48
    s_cbranch_scc1 FW108
FB109:
    s_lshl1_add_u32 s77, s77, 0
    s_mul_i32 s46, s77, 131072
    s_add_u32 s46, s46, s42
    v_mfma_f32_16x16x32_bf16 v[200:203], v[60:63], v[172:175], v[200:203]
    buffer_load_dwordx4 v[40:43], v1, s[20:23], s46 offen sc1
    v_mfma_f32_16x16x32_bf16 v[204:207], v[64:67], v[172:175], v[204:207]
    v_mfma_f32_16x16x32_bf16 v[208:211], v[68:71], v[172:175], v[208:211]
    v_mfma_f32_16x16x32_bf16 v[212:215], v[72:75], v[172:175], v[212:215]
    s_waitcnt vmcnt(12)
    v_mfma_f32_16x16x32_bf16 v[216:219], v[56:59], v[136:139], v[216:219]
    buffer_load_dwordx4 v[44:47], v2, s[20:23], s46 offen sc1
    v_mfma_f32_16x16x32_bf16 v[220:223], v[60:63], v[136:139], v[220:223]
    v_mfma_f32_16x16x32_bf16 v[224:227], v[64:67], v[136:139], v[224:227]
    v_mfma_f32_16x16x32_bf16 v[228:231], v[68:71], v[136:139], v[228:231]
    v_mfma_f32_16x16x32_bf16 v[232:235], v[72:75], v[136:139], v[232:235]
    s_waitcnt vmcnt(12)
    v_mfma_f32_16x16x32_bf16 v[236:239], v[56:59], v[140:143], v[236:239]
    buffer_load_dwordx4 v[48:51], v5, s[24:27], s11 offen offset:512 sc1
    v_mfma_f32_16x16x32_bf16 v[240:243], v[60:63], v[140:143], v[240:243]
    buffer_load_dwordx4 v[52:55], v3, s[20:23], s46 offen sc1
    v_mfma_f32_16x16x32_bf16 v[244:247], v[64:67], v[140:143], v[244:247]
    v_mfma_f32_16x16x32_bf16 v[248:251], v[68:71], v[140:143], v[248:251]
    v_mfma_f32_16x16x32_bf16 v[252:255], v[72:75], v[140:143], v[252:255]
    s_waitcnt vmcnt(12)
    v_mfma_f32_16x16x32_bf16 v[176:179], v[76:79], v[16:19], v[176:179]
    buffer_load_dwordx4 v[56:59], v6, s[20:23], s46 offen sc1
    v_mfma_f32_16x16x32_bf16 v[180:183], v[80:83], v[16:19], v[180:183]
    v_mov_b32 v13, 1
    s_mov_b64 exec, 1
    ds_add_u32 v8, v13 offset:24
    s_mov_b64 exec, -1
    v_mfma_f32_16x16x32_bf16 v[184:187], v[84:87], v[16:19], v[184:187]
    v_mfma_f32_16x16x32_bf16 v[188:191], v[88:91], v[16:19], v[188:191]
    v_mfma_f32_16x16x32_bf16 v[192:195], v[92:95], v[16:19], v[192:195]
    s_waitcnt vmcnt(12)
    v_mfma_f32_16x16x32_bf16 v[196:199], v[76:79], v[20:23], v[196:199]
    s_cmp_ge_u32 s45, 6
    s_cselect_b32 s77, 4294967290, 0
    s_add_u32 s77, s77, s45
    s_lshl_b32 s78, 256, s77
    s_andn2_b32 s79, s78, s48
    s_cbranch_scc1 FW110
FB111:
    s_lshl1_add_u32 s77, s77, 1
    s_mul_i32 s46, s77, 131072
    s_add_u32 s46, s46, s42
    v_mfma_f32_16x16x32_bf16 v[200:203], v[80:83], v[20:23], v[200:203]
    buffer_load_dwordx4 v[60:63], v1, s[20:23], s46 offen sc1
    v_mfma_f32_16x16x32_bf16 v[204:207], v[84:87], v[20:23], v[204:207]
    v_mfma_f32_16x16x32_bf16 v[208:211], v[88:91], v[20:23], v[208:211]
    v_mfma_f32_16x16x32_bf16 v[212:215], v[92:95], v[20:23], v[212:215]
    s_waitcnt vmcnt(12)
    v_mfma_f32_16x16x32_bf16 v[216:219], v[76:79], v[24:27], v[216:219]
    buffer_load_dwordx4 v[64:67], v2, s[20:23], s46 offen sc1
    v_mfma_f32_16x16x32_bf16 v[220:223], v[80:83], v[24:27], v[220:223]
    v_mfma_f32_16x16x32_bf16 v[224:227], v[84:87], v[24:27], v[224:227]
    v_mfma_f32_16x16x32_bf16 v[228:231], v[88:91], v[24:27], v[228:231]
    v_mfma_f32_16x16x32_bf16 v[232:235], v[92:95], v[24:27], v[232:235]
    s_waitcnt vmcnt(12)
    v_mfma_f32_16x16x32_bf16 v[236:239], v[76:79], v[28:31], v[236:239]
    buffer_load_dwordx4 v[68:71], v3, s[20:23], s46 offen sc1
    v_mfma_f32_16x16x32_bf16 v[240:243], v[80:83], v[28:31], v[240:243]
    v_mfma_f32_16x16x32_bf16 v[244:247], v[84:87], v[28:31], v[244:247]
    v_mfma_f32_16x16x32_bf16 v[248:251], v[88:91], v[28:31], v[248:251]
    v_mfma_f32_16x16x32_bf16 v[252:255], v[92:95], v[28:31], v[252:255]
    s_waitcnt vmcnt(12)
    v_mfma_f32_16x16x32_bf16 v[176:179], v[96:99], v[32:35], v[176:179]
    buffer_load_dwordx4 v[76:79], v5, s[24:27], s11 offen offset:768 sc1
    v_mfma_f32_16x16x32_bf16 v[180:183], v[100:103], v[32:35], v[180:183]
    buffer_load_dwordx4 v[80:83], v6, s[20:23], s46 offen sc1
    v_mfma_f32_16x16x32_bf16 v[184:187], v[104:107], v[32:35], v[184:187]
    v_mfma_f32_16x16x32_bf16 v[188:191], v[108:111], v[32:35], v[188:191]
    v_mfma_f32_16x16x32_bf16 v[192:195], v[112:115], v[32:35], v[192:195]
    s_waitcnt vmcnt(12)
    v_mfma_f32_16x16x32_bf16 v[196:199], v[96:99], v[152:155], v[196:199]
    s_cmp_ge_u32 s45, 5
    s_cselect_b32 s77, 4294967291, 1
    s_add_u32 s77, s77, s45
    s_lshl_b32 s78, 256, s77
    s_andn2_b32 s79, s78, s48
    s_cbranch_scc1 FW112
FB113:
    s_lshl1_add_u32 s77, s77, 1
    s_mul_i32 s46, s77, 131072
    s_add_u32 s46, s46, s42
    v_mfma_f32_16x16x32_bf16 v[200:203], v[100:103], v[152:155], v[200:203]
    buffer_load_dwordx4 v[84:87], v1, s[20:23], s46 offen sc1
    v_mfma_f32_16x16x32_bf16 v[204:207], v[104:107], v[152:155], v[204:207]
    v_mfma_f32_16x16x32_bf16 v[208:211], v[108:111], v[152:155], v[208:211]
    v_mfma_f32_16x16x32_bf16 v[212:215], v[112:115], v[152:155], v[212:215]
    s_waitcnt vmcnt(12)
    v_mfma_f32_16x16x32_bf16 v[216:219], v[96:99], v[156:159], v[216:219]
    buffer_load_dwordx4 v[88:91], v2, s[20:23], s46 offen sc1
    v_mfma_f32_16x16x32_bf16 v[220:223], v[100:103], v[156:159], v[220:223]
    v_mfma_f32_16x16x32_bf16 v[224:227], v[104:107], v[156:159], v[224:227]
    v_mfma_f32_16x16x32_bf16 v[228:231], v[108:111], v[156:159], v[228:231]
    v_mfma_f32_16x16x32_bf16 v[232:235], v[112:115], v[156:159], v[232:235]
    s_waitcnt vmcnt(12)
    v_mfma_f32_16x16x32_bf16 v[236:239], v[96:99], v[36:39], v[236:239]
    buffer_load_dwordx4 v[92:95], v3, s[20:23], s46 offen sc1
    v_mfma_f32_16x16x32_bf16 v[240:243], v[100:103], v[36:39], v[240:243]
    v_mfma_f32_16x16x32_bf16 v[244:247], v[104:107], v[36:39], v[244:247]
    v_mfma_f32_16x16x32_bf16 v[248:251], v[108:111], v[36:39], v[248:251]
    v_mfma_f32_16x16x32_bf16 v[252:255], v[112:115], v[36:39], v[252:255]
    s_waitcnt vmcnt(12)
    v_mfma_f32_16x16x32_bf16 v[176:179], v[116:119], v[40:43], v[176:179]
    v_mfma_f32_16x16x32_bf16 v[180:183], v[120:123], v[40:43], v[180:183]
    ds_read_b128 v[96:99], v7 offset:0
    v_mfma_f32_16x16x32_bf16 v[184:187], v[124:127], v[40:43], v[184:187]
    ds_read_b128 v[100:103], v7 offset:1024
    v_mfma_f32_16x16x32_bf16 v[188:191], v[128:131], v[40:43], v[188:191]
    ds_read_b128 v[104:107], v7 offset:2048
    v_mfma_f32_16x16x32_bf16 v[192:195], v[132:135], v[40:43], v[192:195]
    s_waitcnt vmcnt(11)
    v_mfma_f32_16x16x32_bf16 v[196:199], v[116:119], v[44:47], v[196:199]
    ds_read_b128 v[108:111], v7 offset:3072
    v_mfma_f32_16x16x32_bf16 v[200:203], v[120:123], v[44:47], v[200:203]
    ds_read_b128 v[112:115], v7 offset:4096
    v_mfma_f32_16x16x32_bf16 v[204:207], v[124:127], v[44:47], v[204:207]
    buffer_load_dwordx4 v[72:75], v6, s[20:23], s46 offen sc1
    v_mfma_f32_16x16x32_bf16 v[208:211], v[128:131], v[44:47], v[208:211]
    s_add_u32 s78, s11, s32
    buffer_load_dwordx4 v[160:163], v5, s[24:27], s78 offen sc1
    v_mfma_f32_16x16x32_bf16 v[212:215], v[132:135], v[44:47], v[212:215]
    s_waitcnt vmcnt(11)
    v_mfma_f32_16x16x32_bf16 v[216:219], v[116:119], v[52:55], v[216:219]
    s_cmp_ge_u32 s45, 4
    s_cselect_b32 s77, 4294967292, 2
    s_add_u32 s77, s77, s45
    s_lshl_b32 s78, 256, s77
    s_andn2_b32 s79, s78, s48
    s_cbranch_scc1 FW114
FB115:
    s_lshl1_add_u32 s77, s77, 1
    s_mul_i32 s46, s77, 131072
    s_add_u32 s46, s46, s42
    v_mfma_f32_16x16x32_bf16 v[220:223], v[120:123], v[52:55], v[220:223]
    buffer_load_dwordx4 v[164:167], v1, s[20:23], s46 offen sc1
    v_mfma_f32_16x16x32_bf16 v[224:227], v[124:127], v[52:55], v[224:227]
    buffer_load_dwordx4 v[168:171], v2, s[20:23], s46 offen sc1
    v_mfma_f32_16x16x32_bf16 v[228:231], v[128:131], v[52:55], v[228:231]
    v_mfma_f32_16x16x32_bf16 v[232:235], v[132:135], v[52:55], v[232:235]
    s_waitcnt vmcnt(12)
    v_mfma_f32_16x16x32_bf16 v[236:239], v[116:119], v[56:59], v[236:239]
    buffer_load_dwordx4 v[172:175], v3, s[20:23], s46 offen sc1
    v_mfma_f32_16x16x32_bf16 v[240:243], v[120:123], v[56:59], v[240:243]
    v_mfma_f32_16x16x32_bf16 v[244:247], v[124:127], v[56:59], v[244:247]
    v_mfma_f32_16x16x32_bf16 v[248:251], v[128:131], v[56:59], v[248:251]
    v_mfma_f32_16x16x32_bf16 v[252:255], v[132:135], v[56:59], v[252:255]
    s_waitcnt lgkmcnt(0)
    s_waitcnt vmcnt(12)
    v_mfma_f32_16x16x32_bf16 v[176:179], v[96:99], v[60:63], v[176:179]
    v_mfma_f32_16x16x32_bf16 v[180:183], v[100:103], v[60:63], v[180:183]
    ds_read_b128 v[116:119], v7 offset:20480
    v_mfma_f32_16x16x32_bf16 v[184:187], v[104:107], v[60:63], v[184:187]
    ds_read_b128 v[120:123], v7 offset:21504
    v_mfma_f32_16x16x32_bf16 v[188:191], v[108:111], v[60:63], v[188:191]
    ds_read_b128 v[124:127], v7 offset:22528
    v_mfma_f32_16x16x32_bf16 v[192:195], v[112:115], v[60:63], v[192:195]
    s_waitcnt vmcnt(11)
    v_mfma_f32_16x16x32_bf16 v[196:199], v[96:99], v[64:67], v[196:199]
    ds_read_b128 v[128:131], v7 offset:23552
    v_mfma_f32_16x16x32_bf16 v[200:203], v[100:103], v[64:67], v[200:203]
    ds_read_b128 v[132:135], v7 offset:24576
    v_mfma_f32_16x16x32_bf16 v[204:207], v[104:107], v[64:67], v[204:207]
    buffer_load_dwordx4 v[136:139], v6, s[20:23], s46 offen sc1
    v_mfma_f32_16x16x32_bf16 v[208:211], v[108:111], v[64:67], v[208:211]
    v_mov_b32 v13, 1
    s_mov_b64 exec, 1
    ds_add_u32 v8, v13 offset:28
    s_mov_b64 exec, -1
    v_mfma_f32_16x16x32_bf16 v[212:215], v[112:115], v[64:67], v[212:215]
    s_waitcnt vmcnt(11)
    v_mfma_f32_16x16x32_bf16 v[216:219], v[96:99], v[68:71], v[216:219]
    s_cmp_ge_u32 s45, 3
    s_cselect_b32 s77, 4294967293, 3
    s_add_u32 s77, s77, s45
    s_lshl_b32 s78, 256, s77
    s_andn2_b32 s79, s78, s48
    s_cbranch_scc1 FW116
FB117:
    s_lshl1_add_u32 s77, s77, 1
    s_mul_i32 s46, s77, 131072
    s_add_u32 s46, s46, s42
    v_mfma_f32_16x16x32_bf16 v[220:223], v[100:103], v[68:71], v[220:223]
    buffer_load_dwordx4 v[140:143], v1, s[20:23], s46 offen sc1
    v_mfma_f32_16x16x32_bf16 v[224:227], v[104:107], v[68:71], v[224:227]
    s_cmp_ge_u32 s45, 2
    s_cselect_b32 s77, 4294967294, 4
    s_add_u32 s77, s77, s45
    s_lshl_b32 s78, 256, s77
    s_andn2_b32 s79, s78, s48
    s_cbranch_scc1 FW118
FB119:
    s_lshl1_add_u32 s77, s77, 1
    s_mul_i32 s34, s77, 131072
    s_add_u32 s34, s34, s42
    v_mfma_f32_16x16x32_bf16 v[228:231], v[108:111], v[68:71], v[228:231]
    buffer_load_dwordx4 v[16:19], v1, s[20:23], s34 offen sc1
    v_mfma_f32_16x16x32_bf16 v[232:235], v[112:115], v[68:71], v[232:235]
    s_waitcnt vmcnt(11)
    v_mfma_f32_16x16x32_bf16 v[236:239], v[96:99], v[80:83], v[236:239]
    s_cmp_ge_u32 s45, 1
    s_cselect_b32 s77, 4294967295, 5
    s_add_u32 s77, s77, s45
    s_lshl_b32 s78, 256, s77
    s_andn2_b32 s79, s78, s48
    s_cbranch_scc1 FW120
FB121:
    s_lshl1_add_u32 s77, s77, 1
    s_mul_i32 s35, s77, 131072
    s_add_u32 s35, s35, s42
    v_mfma_f32_16x16x32_bf16 v[240:243], v[100:103], v[80:83], v[240:243]
    buffer_load_dwordx4 v[20:23], v1, s[20:23], s35 offen sc1
    v_mfma_f32_16x16x32_bf16 v[244:247], v[104:107], v[80:83], v[244:247]
    v_mfma_f32_16x16x32_bf16 v[248:251], v[108:111], v[80:83], v[248:251]
    v_mfma_f32_16x16x32_bf16 v[252:255], v[112:115], v[80:83], v[252:255]
    s_waitcnt lgkmcnt(1)
    s_waitcnt vmcnt(11)
    v_mfma_f32_16x16x32_bf16 v[176:179], v[116:119], v[84:87], v[176:179]
    v_mfma_f32_16x16x32_bf16 v[180:183], v[120:123], v[84:87], v[180:183]
    ds_read_b128 v[96:99], v7 offset:40960
    v_mfma_f32_16x16x32_bf16 v[184:187], v[124:127], v[84:87], v[184:187]
    ds_read_b128 v[100:103], v7 offset:41984
    v_mfma_f32_16x16x32_bf16 v[188:191], v[128:131], v[84:87], v[188:191]
    ds_read_b128 v[104:107], v7 offset:43008
    v_mfma_f32_16x16x32_bf16 v[192:195], v[132:135], v[84:87], v[192:195]
    s_waitcnt vmcnt(10)
    v_mfma_f32_16x16x32_bf16 v[196:199], v[116:119], v[88:91], v[196:199]
    ds_read_b128 v[108:111], v7 offset:44032
    v_mfma_f32_16x16x32_bf16 v[200:203], v[120:123], v[88:91], v[200:203]
    ds_read_b128 v[112:115], v7 offset:45056
    v_mfma_f32_16x16x32_bf16 v[204:207], v[124:127], v[88:91], v[204:207]
    buffer_load_dwordx4 v[24:27], v2, s[20:23], s46 offen sc1
    v_mfma_f32_16x16x32_bf16 v[208:211], v[128:131], v[88:91], v[208:211]
    buffer_load_dwordx4 v[28:31], v2, s[20:23], s34 offen sc1
    v_mfma_f32_16x16x32_bf16 v[212:215], v[132:135], v[88:91], v[212:215]
    s_waitcnt vmcnt(11)
    v_mfma_f32_16x16x32_bf16 v[216:219], v[116:119], v[92:95], v[216:219]
    buffer_load_dwordx4 v[32:35], v2, s[20:23], s35 offen sc1
    v_mfma_f32_16x16x32_bf16 v[220:223], v[120:123], v[92:95], v[220:223]
    v_mfma_f32_16x16x32_bf16 v[224:227], v[124:127], v[92:95], v[224:227]
    v_mfma_f32_16x16x32_bf16 v[228:231], v[128:131], v[92:95], v[228:231]
    v_mfma_f32_16x16x32_bf16 v[232:235], v[132:135], v[92:95], v[232:235]
    s_waitcnt vmcnt(11)
    v_mfma_f32_16x16x32_bf16 v[236:239], v[116:119], v[72:75], v[236:239]
    buffer_load_dwordx4 v[152:155], v3, s[20:23], s46 offen sc1
    v_mfma_f32_16x16x32_bf16 v[240:243], v[120:123], v[72:75], v[240:243]
    v_mfma_f32_16x16x32_bf16 v[244:247], v[124:127], v[72:75], v[244:247]
    v_mfma_f32_16x16x32_bf16 v[248:251], v[128:131], v[72:75], v[248:251]
    v_mfma_f32_16x16x32_bf16 v[252:255], v[132:135], v[72:75], v[252:255]
    s_waitcnt lgkmcnt(0)
    s_waitcnt vmcnt(10)
    v_mfma_f32_16x16x32_bf16 v[176:179], v[96:99], v[164:167], v[176:179]
    v_mfma_f32_16x16x32_bf16 v[180:183], v[100:103], v[164:167], v[180:183]
    ds_read_b128 v[116:119], v15 offset:0
    v_mfma_f32_16x16x32_bf16 v[184:187], v[104:107], v[164:167], v[184:187]
    ds_read_b128 v[120:123], v15 offset:1024
    v_mfma_f32_16x16x32_bf16 v[188:191], v[108:111], v[164:167], v[188:191]
    ds_read_b128 v[124:127], v15 offset:2048
    v_mfma_f32_16x16x32_bf16 v[192:195], v[112:115], v[164:167], v[192:195]
    s_waitcnt vmcnt(9)
    v_mfma_f32_16x16x32_bf16 v[196:199], v[96:99], v[168:171], v[196:199]
    ds_read_b128 v[128:131], v15 offset:3072
    v_mfma_f32_16x16x32_bf16 v[200:203], v[100:103], v[168:171], v[200:203]
    ds_read_b128 v[132:135], v15 offset:4096
    v_mfma_f32_16x16x32_bf16 v[204:207], v[104:107], v[168:171], v[204:207]
    buffer_load_dwordx4 v[156:159], v3, s[20:23], s34 offen sc1
    v_mfma_f32_16x16x32_bf16 v[208:211], v[108:111], v[168:171], v[208:211]
    v_mfma_f32_16x16x32_bf16 v[212:215], v[112:115], v[168:171], v[212:215]
    ds_read_b128 v[36:39], v4 offset:0
    s_waitcnt vmcnt(9)
    v_mfma_f32_16x16x32_bf16 v[216:219], v[96:99], v[172:175], v[216:219]
    ds_read_b128 v[40:43], v4 offset:1024
    v_mfma_f32_16x16x32_bf16 v[220:223], v[100:103], v[172:175], v[220:223]
    ds_read_b128 v[44:47], v4 offset:2048
    v_mfma_f32_16x16x32_bf16 v[224:227], v[104:107], v[172:175], v[224:227]
    ds_read_b128 v[52:55], v4 offset:3072
    v_mfma_f32_16x16x32_bf16 v[228:231], v[108:111], v[172:175], v[228:231]
    ds_read_b128 v[56:59], v4 offset:4096
    v_mfma_f32_16x16x32_bf16 v[232:235], v[112:115], v[172:175], v[232:235]
    s_waitcnt vmcnt(8)
    v_mfma_f32_16x16x32_bf16 v[236:239], v[96:99], v[136:139], v[236:239]
    buffer_load_dwordx4 v[60:63], v3, s[20:23], s35 offen sc1
    v_mfma_f32_16x16x32_bf16 v[240:243], v[100:103], v[136:139], v[240:243]
    buffer_load_dwordx4 v[64:67], v6, s[20:23], s46 offen sc1
    v_mfma_f32_16x16x32_bf16 v[244:247], v[104:107], v[136:139], v[244:247]
    buffer_load_dwordx4 v[68:71], v6, s[20:23], s34 offen sc1
    v_mfma_f32_16x16x32_bf16 v[248:251], v[108:111], v[136:139], v[248:251]
    v_mfma_f32_16x16x32_bf16 v[252:255], v[112:115], v[136:139], v[252:255]
    s_waitcnt lgkmcnt(5)
    s_waitcnt vmcnt(10)
    v_mfma_f32_16x16x32_bf16 v[176:179], v[116:119], v[140:143], v[176:179]
    buffer_load_dwordx4 v[96:99], v6, s[20:23], s35 offen sc1
    v_mfma_f32_16x16x32_bf16 v[180:183], v[120:123], v[140:143], v[180:183]
    v_mfma_f32_16x16x32_bf16 v[184:187], v[124:127], v[140:143], v[184:187]
    v_mfma_f32_16x16x32_bf16 v[188:191], v[128:131], v[140:143], v[188:191]
    v_mfma_f32_16x16x32_bf16 v[192:195], v[132:135], v[140:143], v[192:195]
    s_waitcnt lgkmcnt(0)
    s_waitcnt vmcnt(10)
    v_mfma_f32_16x16x32_bf16 v[176:179], v[36:39], v[16:19], v[176:179]
    v_mfma_f32_16x16x32_bf16 v[180:183], v[40:43], v[16:19], v[180:183]
    v_mfma_f32_16x16x32_bf16 v[184:187], v[44:47], v[16:19], v[184:187]
    v_mfma_f32_16x16x32_bf16 v[188:191], v[52:55], v[16:19], v[188:191]
    v_mfma_f32_16x16x32_bf16 v[192:195], v[56:59], v[16:19], v[192:195]
    s_waitcnt vmcnt(9)
    v_mfma_f32_16x16x32_bf16 v[176:179], v[144:147], v[20:23], v[176:179]
    v_mfma_f32_16x16x32_bf16 v[180:183], v[148:151], v[20:23], v[180:183]
    v_mfma_f32_16x16x32_bf16 v[184:187], v[48:51], v[20:23], v[184:187]
    v_mfma_f32_16x16x32_bf16 v[188:191], v[76:79], v[20:23], v[188:191]
    v_mfma_f32_16x16x32_bf16 v[192:195], v[160:163], v[20:23], v[192:195]
    s_waitcnt vmcnt(8)
    v_mfma_f32_16x16x32_bf16 v[196:199], v[116:119], v[24:27], v[196:199]
    v_mfma_f32_16x16x32_bf16 v[200:203], v[120:123], v[24:27], v[200:203]
    v_mfma_f32_16x16x32_bf16 v[204:207], v[124:127], v[24:27], v[204:207]
    v_mfma_f32_16x16x32_bf16 v[208:211], v[128:131], v[24:27], v[208:211]
    v_mfma_f32_16x16x32_bf16 v[212:215], v[132:135], v[24:27], v[212:215]
    s_waitcnt vmcnt(7)
    v_mfma_f32_16x16x32_bf16 v[196:199], v[36:39], v[28:31], v[196:199]
    ds_write_b128 v7, v[176:179] offset:0
    v_mfma_f32_16x16x32_bf16 v[200:203], v[40:43], v[28:31], v[200:203]
    ds_write_b128 v7, v[180:183] offset:1024
    v_mfma_f32_16x16x32_bf16 v[204:207], v[44:47], v[28:31], v[204:207]
    v_mfma_f32_16x16x32_bf16 v[208:211], v[52:55], v[28:31], v[208:211]
    v_mfma_f32_16x16x32_bf16 v[212:215], v[56:59], v[28:31], v[212:215]
    s_waitcnt vmcnt(6)
    v_mfma_f32_16x16x32_bf16 v[196:199], v[144:147], v[32:35], v[196:199]
    ds_write_b128 v7, v[184:187] offset:2048
    v_mfma_f32_16x16x32_bf16 v[200:203], v[148:151], v[32:35], v[200:203]
    ds_write_b128 v7, v[188:191] offset:3072
    v_mfma_f32_16x16x32_bf16 v[204:207], v[48:51], v[32:35], v[204:207]
    v_mfma_f32_16x16x32_bf16 v[208:211], v[76:79], v[32:35], v[208:211]
    v_mfma_f32_16x16x32_bf16 v[212:215], v[160:163], v[32:35], v[212:215]
    s_waitcnt vmcnt(5)
    v_mfma_f32_16x16x32_bf16 v[216:219], v[116:119], v[152:155], v[216:219]
    ds_write_b128 v7, v[192:195] offset:4096
    v_mfma_f32_16x16x32_bf16 v[220:223], v[120:123], v[152:155], v[220:223]
    v_mfma_f32_16x16x32_bf16 v[224:227], v[124:127], v[152:155], v[224:227]
    v_mfma_f32_16x16x32_bf16 v[228:231], v[128:131], v[152:155], v[228:231]
    v_mfma_f32_16x16x32_bf16 v[232:235], v[132:135], v[152:155], v[232:235]
    s_waitcnt vmcnt(4)
    v_mfma_f32_16x16x32_bf16 v[216:219], v[36:39], v[156:159], v[216:219]
    ds_write_b128 v7, v[196:199] offset:20480
    v_mfma_f32_16x16x32_bf16 v[220:223], v[40:43], v[156:159], v[220:223]
    ds_write_b128 v7, v[200:203] offset:21504
    v_mfma_f32_16x16x32_bf16 v[224:227], v[44:47], v[156:159], v[224:227]
    v_mfma_f32_16x16x32_bf16 v[228:231], v[52:55], v[156:159], v[228:231]
    v_mfma_f32_16x16x32_bf16 v[232:235], v[56:59], v[156:159], v[232:235]
    ds_write_b128 v7, v[204:207] offset:22528
    ds_write_b128 v7, v[208:211] offset:23552
    s_waitcnt vmcnt(3)
    v_mfma_f32_16x16x32_bf16 v[216:219], v[144:147], v[60:63], v[216:219]
    v_mbcnt_lo_u32_b32 v9, -1, 0
    v_mbcnt_hi_u32_b32 v9, -1, v9
    v_lshlrev_b32 v3, 4, v9
    v_add_u32 v1, s4, v3
    v_mfma_f32_16x16x32_bf16 v[220:223], v[148:151], v[60:63], v[220:223]
    v_add_u32 v2, s5, v3
    v_add_u32 v3, s6, v3
    v_lshlrev_b32 v5, 3, v9
    v_add_u32 v5, s7, v5
    v_mfma_f32_16x16x32_bf16 v[224:227], v[48:51], v[60:63], v[224:227]
    v_and_b32 v6, 15, v9
    v_mul_u32_u24 v6, 1280, v6
    v_lshrrev_b32 v9, 4, v9
    v_lshl_add_u32 v4, v9, 4, v6
    v_mfma_f32_16x16x32_bf16 v[228:231], v[76:79], v[60:63], v[228:231]
    v_lshl_add_u32 v6, v9, 3, v6
    v_mul_f32 v10, v10, v10
    v_mov_b32 v13, 1
    v_mov_b32 v11, v10
    v_mfma_f32_16x16x32_bf16 v[232:235], v[160:163], v[60:63], v[232:235]
    ds_write_b128 v7, v[212:215] offset:24576
    s_waitcnt vmcnt(2)
    v_mfma_f32_16x16x32_bf16 v[236:239], v[116:119], v[64:67], v[236:239]
    ds_write_b128 v7, v[216:219] offset:40960
    v_mfma_f32_16x16x32_bf16 v[240:243], v[120:123], v[64:67], v[240:243]
    ds_write_b128 v7, v[220:223] offset:41984
    v_mfma_f32_16x16x32_bf16 v[244:247], v[124:127], v[64:67], v[244:247]
    ds_write_b128 v7, v[224:227] offset:43008
    v_mfma_f32_16x16x32_bf16 v[248:251], v[128:131], v[64:67], v[248:251]
    ds_write_b128 v7, v[228:231] offset:44032
    v_mfma_f32_16x16x32_bf16 v[252:255], v[132:135], v[64:67], v[252:255]
    ds_write_b128 v7, v[232:235] offset:45056
    s_mov_b64 exec, 1
    s_waitcnt lgkmcnt(14)
    ds_add_rtn_u32 v12, v8, v13 offset:88
    s_mov_b64 exec, -1
    s_waitcnt vmcnt(1)
    v_mfma_f32_16x16x32_bf16 v[236:239], v[36:39], v[68:71], v[236:239]
    s_waitcnt lgkmcnt(14)
    ds_read_b128 v[116:119], v1 offset:0
    s_waitcnt lgkmcnt(14)
    ds_read_b128 v[120:123], v2 offset:0
    s_waitcnt lgkmcnt(14)
    ds_read_b128 v[124:127], v3 offset:0
    v_mfma_f32_16x16x32_bf16 v[240:243], v[40:43], v[68:71], v[240:243]
    s_waitcnt lgkmcnt(14)
    ds_read_b128 v[128:131], v1 offset:1024
    s_waitcnt lgkmcnt(14)
    ds_read_b128 v[132:135], v2 offset:1024
    s_waitcnt lgkmcnt(14)
    ds_read_b128 v[100:103], v3 offset:1024
    v_mfma_f32_16x16x32_bf16 v[244:247], v[44:47], v[68:71], v[244:247]
    s_waitcnt lgkmcnt(14)
    ds_read_b128 v[104:107], v1 offset:2048
    s_waitcnt lgkmcnt(14)
    ds_read_b128 v[108:111], v2 offset:2048
    s_waitcnt lgkmcnt(14)
    ds_read_b128 v[112:115], v3 offset:2048
    v_mfma_f32_16x16x32_bf16 v[248:251], v[52:55], v[68:71], v[248:251]
    s_waitcnt lgkmcnt(14)
    ds_read_b128 v[80:83], v1 offset:3072
    s_waitcnt lgkmcnt(14)
    ds_read_b128 v[84:87], v2 offset:3072
    s_waitcnt lgkmcnt(14)
    ds_read_b128 v[88:91], v3 offset:3072
    v_mfma_f32_16x16x32_bf16 v[252:255], v[56:59], v[68:71], v[252:255]
    s_waitcnt lgkmcnt(14)
    ds_read_b128 v[92:95], v1 offset:4096
    s_waitcnt lgkmcnt(14)
    ds_read_b128 v[72:75], v2 offset:4096
    s_waitcnt lgkmcnt(14)
    ds_read_b128 v[164:167], v3 offset:4096
    s_waitcnt vmcnt(0)
    v_mfma_f32_16x16x32_bf16 v[236:239], v[144:147], v[96:99], v[236:239]
    s_waitcnt lgkmcnt(14)
    ds_read_b32 v14, v8 offset:92
    s_waitcnt lgkmcnt(14)
    ds_read_b64 v[168:169], v5 offset:0
    v_mfma_f32_16x16x32_bf16 v[240:243], v[148:151], v[96:99], v[240:243]
    s_waitcnt lgkmcnt(14)
    ds_read_b64 v[170:171], v5 offset:512
    s_waitcnt lgkmcnt(14)
    ds_read_b64 v[172:173], v5 offset:1024
    v_mfma_f32_16x16x32_bf16 v[244:247], v[48:51], v[96:99], v[244:247]
    s_waitcnt lgkmcnt(14)
    ds_read_b64 v[174:175], v5 offset:1536
    s_waitcnt lgkmcnt(14)
    ds_read_b64 v[136:137], v5 offset:2048
    v_mfma_f32_16x16x32_bf16 v[248:251], v[76:79], v[96:99], v[248:251]
    v_mfma_f32_16x16x32_bf16 v[252:255], v[160:163], v[96:99], v[252:255]
    v_readfirstlane_b32 s77, v12
    s_cmp_lt_u32 s77, 3
    s_cbranch_scc1 RS122
RB123:
    v_pk_add_f32 v[120:121], v[120:121], v[124:125]
    v_pk_add_f32 v[122:123], v[122:123], v[126:127]
    v_pk_add_f32 v[116:117], v[116:117], v[120:121]
    v_pk_add_f32 v[118:119], v[118:119], v[122:123]
    v_pk_add_f32 v[132:133], v[132:133], v[100:101]
    v_pk_add_f32 v[134:135], v[134:135], v[102:103]
    v_pk_add_f32 v[128:129], v[128:129], v[132:133]
    v_pk_add_f32 v[130:131], v[130:131], v[134:135]
    s_waitcnt lgkmcnt(12)
    v_pk_add_f32 v[108:109], v[108:109], v[112:113]
    v_pk_add_f32 v[110:111], v[110:111], v[114:115]
    v_pk_add_f32 v[104:105], v[104:105], v[108:109]
    v_pk_add_f32 v[106:107], v[106:107], v[110:111]
    s_waitcnt lgkmcnt(9)
    v_pk_add_f32 v[84:85], v[84:85], v[88:89]
    v_pk_add_f32 v[86:87], v[86:87], v[90:91]
    v_pk_add_f32 v[80:81], v[80:81], v[84:85]
    v_pk_add_f32 v[82:83], v[82:83], v[86:87]
    s_waitcnt lgkmcnt(6)
    v_pk_add_f32 v[72:73], v[72:73], v[164:165]
    v_pk_add_f32 v[74:75], v[74:75], v[166:167]
    v_pk_add_f32 v[92:93], v[92:93], v[72:73]
    v_pk_add_f32 v[94:95], v[94:95], v[74:75]
    s_nop 0
    v_pk_add_f32 v[236:237], v[236:237], v[116:117]
    v_pk_add_f32 v[238:239], v[238:239], v[118:119]
    v_pk_mul_f32 v[236:237], v[236:237], v[10:11]
    v_pk_mul_f32 v[238:239], v[238:239], v[10:11]
    v_cvt_pk_bf16_f32 v236, v236, v237
    v_cvt_pk_bf16_f32 v238, v238, v239
    v_pk_add_f32 v[240:241], v[240:241], v[128:129]
    v_pk_add_f32 v[242:243], v[242:243], v[130:131]
    v_pk_mul_f32 v[240:241], v[240:241], v[10:11]
    v_pk_mul_f32 v[242:243], v[242:243], v[10:11]
    v_cvt_pk_bf16_f32 v240, v240, v241
    v_cvt_pk_bf16_f32 v242, v242, v243
    v_pk_add_f32 v[244:245], v[244:245], v[104:105]
    v_pk_add_f32 v[246:247], v[246:247], v[106:107]
    v_pk_mul_f32 v[244:245], v[244:245], v[10:11]
    v_pk_mul_f32 v[246:247], v[246:247], v[10:11]
    v_cvt_pk_bf16_f32 v244, v244, v245
    v_cvt_pk_bf16_f32 v246, v246, v247
    v_pk_add_f32 v[248:249], v[248:249], v[80:81]
    v_pk_add_f32 v[250:251], v[250:251], v[82:83]
    v_pk_mul_f32 v[248:249], v[248:249], v[10:11]
    v_pk_mul_f32 v[250:251], v[250:251], v[10:11]
    v_cvt_pk_bf16_f32 v248, v248, v249
    v_cvt_pk_bf16_f32 v250, v250, v251
    v_pk_add_f32 v[252:253], v[252:253], v[92:93]
    v_pk_add_f32 v[254:255], v[254:255], v[94:95]
    v_pk_mul_f32 v[252:253], v[252:253], v[10:11]
    v_pk_mul_f32 v[254:255], v[254:255], v[10:11]
    v_cvt_pk_bf16_f32 v252, v252, v253
    v_cvt_pk_bf16_f32 v254, v254, v255
    s_waitcnt lgkmcnt(0)
    v_cmp_gt_u32 vcc, 4, v14
    s_cbranch_vccnz TS124
TB125:
    v_and_b32 v117, s10, v236
    v_lshlrev_b32 v116, 16, v236
    v_and_b32 v121, s10, v168
    v_lshlrev_b32 v120, 16, v168
    v_and_b32 v119, s10, v238
    v_lshlrev_b32 v118, 16, v238
    v_and_b32 v123, s10, v169
    v_lshlrev_b32 v122, 16, v169
    v_pk_add_f32 v[116:117], v[116:117], v[120:121]
    v_pk_add_f32 v[118:119], v[118:119], v[122:123]
    v_cvt_pk_bf16_f32 v236, v116, v117
    v_cvt_pk_bf16_f32 v237, v118, v119
    v_and_b32 v129, s10, v240
    v_lshlrev_b32 v128, 16, v240
    v_and_b32 v133, s10, v170
    v_lshlrev_b32 v132, 16, v170
    v_and_b32 v131, s10, v242
    v_lshlrev_b32 v130, 16, v242
    v_and_b32 v135, s10, v171
    v_lshlrev_b32 v134, 16, v171
    v_pk_add_f32 v[128:129], v[128:129], v[132:133]
    v_pk_add_f32 v[130:131], v[130:131], v[134:135]
    v_cvt_pk_bf16_f32 v238, v128, v129
    v_cvt_pk_bf16_f32 v239, v130, v131
    buffer_store_dwordx4 v[236:239], v4, s[28:31], s8 offen offset:0 sc1
    v_and_b32 v105, s10, v244
    v_lshlrev_b32 v104, 16, v244
    v_and_b32 v109, s10, v172
    v_lshlrev_b32 v108, 16, v172
    v_and_b32 v107, s10, v246
    v_lshlrev_b32 v106, 16, v246
    v_and_b32 v111, s10, v173
    v_lshlrev_b32 v110, 16, v173
    v_pk_add_f32 v[104:105], v[104:105], v[108:109]
    v_pk_add_f32 v[106:107], v[106:107], v[110:111]
    v_cvt_pk_bf16_f32 v244, v104, v105
    v_cvt_pk_bf16_f32 v245, v106, v107
    v_and_b32 v81, s10, v248
    v_lshlrev_b32 v80, 16, v248
    v_and_b32 v85, s10, v174
    v_lshlrev_b32 v84, 16, v174
    v_and_b32 v83, s10, v250
    v_lshlrev_b32 v82, 16, v250
    v_and_b32 v87, s10, v175
    v_lshlrev_b32 v86, 16, v175
    v_pk_add_f32 v[80:81], v[80:81], v[84:85]
    v_pk_add_f32 v[82:83], v[82:83], v[86:87]
    v_cvt_pk_bf16_f32 v246, v80, v81
    v_cvt_pk_bf16_f32 v247, v82, v83
    buffer_store_dwordx4 v[244:247], v4, s[28:31], s8 offen offset:64 sc1
    v_and_b32 v93, s10, v252
    v_lshlrev_b32 v92, 16, v252
    v_and_b32 v73, s10, v136
    v_lshlrev_b32 v72, 16, v136
    v_and_b32 v95, s10, v254
    v_lshlrev_b32 v94, 16, v254
    v_and_b32 v75, s10, v137
    v_lshlrev_b32 v74, 16, v137
    v_pk_add_f32 v[92:93], v[92:93], v[72:73]
    v_pk_add_f32 v[94:95], v[94:95], v[74:75]
    v_cvt_pk_bf16_f32 v252, v92, v93
    v_cvt_pk_bf16_f32 v253, v94, v95
    buffer_store_dwordx2 v[252:253], v6, s[28:31], s9 offen sc1
    s_endpgm
RS122:
    s_mov_b32 s83, 200000
SPL126:
    ds_read_b32 v12, v8 offset:88
    s_waitcnt lgkmcnt(0)
    s_nop 0
    v_readfirstlane_b32 s82, v12
    s_sub_u32 s83, s83, 1
    s_cselect_b32 s82, -1, s82
    s_cmp_ge_u32 s82, 4
    s_cbranch_scc1 SPD127
    s_branch SPL126
SPD127:
    ds_read_b128 v[116:119], v1 offset:0
    ds_read_b128 v[120:123], v2 offset:0
    ds_read_b128 v[124:127], v3 offset:0
    ds_read_b128 v[128:131], v1 offset:1024
    ds_read_b128 v[132:135], v2 offset:1024
    ds_read_b128 v[100:103], v3 offset:1024
    ds_read_b128 v[104:107], v1 offset:2048
    ds_read_b128 v[108:111], v2 offset:2048
    ds_read_b128 v[112:115], v3 offset:2048
    ds_read_b128 v[80:83], v1 offset:3072
    ds_read_b128 v[84:87], v2 offset:3072
    ds_read_b128 v[88:91], v3 offset:3072
    ds_read_b128 v[92:95], v1 offset:4096
    ds_read_b128 v[72:75], v2 offset:4096
    ds_read_b128 v[164:167], v3 offset:4096
    s_waitcnt lgkmcnt(14)
    ds_read_b32 v14, v8 offset:92
    s_waitcnt lgkmcnt(0)
    ds_read_b64 v[168:169], v5 offset:0
    ds_read_b64 v[170:171], v5 offset:512
    ds_read_b64 v[172:173], v5 offset:1024
    ds_read_b64 v[174:175], v5 offset:1536
    ds_read_b64 v[136:137], v5 offset:2048
    s_branch RB123
TS124:
    s_mov_b32 s83, 200000
SPL128:
    ds_read_b32 v14, v8 offset:92
    s_waitcnt lgkmcnt(0)
    s_nop 0
    v_readfirstlane_b32 s82, v14
    s_sub_u32 s83, s83, 1
    s_cselect_b32 s82, -1, s82
    s_cmp_ge_u32 s82, 4
    s_cbranch_scc1 SPD129
    s_branch SPL128
SPD129:
    ds_read_b64 v[168:169], v5 offset:0
    ds_read_b64 v[170:171], v5 offset:512
    ds_read_b64 v[172:173], v5 offset:1024
    ds_read_b64 v[174:175], v5 offset:1536
    ds_read_b64 v[136:137], v5 offset:2048
    s_waitcnt lgkmcnt(0)
    s_branch TB125
L_G2H:
    s_cmp_eq_u32 s3, 7
    s_cbranch_scc1 L_G2T
    s_lshl_b32 s77, s40, 2
    v_add_u32 v13, s77, v8
    s_mov_b32 s83, 200000
SPL130:
    ds_read_b32 v12, v13 offset:56
    s_waitcnt lgkmcnt(0)
    s_nop 0
    v_readfirstlane_b32 s82, v12
    s_sub_u32 s83, s83, 1
    s_cselect_b32 s82, -1, s82
    s_cmp_ge_u32 s82, 2
    s_cbranch_scc1 SPD131
    s_sleep 4
    s_branch SPL130
SPD131:
    s_cmp_ge_u32 s45, 1
    s_cselect_b32 s77, 4294967295, 6
    s_add_u32 s77, s77, s45
    s_lshl1_add_u32 s77, s77, 0
    s_mul_i32 s77, s77, 40960
    s_add_u32 s77, s77, s41
    s_add_u32 s78, s77, s32
    s_add_u32 m0, s47, 5120
    s_nop 0
    buffer_load_dwordx4 v5, s[24:27], s77 offen offset:0 sc1 lds
    s_add_u32 m0, s47, 5888
    s_nop 0
    buffer_load_dwordx4 v5, s[24:27], s77 offen offset:256 sc1 lds
    s_add_u32 m0, s47, 6656
    s_nop 0
    buffer_load_dwordx4 v5, s[24:27], s77 offen offset:512 sc1 lds
    global_load_dword v11, v14, s[50:51]
    s_add_u32 m0, s47, 7424
    s_nop 0
    buffer_load_dwordx4 v5, s[24:27], s77 offen offset:768 sc1 lds
    s_add_u32 m0, s47, 9216
    s_nop 0
    buffer_load_dwordx4 v5, s[24:27], s78 offen sc1 lds
    s_waitcnt vmcnt(7)
    s_cmp_ge_u32 s45, 7
    s_cselect_b32 s77, 4294967289, 0
    s_add_u32 s77, s77, s45
    s_lshl1_add_u32 s77, s77, 1
    s_mul_i32 s77, s77, 40960
    s_add_u32 s77, s77, s41
    s_add_u32 s78, s77, s32
    s_add_u32 m0, s36, 0
    s_nop 0
    buffer_load_dwordx4 v5, s[24:27], s77 offen offset:0 sc1 lds
    global_load_dword v11, v14, s[50:51]
    s_add_u32 m0, s36, 768
    s_nop 0
    buffer_load_dwordx4 v5, s[24:27], s77 offen offset:256 sc1 lds
    s_add_u32 m0, s36, 1536
    s_nop 0
    buffer_load_dwordx4 v5, s[24:27], s77 offen offset:512 sc1 lds
    s_add_u32 m0, s36, 2304
    s_nop 0
    buffer_load_dwordx4 v5, s[24:27], s77 offen offset:768 sc1 lds
    global_load_dword v11, v14, s[50:51]
    s_add_u32 m0, s36, 4096
    s_nop 0
    buffer_load_dwordx4 v5, s[24:27], s78 offen sc1 lds
    s_mov_b32 s83, 200000
SPL132:
    ds_read_b32 v12, v8 offset:112
    s_waitcnt lgkmcnt(0)
    s_nop 0
    v_readfirstlane_b32 s82, v12
    s_sub_u32 s83, s83, 1
    s_cselect_b32 s82, -1, s82
    s_cmp_ge_u32 s82, 4
    s_cbranch_scc1 SPD133
    s_sleep 2
    s_branch SPL132
SPD133:
    s_waitcnt vmcnt(7)
    s_cmp_ge_u32 s45, 6
    s_cselect_b32 s77, 4294967290, 1
    s_add_u32 s77, s77, s45
    s_lshl1_add_u32 s77, s77, 1
    s_mul_i32 s77, s77, 40960
    s_add_u32 s77, s77, s41
    s_add_u32 s78, s77, s32
    s_add_u32 m0, s47, 0
    s_nop 0
    buffer_load_dwordx4 v5, s[24:27], s77 offen offset:0 sc1 lds
    s_add_u32 m0, s47, 768
    s_nop 0
    buffer_load_dwordx4 v5, s[24:27], s77 offen offset:256 sc1 lds
    global_load_dword v11, v14, s[50:51]
    s_add_u32 m0, s47, 1536
    s_nop 0
    buffer_load_dwordx4 v5, s[24:27], s77 offen offset:512 sc1 lds
    s_add_u32 m0, s47, 2304
    s_nop 0
    buffer_load_dwordx4 v5, s[24:27], s77 offen offset:768 sc1 lds
    s_add_u32 m0, s47, 4096
    s_nop 0
    buffer_load_dwordx4 v5, s[24:27], s78 offen sc1 lds
    global_load_dword v11, v14, s[50:51]
    s_waitcnt vmcnt(7)
    s_cmp_ge_u32 s45, 5
    s_cselect_b32 s77, 4294967291, 2
    s_add_u32 s77, s77, s45
    s_lshl1_add_u32 s77, s77, 1
    s_mul_i32 s77, s77, 40960
    s_add_u32 s77, s77, s41
    s_add_u32 s78, s77, s32
    s_add_u32 m0, s47, 10240
    s_nop 0
    buffer_load_dwordx4 v5, s[24:27], s77 offen offset:0 sc1 lds
    s_add_u32 m0, s47, 11008
    s_nop 0
    buffer_load_dwordx4 v5, s[24:27], s77 offen offset:256 sc1 lds
    s_add_u32 m0, s47, 11776
    s_nop 0
    buffer_load_dwordx4 v5, s[24:27], s77 offen offset:512 sc1 lds
    global_load_dword v11, v14, s[50:51]
    s_add_u32 m0, s47, 12544
    s_nop 0
    buffer_load_dwordx4 v5, s[24:27], s77 offen offset:768 sc1 lds
    s_add_u32 m0, s47, 14336
    s_nop 0
    buffer_load_dwordx4 v5, s[24:27], s78 offen sc1 lds
    s_waitcnt vmcnt(7)
    s_cmp_ge_u32 s45, 4
    s_cselect_b32 s77, 4294967292, 3
    s_add_u32 s77, s77, s45
    s_lshl1_add_u32 s77, s77, 1
    s_mul_i32 s77, s77, 40960
    s_add_u32 s77, s77, s41
    s_add_u32 s78, s77, s32
    s_add_u32 m0, s47, 15360
    s_nop 0
    buffer_load_dwordx4 v5, s[24:27], s77 offen offset:0 sc1 lds
    global_load_dword v11, v14, s[50:51]
    s_add_u32 m0, s47, 16128
    s_nop 0
    buffer_load_dwordx4 v5, s[24:27], s77 offen offset:256 sc1 lds
    s_add_u32 m0, s47, 16896
    s_nop 0
    buffer_load_dwordx4 v5, s[24:27], s77 offen offset:512 sc1 lds
    s_add_u32 m0, s47, 17664
    s_nop 0
    buffer_load_dwordx4 v5, s[24:27], s77 offen offset:768 sc1 lds
    global_load_dword v11, v14, s[50:51]
    s_add_u32 m0, s47, 19456
    s_nop 0
    buffer_load_dwordx4 v5, s[24:27], s78 offen sc1 lds
    s_mov_b32 s48, 0
    s_cmp_ge_u32 s45, 3
    s_cselect_b32 s77, 4294967293, 4
    s_add_u32 s77, s77, s45
    s_lshl1_add_u32 s77, s77, 1
    s_mul_i32 s77, s77, 40960
    s_add_u32 s11, s77, s41
    s_cmp_ge_u32 s45, 2
    s_cselect_b32 s77, 4294967294, 5
    s_add_u32 s77, s77, s45
    s_lshl1_add_u32 s77, s77, 1
    s_mul_i32 s77, s77, 40960
    s_add_u32 s12, s77, s41
    s_cmp_ge_u32 s45, 1
    s_cselect_b32 s77, 4294967295, 6
    s_add_u32 s77, s77, s45
    s_lshl1_add_u32 s77, s77, 1
    s_mul_i32 s77, s77, 40960
    s_add_u32 s13, s77, s41
    s_cmp_ge_u32 s45, 7
    s_cselect_b32 s77, 4294967289, 0
    s_add_u32 s77, s77, s45
    s_lshl_b32 s78, 1, s77
    s_andn2_b32 s79, s78, s48
    s_cbranch_scc1 FW134
FB135:
    s_lshl1_add_u32 s77, s77, 0
    s_mul_i32 s46, s77, 131072
    s_add_u32 s46, s46, s42
    buffer_load_dwordx4 v[136:139], v1, s[20:23], s46 offen sc1
    buffer_load_dwordx4 v[140:143], v2, s[20:23], s46 offen sc1
    buffer_load_dwordx4 v[144:147], v3, s[20:23], s46 offen sc1
    buffer_load_dwordx4 v[148:151], v6, s[20:23], s46 offen sc1
    s_cmp_ge_u32 s45, 6
    s_cselect_b32 s77, 4294967290, 1
    s_add_u32 s77, s77, s45
    s_lshl_b32 s78, 1, s77
    s_andn2_b32 s79, s78, s48
    s_cbranch_scc1 FW136
FB137:
    s_lshl1_add_u32 s77, s77, 0
    buffer_load_dword v10, v10, s[16:19], s39 offen sc1
    s_mul_i32 s46, s77, 131072
    s_add_u32 s46, s46, s42
    buffer_load_dwordx4 v[152:155], v1, s[20:23], s46 offen sc1
    buffer_load_dwordx4 v[156:159], v2, s[20:23], s46 offen sc1
    buffer_load_dwordx4 v[160:163], v3, s[20:23], s46 offen sc1
    buffer_load_dwordx4 v[164:167], v6, s[20:23], s46 offen sc1
    s_cmp_ge_u32 s45, 5
    s_cselect_b32 s77, 4294967291, 2
    s_add_u32 s77, s77, s45
    s_lshl_b32 s78, 1, s77
    s_andn2_b32 s79, s78, s48
    s_cbranch_scc1 FW138
FB139:
    s_lshl1_add_u32 s77, s77, 0
    s_mul_i32 s46, s77, 131072
    s_add_u32 s46, s46, s42
    buffer_load_dwordx4 v[168:171], v1, s[20:23], s46 offen sc1
    buffer_load_dwordx4 v[172:175], v2, s[20:23], s46 offen sc1
    s_waitcnt vmcnt(10)
    v_mfma_f32_16x16x32_bf16 v[176:179], v[16:19], v[136:139], 0
    v_mfma_f32_16x16x32_bf16 v[180:183], v[20:23], v[136:139], 0
    v_mfma_f32_16x16x32_bf16 v[184:187], v[24:27], v[136:139], 0
    v_mfma_f32_16x16x32_bf16 v[188:191], v[28:31], v[136:139], 0
    v_mfma_f32_16x16x32_bf16 v[192:195], v[32:35], v[136:139], 0
    s_waitcnt vmcnt(9)
    v_mfma_f32_16x16x32_bf16 v[196:199], v[16:19], v[140:143], 0
    buffer_load_dwordx4 v[136:139], v3, s[20:23], s46 offen sc1
    v_mfma_f32_16x16x32_bf16 v[200:203], v[20:23], v[140:143], 0
    v_mfma_f32_16x16x32_bf16 v[204:207], v[24:27], v[140:143], 0
    v_mfma_f32_16x16x32_bf16 v[208:211], v[28:31], v[140:143], 0
    v_mfma_f32_16x16x32_bf16 v[212:215], v[32:35], v[140:143], 0
    s_waitcnt vmcnt(9)
    v_mfma_f32_16x16x32_bf16 v[216:219], v[16:19], v[144:147], 0
    buffer_load_dwordx4 v[140:143], v6, s[20:23], s46 offen sc1
    v_mfma_f32_16x16x32_bf16 v[220:223], v[20:23], v[144:147], 0
    v_mfma_f32_16x16x32_bf16 v[224:227], v[24:27], v[144:147], 0
    v_mfma_f32_16x16x32_bf16 v[228:231], v[28:31], v[144:147], 0
    v_mfma_f32_16x16x32_bf16 v[232:235], v[32:35], v[144:147], 0
    s_waitcnt vmcnt(9)
    v_mfma_f32_16x16x32_bf16 v[236:239], v[16:19], v[148:151], 0
    buffer_load_dwordx4 v[144:147], v5, s[24:27], s11 offen offset:0 sc1
    v_mfma_f32_16x16x32_bf16 v[240:243], v[20:23], v[148:151], 0
    v_mfma_f32_16x16x32_bf16 v[244:247], v[24:27], v[148:151], 0
    v_mfma_f32_16x16x32_bf16 v[248:251], v[28:31], v[148:151], 0
    v_mfma_f32_16x16x32_bf16 v[252:255], v[32:35], v[148:151], 0
    s_waitcnt vmcnt(8)
    v_mfma_f32_16x16x32_bf16 v[176:179], v[36:39], v[152:155], v[176:179]
    s_cmp_ge_u32 s45, 4
    s_cselect_b32 s77, 4294967292, 3
    s_add_u32 s77, s77, s45
    s_lshl_b32 s78, 1, s77
    s_andn2_b32 s79, s78, s48
    s_cbranch_scc1 FW140
FB141:
    s_lshl1_add_u32 s77, s77, 0
    s_mul_i32 s46, s77, 131072
    s_add_u32 s46, s46, s42
    v_mfma_f32_16x16x32_bf16 v[180:183], v[40:43], v[152:155], v[180:183]
    buffer_load_dwordx4 v[16:19], v1, s[20:23], s46 offen sc1
    v_mfma_f32_16x16x32_bf16 v[184:187], v[44:47], v[152:155], v[184:187]
    buffer_load_dwordx4 v[20:23], v2, s[20:23], s46 offen sc1
    v_mfma_f32_16x16x32_bf16 v[188:191], v[48:51], v[152:155], v[188:191]
    buffer_load_dwordx4 v[24:27], v5, s[24:27], s11 offen offset:256 sc1
    v_mfma_f32_16x16x32_bf16 v[192:195], v[52:55], v[152:155], v[192:195]
    s_waitcnt vmcnt(10)
    v_mfma_f32_16x16x32_bf16 v[196:199], v[36:39], v[156:159], v[196:199]
    buffer_load_dwordx4 v[28:31], v3, s[20:23], s46 offen sc1
    v_mfma_f32_16x16x32_bf16 v[200:203], v[40:43], v[156:159], v[200:203]
    buffer_load_dwordx4 v[32:35], v6, s[20:23], s46 offen sc1
    v_mfma_f32_16x16x32_bf16 v[204:207], v[44:47], v[156:159], v[204:207]
    buffer_load_dwordx4 v[148:151], v5, s[24:27], s11 offen offset:512 sc1
    v_mfma_f32_16x16x32_bf16 v[208:211], v[48:51], v[156:159], v[208:211]
    s_cmp_ge_u32 s45, 3
    s_cselect_b32 s77, 4294967293, 4
    s_add_u32 s77, s77, s45
    s_lshl_b32 s78, 1, s77
    s_andn2_b32 s79, s78, s48
    s_cbranch_scc1 FW142
FB143:
    s_lshl1_add_u32 s77, s77, 0
    s_mul_i32 s46, s77, 131072
    s_add_u32 s46, s46, s42
    v_mfma_f32_16x16x32_bf16 v[212:215], v[52:55], v[156:159], v[212:215]
    s_waitcnt vmcnt(12)
    v_mfma_f32_16x16x32_bf16 v[216:219], v[36:39], v[160:163], v[216:219]
    buffer_load_dwordx4 v[152:155], v1, s[20:23], s46 offen sc1
    v_mfma_f32_16x16x32_bf16 v[220:223], v[40:43], v[160:163], v[220:223]
    buffer_load_dwordx4 v[156:159], v2, s[20:23], s46 offen sc1
    v_mfma_f32_16x16x32_bf16 v[224:227], v[44:47], v[160:163], v[224:227]
    v_mfma_f32_16x16x32_bf16 v[228:231], v[48:51], v[160:163], v[228:231]
    v_mfma_f32_16x16x32_bf16 v[232:235], v[52:55], v[160:163], v[232:235]
    s_waitcnt vmcnt(13)
    v_mfma_f32_16x16x32_bf16 v[236:239], v[36:39], v[164:167], v[236:239]
    buffer_load_dwordx4 v[160:163], v5, s[24:27], s11 offen offset:768 sc1
    v_mfma_f32_16x16x32_bf16 v[240:243], v[40:43], v[164:167], v[240:243]
    v_mfma_f32_16x16x32_bf16 v[244:247], v[44:47], v[164:167], v[244:247]
    v_mfma_f32_16x16x32_bf16 v[248:251], v[48:51], v[164:167], v[248:251]
    v_mfma_f32_16x16x32_bf16 v[252:255], v[52:55], v[164:167], v[252:255]
    s_waitcnt vmcnt(13)
    v_mfma_f32_16x16x32_bf16 v[176:179], v[56:59], v[168:171], v[176:179]
    buffer_load_dwordx4 v[36:39], v3, s[20:23], s46 offen sc1
    v_mfma_f32_16x16x32_bf16 v[180:183], v[60:63], v[168:171], v[180:183]
    buffer_load_dwordx4 v[40:43], v6, s[20:23], s46 offen sc1
    v_mfma_f32_16x16x32_bf16 v[184:187], v[64:67], v[168:171], v[184:187]
    v_mfma_f32_16x16x32_bf16 v[188:191], v[68:71], v[168:171], v[188:191]
    v_mfma_f32_16x16x32_bf16 v[192:195], v[72:75], v[168:171], v[192:195]
    s_waitcnt vmcnt(14)
    v_mfma_f32_16x16x32_bf16 v[196:199], v[56:59], v[172:175], v[196:199]
    s_add_u32 s78, s11, s32
    buffer_load_dwordx4 v[44:47], v5, s[24:27], s78 offen sc1
    v_mfma_f32_16x16x32_bf16 v[200:203], v[60:63], v[172:175], v[200:203]
    s_cmp_ge_u32 s45, 2
    s_cselect_b32 s77, 4294967294, 5
    s_add_u32 s77, s77, s45
    s_lshl_b32 s78, 1, s77
    s_andn2_b32 s79, s78, s48
    s_cbranch_scc1 FW144
FB145:
    s_lshl1_add_u32 s77, s77, 0
    s_mul_i32 s46, s77, 131072
    s_add_u32 s46, s46, s42
    v_mfma_f32_16x16x32_bf16 v[204:207], v[64:67], v[172:175], v[204:207]
    buffer_load_dwordx4 v[48:51], v1, s[20:23], s46 offen sc1
    v_mfma_f32_16x16x32_bf16 v[208:211], v[68:71], v[172:175], v[208:211]
    v_mfma_f32_16x16x32_bf16 v[212:215], v[72:75], v[172:175], v[212:215]
    s_waitcnt vmcnt(15)
    v_mfma_f32_16x16x32_bf16 v[216:219], v[56:59], v[136:139], v[216:219]
    buffer_load_dwordx4 v[52:55], v2, s[20:23], s46 offen sc1
    v_mfma_f32_16x16x32_bf16 v[220:223], v[60:63], v[136:139], v[220:223]
    v_mfma_f32_16x16x32_bf16 v[224:227], v[64:67], v[136:139], v[224:227]
    v_mfma_f32_16x16x32_bf16 v[228:231], v[68:71], v[136:139], v[228:231]
    v_mfma_f32_16x16x32_bf16 v[232:235], v[72:75], v[136:139], v[232:235]
    s_waitcnt vmcnt(15)
    v_mfma_f32_16x16x32_bf16 v[236:239], v[56:59], v[140:143], v[236:239]
    buffer_load_dwordx4 v[164:167], v5, s[24:27], s12 offen offset:0 sc1
    v_mfma_f32_16x16x32_bf16 v[240:243], v[60:63], v[140:143], v[240:243]
    buffer_load_dwordx4 v[168:171], v3, s[20:23], s46 offen sc1
    v_mfma_f32_16x16x32_bf16 v[244:247], v[64:67], v[140:143], v[244:247]
    v_mfma_f32_16x16x32_bf16 v[248:251], v[68:71], v[140:143], v[248:251]
    v_mfma_f32_16x16x32_bf16 v[252:255], v[72:75], v[140:143], v[252:255]
    s_waitcnt vmcnt(15)
    v_mfma_f32_16x16x32_bf16 v[176:179], v[76:79], v[16:19], v[176:179]
    buffer_load_dwordx4 v[56:59], v6, s[20:23], s46 offen sc1
    v_mfma_f32_16x16x32_bf16 v[180:183], v[80:83], v[16:19], v[180:183]
    v_mfma_f32_16x16x32_bf16 v[184:187], v[84:87], v[16:19], v[184:187]
    v_mfma_f32_16x16x32_bf16 v[188:191], v[88:91], v[16:19], v[188:191]
    v_mfma_f32_16x16x32_bf16 v[192:195], v[92:95], v[16:19], v[192:195]
    s_waitcnt vmcnt(15)
    v_mfma_f32_16x16x32_bf16 v[196:199], v[76:79], v[20:23], v[196:199]
    buffer_load_dwordx4 v[60:63], v5, s[24:27], s12 offen offset:256 sc1
    v_mfma_f32_16x16x32_bf16 v[200:203], v[80:83], v[20:23], v[200:203]
    s_cmp_ge_u32 s45, 1
    s_cselect_b32 s77, 4294967295, 6
    s_add_u32 s77, s77, s45
    s_lshl_b32 s78, 1, s77
    s_andn2_b32 s79, s78, s48
    s_cbranch_scc1 FW146
FB147:
    s_lshl1_add_u32 s77, s77, 0
    s_mul_i32 s46, s77, 131072
    s_add_u32 s46, s46, s42
    v_mfma_f32_16x16x32_bf16 v[204:207], v[84:87], v[20:23], v[204:207]
    buffer_load_dwordx4 v[64:67], v1, s[20:23], s46 offen sc1
    v_mfma_f32_16x16x32_bf16 v[208:211], v[88:91], v[20:23], v[208:211]
    v_mfma_f32_16x16x32_bf16 v[212:215], v[92:95], v[20:23], v[212:215]
    s_waitcnt vmcnt(15)
    v_mfma_f32_16x16x32_bf16 v[216:219], v[76:79], v[28:31], v[216:219]
    buffer_load_dwordx4 v[68:71], v2, s[20:23], s46 offen sc1
    v_mfma_f32_16x16x32_bf16 v[220:223], v[80:83], v[28:31], v[220:223]
    v_mfma_f32_16x16x32_bf16 v[224:227], v[84:87], v[28:31], v[224:227]
    v_mfma_f32_16x16x32_bf16 v[228:231], v[88:91], v[28:31], v[228:231]
    v_mfma_f32_16x16x32_bf16 v[232:235], v[92:95], v[28:31], v[232:235]
    s_waitcnt vmcnt(15)
    v_mfma_f32_16x16x32_bf16 v[236:239], v[76:79], v[32:35], v[236:239]
    buffer_load_dwordx4 v[72:75], v5, s[24:27], s12 offen offset:512 sc1
    v_mfma_f32_16x16x32_bf16 v[240:243], v[80:83], v[32:35], v[240:243]
    buffer_load_dwordx4 v[172:175], v3, s[20:23], s46 offen sc1
    v_mfma_f32_16x16x32_bf16 v[244:247], v[84:87], v[32:35], v[244:247]
    v_mfma_f32_16x16x32_bf16 v[248:251], v[88:91], v[32:35], v[248:251]
    v_mfma_f32_16x16x32_bf16 v[252:255], v[92:95], v[32:35], v[252:255]
    s_waitcnt vmcnt(15)
    v_mfma_f32_16x16x32_bf16 v[176:179], v[96:99], v[152:155], v[176:179]
    buffer_load_dwordx4 v[76:79], v6, s[20:23], s46 offen sc1
    v_mfma_f32_16x16x32_bf16 v[180:183], v[100:103], v[152:155], v[180:183]
    v_mfma_f32_16x16x32_bf16 v[184:187], v[104:107], v[152:155], v[184:187]
    v_mfma_f32_16x16x32_bf16 v[188:191], v[108:111], v[152:155], v[188:191]
    v_mfma_f32_16x16x32_bf16 v[192:195], v[112:115], v[152:155], v[192:195]
    s_waitcnt vmcnt(15)
    v_mfma_f32_16x16x32_bf16 v[196:199], v[96:99], v[156:159], v[196:199]
    buffer_load_dwordx4 v[80:83], v5, s[24:27], s12 offen offset:768 sc1
    v_mfma_f32_16x16x32_bf16 v[200:203], v[100:103], v[156:159], v[200:203]
    s_cmp_ge_u32 s45, 7
    s_cselect_b32 s77, 4294967289, 0
    s_add_u32 s77, s77, s45
    s_lshl_b32 s78, 256, s77
    s_andn2_b32 s79, s78, s48
    s_cbranch_scc1 FW148
FB149:
    s_lshl1_add_u32 s77, s77, 1
    s_mul_i32 s46, s77, 131072
    s_add_u32 s46, s46, s42
    v_mfma_f32_16x16x32_bf16 v[204:207], v[104:107], v[156:159], v[204:207]
    buffer_load_dwordx4 v[84:87], v1, s[20:23], s46 offen sc1
    v_mfma_f32_16x16x32_bf16 v[208:211], v[108:111], v[156:159], v[208:211]
    v_mfma_f32_16x16x32_bf16 v[212:215], v[112:115], v[156:159], v[212:215]
    s_waitcnt vmcnt(15)
    v_mfma_f32_16x16x32_bf16 v[216:219], v[96:99], v[36:39], v[216:219]
    buffer_load_dwordx4 v[88:91], v2, s[20:23], s46 offen sc1
    v_mfma_f32_16x16x32_bf16 v[220:223], v[100:103], v[36:39], v[220:223]
    v_mfma_f32_16x16x32_bf16 v[224:227], v[104:107], v[36:39], v[224:227]
    v_mfma_f32_16x16x32_bf16 v[228:231], v[108:111], v[36:39], v[228:231]
    v_mfma_f32_16x16x32_bf16 v[232:235], v[112:115], v[36:39], v[232:235]
    s_waitcnt vmcnt(15)
    v_mfma_f32_16x16x32_bf16 v[236:239], v[96:99], v[40:43], v[236:239]
    s_add_u32 s78, s12, s32
    buffer_load_dwordx4 v[92:95], v5, s[24:27], s78 offen sc1
    v_mfma_f32_16x16x32_bf16 v[240:243], v[100:103], v[40:43], v[240:243]
    buffer_load_dwordx4 v[136:139], v3, s[20:23], s46 offen sc1
    v_mfma_f32_16x16x32_bf16 v[244:247], v[104:107], v[40:43], v[244:247]
    v_mfma_f32_16x16x32_bf16 v[248:251], v[108:111], v[40:43], v[248:251]
    v_mfma_f32_16x16x32_bf16 v[252:255], v[112:115], v[40:43], v[252:255]
    s_waitcnt vmcnt(15)
    v_mfma_f32_16x16x32_bf16 v[176:179], v[116:119], v[48:51], v[176:179]
    v_mfma_f32_16x16x32_bf16 v[180:183], v[120:123], v[48:51], v[180:183]
    ds_read_b128 v[96:99], v7 offset:5120
    v_mfma_f32_16x16x32_bf16 v[184:187], v[124:127], v[48:51], v[184:187]
    ds_read_b128 v[100:103], v7 offset:6144
    v_mfma_f32_16x16x32_bf16 v[188:191], v[128:131], v[48:51], v[188:191]
    ds_read_b128 v[104:107], v7 offset:7168
    v_mfma_f32_16x16x32_bf16 v[192:195], v[132:135], v[48:51], v[192:195]
    s_waitcnt vmcnt(14)
    v_mfma_f32_16x16x32_bf16 v[196:199], v[116:119], v[52:55], v[196:199]
    ds_read_b128 v[108:111], v7 offset:8192
    v_mfma_f32_16x16x32_bf16 v[200:203], v[120:123], v[52:55], v[200:203]
    ds_read_b128 v[112:115], v7 offset:9216
    v_mfma_f32_16x16x32_bf16 v[204:207], v[124:127], v[52:55], v[204:207]
    buffer_load_dwordx4 v[140:143], v6, s[20:23], s46 offen sc1
    v_mfma_f32_16x16x32_bf16 v[208:211], v[128:131], v[52:55], v[208:211]
    v_mov_b32 v13, 1
    s_mov_b64 exec, 1
    ds_add_u32 v8, v13 offset:24
    s_mov_b64 exec, -1
    v_mfma_f32_16x16x32_bf16 v[212:215], v[132:135], v[52:55], v[212:215]
    s_waitcnt vmcnt(13)
    v_mfma_f32_16x16x32_bf16 v[216:219], v[116:119], v[168:171], v[216:219]
    buffer_load_dwordx4 v[16:19], v5, s[24:27], s13 offen offset:0 sc1
    v_mfma_f32_16x16x32_bf16 v[220:223], v[120:123], v[168:171], v[220:223]
    s_cmp_ge_u32 s45, 6
    s_cselect_b32 s77, 4294967290, 1
    s_add_u32 s77, s77, s45
    s_lshl_b32 s78, 256, s77
    s_andn2_b32 s79, s78, s48
    s_cbranch_scc1 FW150
FB151:
    s_lshl1_add_u32 s77, s77, 1
    s_mul_i32 s46, s77, 131072
    s_add_u32 s46, s46, s42
    v_mfma_f32_16x16x32_bf16 v[224:227], v[124:127], v[168:171], v[224:227]
    buffer_load_dwordx4 v[20:23], v1, s[20:23], s46 offen sc1
    v_mfma_f32_16x16x32_bf16 v[228:231], v[128:131], v[168:171], v[228:231]
    buffer_load_dwordx4 v[28:31], v2, s[20:23], s46 offen sc1
    v_mfma_f32_16x16x32_bf16 v[232:235], v[132:135], v[168:171], v[232:235]
    s_waitcnt vmcnt(15)
    v_mfma_f32_16x16x32_bf16 v[236:239], v[116:119], v[56:59], v[236:239]
    buffer_load_dwordx4 v[32:35], v5, s[24:27], s13 offen offset:256 sc1
    v_mfma_f32_16x16x32_bf16 v[240:243], v[120:123], v[56:59], v[240:243]
    buffer_load_dwordx4 v[152:155], v3, s[20:23], s46 offen sc1
    v_mfma_f32_16x16x32_bf16 v[244:247], v[124:127], v[56:59], v[244:247]
    v_mfma_f32_16x16x32_bf16 v[248:251], v[128:131], v[56:59], v[248:251]
    v_mfma_f32_16x16x32_bf16 v[252:255], v[132:135], v[56:59], v[252:255]
    s_waitcnt lgkmcnt(1)
    s_waitcnt vmcnt(15)
    v_mfma_f32_16x16x32_bf16 v[176:179], v[96:99], v[64:67], v[176:179]
    v_mfma_f32_16x16x32_bf16 v[180:183], v[100:103], v[64:67], v[180:183]
    ds_read_b128 v[116:119], v4 offset:0
    v_mfma_f32_16x16x32_bf16 v[184:187], v[104:107], v[64:67], v[184:187]
    ds_read_b128 v[120:123], v4 offset:1024
    v_mfma_f32_16x16x32_bf16 v[188:191], v[108:111], v[64:67], v[188:191]
    ds_read_b128 v[124:127], v4 offset:2048
    v_mfma_f32_16x16x32_bf16 v[192:195], v[112:115], v[64:67], v[192:195]
    s_waitcnt vmcnt(14)
    v_mfma_f32_16x16x32_bf16 v[196:199], v[96:99], v[68:71], v[196:199]
    ds_read_b128 v[128:131], v4 offset:3072
    v_mfma_f32_16x16x32_bf16 v[200:203], v[100:103], v[68:71], v[200:203]
    ds_read_b128 v[132:135], v4 offset:4096
    v_mfma_f32_16x16x32_bf16 v[204:207], v[104:107], v[68:71], v[204:207]
    buffer_load_dwordx4 v[156:159], v6, s[20:23], s46 offen sc1
    v_mfma_f32_16x16x32_bf16 v[208:211], v[108:111], v[68:71], v[208:211]
    buffer_load_dwordx4 v[36:39], v5, s[24:27], s13 offen offset:512 sc1
    v_mfma_f32_16x16x32_bf16 v[212:215], v[112:115], v[68:71], v[212:215]
    s_waitcnt vmcnt(14)
    v_mfma_f32_16x16x32_bf16 v[216:219], v[96:99], v[172:175], v[216:219]
    s_cmp_ge_u32 s45, 5
    s_cselect_b32 s77, 4294967291, 2
    s_add_u32 s77, s77, s45
    s_lshl_b32 s78, 256, s77
    s_andn2_b32 s79, s78, s48
    s_cbranch_scc1 FW152
FB153:
    s_lshl1_add_u32 s77, s77, 1
    s_mul_i32 s46, s77, 131072
    s_add_u32 s46, s46, s42
    v_mfma_f32_16x16x32_bf16 v[220:223], v[100:103], v[172:175], v[220:223]
    buffer_load_dwordx4 v[40:43], v1, s[20:23], s46 offen sc1
    v_mfma_f32_16x16x32_bf16 v[224:227], v[104:107], v[172:175], v[224:227]
    buffer_load_dwordx4 v[48:51], v2, s[20:23], s46 offen sc1
    v_mfma_f32_16x16x32_bf16 v[228:231], v[108:111], v[172:175], v[228:231]
    v_mfma_f32_16x16x32_bf16 v[232:235], v[112:115], v[172:175], v[232:235]
    s_waitcnt vmcnt(15)
    v_mfma_f32_16x16x32_bf16 v[236:239], v[96:99], v[76:79], v[236:239]
    buffer_load_dwordx4 v[52:55], v5, s[24:27], s13 offen offset:768 sc1
    v_mfma_f32_16x16x32_bf16 v[240:243], v[100:103], v[76:79], v[240:243]
    buffer_load_dwordx4 v[168:171], v3, s[20:23], s46 offen sc1
    v_mfma_f32_16x16x32_bf16 v[244:247], v[104:107], v[76:79], v[244:247]
    v_mfma_f32_16x16x32_bf16 v[248:251], v[108:111], v[76:79], v[248:251]
    v_mfma_f32_16x16x32_bf16 v[252:255], v[112:115], v[76:79], v[252:255]
    s_waitcnt lgkmcnt(0)
    s_waitcnt vmcnt(15)
    v_mfma_f32_16x16x32_bf16 v[176:179], v[116:119], v[84:87], v[176:179]
    v_mfma_f32_16x16x32_bf16 v[180:183], v[120:123], v[84:87], v[180:183]
    ds_read_b128 v[96:99], v7 offset:0
    v_mfma_f32_16x16x32_bf16 v[184:187], v[124:127], v[84:87], v[184:187]
    ds_read_b128 v[100:103], v7 offset:1024
    v_mfma_f32_16x16x32_bf16 v[188:191], v[128:131], v[84:87], v[188:191]
    ds_read_b128 v[104:107], v7 offset:2048
    v_mfma_f32_16x16x32_bf16 v[192:195], v[132:135], v[84:87], v[192:195]
    s_waitcnt vmcnt(14)
    v_mfma_f32_16x16x32_bf16 v[196:199], v[116:119], v[88:91], v[196:199]
    ds_read_b128 v[108:111], v7 offset:3072
    v_mfma_f32_16x16x32_bf16 v[200:203], v[120:123], v[88:91], v[200:203]
    ds_read_b128 v[112:115], v7 offset:4096
    v_mfma_f32_16x16x32_bf16 v[204:207], v[124:127], v[88:91], v[204:207]
    buffer_load_dwordx4 v[56:59], v6, s[20:23], s46 offen sc1
    v_mfma_f32_16x16x32_bf16 v[208:211], v[128:131], v[88:91], v[208:211]
    s_add_u32 s78, s13, s32
    buffer_load_dwordx4 v[64:67], v5, s[24:27], s78 offen sc1
    v_mfma_f32_16x16x32_bf16 v[212:215], v[132:135], v[88:91], v[212:215]
    s_waitcnt vmcnt(14)
    v_mfma_f32_16x16x32_bf16 v[216:219], v[116:119], v[136:139], v[216:219]
    s_cmp_ge_u32 s45, 4
    s_cselect_b32 s77, 4294967292, 3
    s_add_u32 s77, s77, s45
    s_lshl_b32 s78, 256, s77
    s_andn2_b32 s79, s78, s48
    s_cbranch_scc1 FW154
FB155:
    s_lshl1_add_u32 s77, s77, 1
    s_mul_i32 s46, s77, 131072
    s_add_u32 s46, s46, s42
    v_mfma_f32_16x16x32_bf16 v[220:223], v[120:123], v[136:139], v[220:223]
    buffer_load_dwordx4 v[68:71], v1, s[20:23], s46 offen sc1
    v_mfma_f32_16x16x32_bf16 v[224:227], v[124:127], v[136:139], v[224:227]
    buffer_load_dwordx4 v[172:175], v2, s[20:23], s46 offen sc1
    v_mfma_f32_16x16x32_bf16 v[228:231], v[128:131], v[136:139], v[228:231]
    v_mfma_f32_16x16x32_bf16 v[232:235], v[132:135], v[136:139], v[232:235]
    s_waitcnt vmcnt(15)
    v_mfma_f32_16x16x32_bf16 v[236:239], v[116:119], v[140:143], v[236:239]
    buffer_load_dwordx4 v[76:79], v3, s[20:23], s46 offen sc1
    v_mfma_f32_16x16x32_bf16 v[240:243], v[120:123], v[140:143], v[240:243]
    v_mfma_f32_16x16x32_bf16 v[244:247], v[124:127], v[140:143], v[244:247]
    v_mfma_f32_16x16x32_bf16 v[248:251], v[128:131], v[140:143], v[248:251]
    v_mfma_f32_16x16x32_bf16 v[252:255], v[132:135], v[140:143], v[252:255]
    s_waitcnt lgkmcnt(0)
    s_waitcnt vmcnt(14)
    v_mfma_f32_16x16x32_bf16 v[176:179], v[96:99], v[20:23], v[176:179]
    v_mfma_f32_16x16x32_bf16 v[180:183], v[100:103], v[20:23], v[180:183]
    ds_read_b128 v[116:119], v7 offset:10240
    v_mfma_f32_16x16x32_bf16 v[184:187], v[104:107], v[20:23], v[184:187]
    ds_read_b128 v[120:123], v7 offset:11264
    v_mfma_f32_16x16x32_bf16 v[188:191], v[108:111], v[20:23], v[188:191]
    ds_read_b128 v[124:127], v7 offset:12288
    v_mfma_f32_16x16x32_bf16 v[192:195], v[112:115], v[20:23], v[192:195]
    s_waitcnt vmcnt(13)
    v_mfma_f32_16x16x32_bf16 v[196:199], v[96:99], v[28:31], v[196:199]
    ds_read_b128 v[128:131], v7 offset:13312
    v_mfma_f32_16x16x32_bf16 v[200:203], v[100:103], v[28:31], v[200:203]
    ds_read_b128 v[132:135], v7 offset:14336
    v_mfma_f32_16x16x32_bf16 v[204:207], v[104:107], v[28:31], v[204:207]
    buffer_load_dwordx4 v[84:87], v6, s[20:23], s46 offen sc1
    v_mfma_f32_16x16x32_bf16 v[208:211], v[108:111], v[28:31], v[208:211]
    v_mov_b32 v13, 1
    s_mov_b64 exec, 1
    ds_add_u32 v8, v13 offset:28
    s_mov_b64 exec, -1
    v_mfma_f32_16x16x32_bf16 v[212:215], v[112:115], v[28:31], v[212:215]
    s_waitcnt vmcnt(12)
    v_mfma_f32_16x16x32_bf16 v[216:219], v[96:99], v[152:155], v[216:219]
    s_cmp_ge_u32 s45, 3
    s_cselect_b32 s77, 4294967293, 4
    s_add_u32 s77, s77, s45
    s_lshl_b32 s78, 256, s77
    s_andn2_b32 s79, s78, s48
    s_cbranch_scc1 FW156
FB157:
    s_lshl1_add_u32 s77, s77, 1
    s_mul_i32 s46, s77, 131072
    s_add_u32 s46, s46, s42
    v_mfma_f32_16x16x32_bf16 v[220:223], v[100:103], v[152:155], v[220:223]
    buffer_load_dwordx4 v[88:91], v1, s[20:23], s46 offen sc1
    v_mfma_f32_16x16x32_bf16 v[224:227], v[104:107], v[152:155], v[224:227]
    s_cmp_ge_u32 s45, 2
    s_cselect_b32 s77, 4294967294, 5
    s_add_u32 s77, s77, s45
    s_lshl_b32 s78, 256, s77
    s_andn2_b32 s79, s78, s48
    s_cbranch_scc1 FW158
FB159:
    s_lshl1_add_u32 s77, s77, 1
    s_mul_i32 s34, s77, 131072
    s_add_u32 s34, s34, s42
    v_mfma_f32_16x16x32_bf16 v[228:231], v[108:111], v[152:155], v[228:231]
    buffer_load_dwordx4 v[136:139], v1, s[20:23], s34 offen sc1
    v_mfma_f32_16x16x32_bf16 v[232:235], v[112:115], v[152:155], v[232:235]
    s_waitcnt vmcnt(13)
    v_mfma_f32_16x16x32_bf16 v[236:239], v[96:99], v[156:159], v[236:239]
    s_cmp_ge_u32 s45, 1
    s_cselect_b32 s77, 4294967295, 6
    s_add_u32 s77, s77, s45
    s_lshl_b32 s78, 256, s77
    s_andn2_b32 s79, s78, s48
    s_cbranch_scc1 FW160
FB161:
    s_lshl1_add_u32 s77, s77, 1
    s_mul_i32 s35, s77, 131072
    s_add_u32 s35, s35, s42
    v_mfma_f32_16x16x32_bf16 v[240:243], v[100:103], v[156:159], v[240:243]
    buffer_load_dwordx4 v[140:143], v1, s[20:23], s35 offen sc1
    v_mfma_f32_16x16x32_bf16 v[244:247], v[104:107], v[156:159], v[244:247]
    v_mfma_f32_16x16x32_bf16 v[248:251], v[108:111], v[156:159], v[248:251]
    v_mfma_f32_16x16x32_bf16 v[252:255], v[112:115], v[156:159], v[252:255]
    s_waitcnt lgkmcnt(1)
    s_waitcnt vmcnt(12)
    v_mfma_f32_16x16x32_bf16 v[176:179], v[116:119], v[40:43], v[176:179]
    v_mfma_f32_16x16x32_bf16 v[180:183], v[120:123], v[40:43], v[180:183]
    ds_read_b128 v[96:99], v7 offset:15360
    v_mfma_f32_16x16x32_bf16 v[184:187], v[124:127], v[40:43], v[184:187]
    ds_read_b128 v[100:103], v7 offset:16384
    v_mfma_f32_16x16x32_bf16 v[188:191], v[128:131], v[40:43], v[188:191]
    ds_read_b128 v[104:107], v7 offset:17408
    v_mfma_f32_16x16x32_bf16 v[192:195], v[132:135], v[40:43], v[192:195]
    s_waitcnt vmcnt(11)
    v_mfma_f32_16x16x32_bf16 v[196:199], v[116:119], v[48:51], v[196:199]
    ds_read_b128 v[108:111], v7 offset:18432
    v_mfma_f32_16x16x32_bf16 v[200:203], v[120:123], v[48:51], v[200:203]
    ds_read_b128 v[112:115], v7 offset:19456
    v_mfma_f32_16x16x32_bf16 v[204:207], v[124:127], v[48:51], v[204:207]
    buffer_load_dwordx4 v[20:23], v2, s[20:23], s46 offen sc1
    v_mfma_f32_16x16x32_bf16 v[208:211], v[128:131], v[48:51], v[208:211]
    buffer_load_dwordx4 v[28:31], v2, s[20:23], s34 offen sc1
    v_mfma_f32_16x16x32_bf16 v[212:215], v[132:135], v[48:51], v[212:215]
    s_waitcnt vmcnt(11)
    v_mfma_f32_16x16x32_bf16 v[216:219], v[116:119], v[168:171], v[216:219]
    buffer_load_dwordx4 v[152:155], v2, s[20:23], s35 offen sc1
    v_mfma_f32_16x16x32_bf16 v[220:223], v[120:123], v[168:171], v[220:223]
    v_mfma_f32_16x16x32_bf16 v[224:227], v[124:127], v[168:171], v[224:227]
    v_mfma_f32_16x16x32_bf16 v[228:231], v[128:131], v[168:171], v[228:231]
    v_mfma_f32_16x16x32_bf16 v[232:235], v[132:135], v[168:171], v[232:235]
    s_waitcnt vmcnt(11)
    v_mfma_f32_16x16x32_bf16 v[236:239], v[116:119], v[56:59], v[236:239]
    buffer_load_dwordx4 v[156:159], v3, s[20:23], s46 offen sc1
    v_mfma_f32_16x16x32_bf16 v[240:243], v[120:123], v[56:59], v[240:243]
    v_mfma_f32_16x16x32_bf16 v[244:247], v[124:127], v[56:59], v[244:247]
    v_mfma_f32_16x16x32_bf16 v[248:251], v[128:131], v[56:59], v[248:251]
    v_mfma_f32_16x16x32_bf16 v[252:255], v[132:135], v[56:59], v[252:255]
    s_waitcnt lgkmcnt(0)
    s_waitcnt vmcnt(10)
    v_mfma_f32_16x16x32_bf16 v[176:179], v[96:99], v[68:71], v[176:179]
    buffer_load_dwordx4 v[116:119], v3, s[20:23], s34 offen sc1
    v_mfma_f32_16x16x32_bf16 v[180:183], v[100:103], v[68:71], v[180:183]
    v_mfma_f32_16x16x32_bf16 v[184:187], v[104:107], v[68:71], v[184:187]
    v_mfma_f32_16x16x32_bf16 v[188:191], v[108:111], v[68:71], v[188:191]
    v_mfma_f32_16x16x32_bf16 v[192:195], v[112:115], v[68:71], v[192:195]
    s_waitcnt vmcnt(10)
    v_mfma_f32_16x16x32_bf16 v[196:199], v[96:99], v[172:175], v[196:199]
    buffer_load_dwordx4 v[120:123], v3, s[20:23], s35 offen sc1
    v_mfma_f32_16x16x32_bf16 v[200:203], v[100:103], v[172:175], v[200:203]
    v_mfma_f32_16x16x32_bf16 v[204:207], v[104:107], v[172:175], v[204:207]
    v_mfma_f32_16x16x32_bf16 v[208:211], v[108:111], v[172:175], v[208:211]
    v_mfma_f32_16x16x32_bf16 v[212:215], v[112:115], v[172:175], v[212:215]
    s_waitcnt vmcnt(10)
    v_mfma_f32_16x16x32_bf16 v[216:219], v[96:99], v[76:79], v[216:219]
    buffer_load_dwordx4 v[124:127], v6, s[20:23], s46 offen sc1
    v_mfma_f32_16x16x32_bf16 v[220:223], v[100:103], v[76:79], v[220:223]
    v_mfma_f32_16x16x32_bf16 v[224:227], v[104:107], v[76:79], v[224:227]
    v_mfma_f32_16x16x32_bf16 v[228:231], v[108:111], v[76:79], v[228:231]
    v_mfma_f32_16x16x32_bf16 v[232:235], v[112:115], v[76:79], v[232:235]
    s_waitcnt vmcnt(10)
    v_mfma_f32_16x16x32_bf16 v[236:239], v[96:99], v[84:87], v[236:239]
    buffer_load_dwordx4 v[128:131], v6, s[20:23], s34 offen sc1
    v_mfma_f32_16x16x32_bf16 v[240:243], v[100:103], v[84:87], v[240:243]
    v_mfma_f32_16x16x32_bf16 v[244:247], v[104:107], v[84:87], v[244:247]
    v_mfma_f32_16x16x32_bf16 v[248:251], v[108:111], v[84:87], v[248:251]
    v_mfma_f32_16x16x32_bf16 v[252:255], v[112:115], v[84:87], v[252:255]
    s_waitcnt vmcnt(10)
    v_mfma_f32_16x16x32_bf16 v[176:179], v[144:147], v[88:91], v[176:179]
    buffer_load_dwordx4 v[96:99], v6, s[20:23], s35 offen sc1
    v_mfma_f32_16x16x32_bf16 v[180:183], v[24:27], v[88:91], v[180:183]
    v_mfma_f32_16x16x32_bf16 v[184:187], v[148:151], v[88:91], v[184:187]
    v_mfma_f32_16x16x32_bf16 v[188:191], v[160:163], v[88:91], v[188:191]
    v_mfma_f32_16x16x32_bf16 v[192:195], v[44:47], v[88:91], v[192:195]
    s_waitcnt vmcnt(10)
    v_mfma_f32_16x16x32_bf16 v[176:179], v[164:167], v[136:139], v[176:179]
    v_mfma_f32_16x16x32_bf16 v[180:183], v[60:63], v[136:139], v[180:183]
    v_mfma_f32_16x16x32_bf16 v[184:187], v[72:75], v[136:139], v[184:187]
    v_mfma_f32_16x16x32_bf16 v[188:191], v[80:83], v[136:139], v[188:191]
    v_mfma_f32_16x16x32_bf16 v[192:195], v[92:95], v[136:139], v[192:195]
    s_waitcnt vmcnt(9)
    v_mfma_f32_16x16x32_bf16 v[176:179], v[16:19], v[140:143], v[176:179]
    v_mfma_f32_16x16x32_bf16 v[180:183], v[32:35], v[140:143], v[180:183]
    v_mfma_f32_16x16x32_bf16 v[184:187], v[36:39], v[140:143], v[184:187]
    v_mfma_f32_16x16x32_bf16 v[188:191], v[52:55], v[140:143], v[188:191]
    v_mfma_f32_16x16x32_bf16 v[192:195], v[64:67], v[140:143], v[192:195]
    s_waitcnt vmcnt(8)
    v_mfma_f32_16x16x32_bf16 v[196:199], v[144:147], v[20:23], v[196:199]
    v_mfma_f32_16x16x32_bf16 v[200:203], v[24:27], v[20:23], v[200:203]
    v_mfma_f32_16x16x32_bf16 v[204:207], v[148:151], v[20:23], v[204:207]
    v_mfma_f32_16x16x32_bf16 v[208:211], v[160:163], v[20:23], v[208:211]
    v_mfma_f32_16x16x32_bf16 v[212:215], v[44:47], v[20:23], v[212:215]
    s_waitcnt vmcnt(7)
    v_mfma_f32_16x16x32_bf16 v[196:199], v[164:167], v[28:31], v[196:199]
    ds_write_b128 v7, v[176:179] offset:0
    v_mfma_f32_16x16x32_bf16 v[200:203], v[60:63], v[28:31], v[200:203]
    ds_write_b128 v7, v[180:183] offset:1024
    v_mfma_f32_16x16x32_bf16 v[204:207], v[72:75], v[28:31], v[204:207]
    v_mfma_f32_16x16x32_bf16 v[208:211], v[80:83], v[28:31], v[208:211]
    v_mfma_f32_16x16x32_bf16 v[212:215], v[92:95], v[28:31], v[212:215]
    s_waitcnt vmcnt(6)
    v_mfma_f32_16x16x32_bf16 v[196:199], v[16:19], v[152:155], v[196:199]
    ds_write_b128 v7, v[184:187] offset:2048
    v_mfma_f32_16x16x32_bf16 v[200:203], v[32:35], v[152:155], v[200:203]
    ds_write_b128 v7, v[188:191] offset:3072
    v_mfma_f32_16x16x32_bf16 v[204:207], v[36:39], v[152:155], v[204:207]
    v_mfma_f32_16x16x32_bf16 v[208:211], v[52:55], v[152:155], v[208:211]
    v_mfma_f32_16x16x32_bf16 v[212:215], v[64:67], v[152:155], v[212:215]
    s_waitcnt vmcnt(5)
    v_mfma_f32_16x16x32_bf16 v[216:219], v[144:147], v[156:159], v[216:219]
    ds_write_b128 v7, v[192:195] offset:4096
    v_mfma_f32_16x16x32_bf16 v[220:223], v[24:27], v[156:159], v[220:223]
    v_mfma_f32_16x16x32_bf16 v[224:227], v[148:151], v[156:159], v[224:227]
    v_mfma_f32_16x16x32_bf16 v[228:231], v[160:163], v[156:159], v[228:231]
    v_mfma_f32_16x16x32_bf16 v[232:235], v[44:47], v[156:159], v[232:235]
    s_waitcnt vmcnt(4)
    v_mfma_f32_16x16x32_bf16 v[216:219], v[164:167], v[116:119], v[216:219]
    ds_write_b128 v7, v[196:199] offset:5120
    v_mfma_f32_16x16x32_bf16 v[220:223], v[60:63], v[116:119], v[220:223]
    ds_write_b128 v7, v[200:203] offset:6144
    v_mfma_f32_16x16x32_bf16 v[224:227], v[72:75], v[116:119], v[224:227]
    v_mfma_f32_16x16x32_bf16 v[228:231], v[80:83], v[116:119], v[228:231]
    v_mfma_f32_16x16x32_bf16 v[232:235], v[92:95], v[116:119], v[232:235]
    ds_write_b128 v7, v[204:207] offset:7168
    ds_write_b128 v7, v[208:211] offset:8192
    s_waitcnt vmcnt(3)
    v_mfma_f32_16x16x32_bf16 v[216:219], v[16:19], v[120:123], v[216:219]
    v_mbcnt_lo_u32_b32 v9, -1, 0
    v_mbcnt_hi_u32_b32 v9, -1, v9
    v_lshlrev_b32 v3, 4, v9
    v_add_u32 v1, s4, v3
    v_mfma_f32_16x16x32_bf16 v[220:223], v[32:35], v[120:123], v[220:223]
    v_add_u32 v2, s5, v3
    v_add_u32 v3, s6, v3
    v_lshlrev_b32 v5, 3, v9
    v_add_u32 v5, s7, v5
    v_mfma_f32_16x16x32_bf16 v[224:227], v[36:39], v[120:123], v[224:227]
    v_and_b32 v6, 15, v9
    v_mul_u32_u24 v6, 1280, v6
    v_lshrrev_b32 v9, 4, v9
    v_lshl_add_u32 v4, v9, 4, v6
    v_mfma_f32_16x16x32_bf16 v[228:231], v[52:55], v[120:123], v[228:231]
    v_lshl_add_u32 v6, v9, 3, v6
    v_mul_f32 v10, v10, v10
    v_mov_b32 v13, 1
    v_mov_b32 v11, v10
    v_mfma_f32_16x16x32_bf16 v[232:235], v[64:67], v[120:123], v[232:235]
    ds_write_b128 v7, v[212:215] offset:9216
    s_waitcnt vmcnt(2)
    v_mfma_f32_16x16x32_bf16 v[236:239], v[144:147], v[124:127], v[236:239]
    ds_write_b128 v7, v[216:219] offset:10240
    v_mfma_f32_16x16x32_bf16 v[240:243], v[24:27], v[124:127], v[240:243]
    ds_write_b128 v7, v[220:223] offset:11264
    v_mfma_f32_16x16x32_bf16 v[244:247], v[148:151], v[124:127], v[244:247]
    ds_write_b128 v7, v[224:227] offset:12288
    v_mfma_f32_16x16x32_bf16 v[248:251], v[160:163], v[124:127], v[248:251]
    ds_write_b128 v7, v[228:231] offset:13312
    v_mfma_f32_16x16x32_bf16 v[252:255], v[44:47], v[124:127], v[252:255]
    ds_write_b128 v7, v[232:235] offset:14336
    s_mov_b64 exec, 1
    s_waitcnt lgkmcnt(14)
    ds_add_rtn_u32 v12, v8, v13 offset:88
    s_mov_b64 exec, -1
    s_waitcnt vmcnt(1)
    v_mfma_f32_16x16x32_bf16 v[236:239], v[164:167], v[128:131], v[236:239]
    s_waitcnt lgkmcnt(14)
    ds_read_b128 v[144:147], v1 offset:0
    s_waitcnt lgkmcnt(14)
    ds_read_b128 v[24:27], v2 offset:0
    s_waitcnt lgkmcnt(14)
    ds_read_b128 v[148:151], v3 offset:0
    v_mfma_f32_16x16x32_bf16 v[240:243], v[60:63], v[128:131], v[240:243]
    s_waitcnt lgkmcnt(14)
    ds_read_b128 v[160:163], v1 offset:1024
    s_waitcnt lgkmcnt(14)
    ds_read_b128 v[44:47], v2 offset:1024
    s_waitcnt lgkmcnt(14)
    ds_read_b128 v[100:103], v3 offset:1024
    v_mfma_f32_16x16x32_bf16 v[244:247], v[72:75], v[128:131], v[244:247]
    s_waitcnt lgkmcnt(14)
    ds_read_b128 v[104:107], v1 offset:2048
    s_waitcnt lgkmcnt(14)
    ds_read_b128 v[108:111], v2 offset:2048
    s_waitcnt lgkmcnt(14)
    ds_read_b128 v[112:115], v3 offset:2048
    v_mfma_f32_16x16x32_bf16 v[248:251], v[80:83], v[128:131], v[248:251]
    s_waitcnt lgkmcnt(14)
    ds_read_b128 v[132:135], v1 offset:3072
    s_waitcnt lgkmcnt(14)
    ds_read_b128 v[40:43], v2 offset:3072
    s_waitcnt lgkmcnt(14)
    ds_read_b128 v[48:51], v3 offset:3072
    v_mfma_f32_16x16x32_bf16 v[252:255], v[92:95], v[128:131], v[252:255]
    s_waitcnt lgkmcnt(14)
    ds_read_b128 v[168:171], v1 offset:4096
    s_waitcnt lgkmcnt(14)
    ds_read_b128 v[56:59], v2 offset:4096
    s_waitcnt lgkmcnt(14)
    ds_read_b128 v[68:71], v3 offset:4096
    s_waitcnt vmcnt(0)
    v_mfma_f32_16x16x32_bf16 v[236:239], v[16:19], v[96:99], v[236:239]
    s_waitcnt lgkmcnt(14)
    ds_read_b32 v14, v8 offset:92
    s_waitcnt lgkmcnt(14)
    ds_read_b64 v[172:173], v5 offset:0
    v_mfma_f32_16x16x32_bf16 v[240:243], v[32:35], v[96:99], v[240:243]
    s_waitcnt lgkmcnt(14)
    ds_read_b64 v[174:175], v5 offset:512
    s_waitcnt lgkmcnt(14)
    ds_read_b64 v[76:77], v5 offset:1024
    v_mfma_f32_16x16x32_bf16 v[244:247], v[36:39], v[96:99], v[244:247]
    s_waitcnt lgkmcnt(14)
    ds_read_b64 v[78:79], v5 offset:1536
    s_waitcnt lgkmcnt(14)
    ds_read_b64 v[84:85], v5 offset:2048
    v_mfma_f32_16x16x32_bf16 v[248:251], v[52:55], v[96:99], v[248:251]
    v_mfma_f32_16x16x32_bf16 v[252:255], v[64:67], v[96:99], v[252:255]
    v_readfirstlane_b32 s77, v12
    s_cmp_lt_u32 s77, 3
    s_cbranch_scc1 RS162
RB163:
    v_pk_add_f32 v[24:25], v[24:25], v[148:149]
    v_pk_add_f32 v[26:27], v[26:27], v[150:151]
    v_pk_add_f32 v[144:145], v[144:145], v[24:25]
    v_pk_add_f32 v[146:147], v[146:147], v[26:27]
    v_pk_add_f32 v[44:45], v[44:45], v[100:101]
    v_pk_add_f32 v[46:47], v[46:47], v[102:103]
    v_pk_add_f32 v[160:161], v[160:161], v[44:45]
    v_pk_add_f32 v[162:163], v[162:163], v[46:47]
    s_waitcnt lgkmcnt(12)
    v_pk_add_f32 v[108:109], v[108:109], v[112:113]
    v_pk_add_f32 v[110:111], v[110:111], v[114:115]
    v_pk_add_f32 v[104:105], v[104:105], v[108:109]
    v_pk_add_f32 v[106:107], v[106:107], v[110:111]
    s_waitcnt lgkmcnt(9)
    v_pk_add_f32 v[40:41], v[40:41], v[48:49]
    v_pk_add_f32 v[42:43], v[42:43], v[50:51]
    v_pk_add_f32 v[132:133], v[132:133], v[40:41]
    v_pk_add_f32 v[134:135], v[134:135], v[42:43]
    s_waitcnt lgkmcnt(6)
    v_pk_add_f32 v[56:57], v[56:57], v[68:69]
    v_pk_add_f32 v[58:59], v[58:59], v[70:71]
    v_pk_add_f32 v[168:169], v[168:169], v[56:57]
    v_pk_add_f32 v[170:171], v[170:171], v[58:59]
    s_nop 0
    v_pk_add_f32 v[236:237], v[236:237], v[144:145]
    v_pk_add_f32 v[238:239], v[238:239], v[146:147]
    v_pk_mul_f32 v[236:237], v[236:237], v[10:11]
    v_pk_mul_f32 v[238:239], v[238:239], v[10:11]
    v_cvt_pk_bf16_f32 v236, v236, v237
    v_cvt_pk_bf16_f32 v238, v238, v239
    v_pk_add_f32 v[240:241], v[240:241], v[160:161]
    v_pk_add_f32 v[242:243], v[242:243], v[162:163]
    v_pk_mul_f32 v[240:241], v[240:241], v[10:11]
    v_pk_mul_f32 v[242:243], v[242:243], v[10:11]
    v_cvt_pk_bf16_f32 v240, v240, v241
    v_cvt_pk_bf16_f32 v242, v242, v243
    v_pk_add_f32 v[244:245], v[244:245], v[104:105]
    v_pk_add_f32 v[246:247], v[246:247], v[106:107]
    v_pk_mul_f32 v[244:245], v[244:245], v[10:11]
    v_pk_mul_f32 v[246:247], v[246:247], v[10:11]
    v_cvt_pk_bf16_f32 v244, v244, v245
    v_cvt_pk_bf16_f32 v246, v246, v247
    v_pk_add_f32 v[248:249], v[248:249], v[132:133]
    v_pk_add_f32 v[250:251], v[250:251], v[134:135]
    v_pk_mul_f32 v[248:249], v[248:249], v[10:11]
    v_pk_mul_f32 v[250:251], v[250:251], v[10:11]
    v_cvt_pk_bf16_f32 v248, v248, v249
    v_cvt_pk_bf16_f32 v250, v250, v251
    v_pk_add_f32 v[252:253], v[252:253], v[168:169]
    v_pk_add_f32 v[254:255], v[254:255], v[170:171]
    v_pk_mul_f32 v[252:253], v[252:253], v[10:11]
    v_pk_mul_f32 v[254:255], v[254:255], v[10:11]
    v_cvt_pk_bf16_f32 v252, v252, v253
    v_cvt_pk_bf16_f32 v254, v254, v255
    s_waitcnt lgkmcnt(0)
    v_cmp_gt_u32 vcc, 4, v14
    s_cbranch_vccnz TS164
TB165:
    v_and_b32 v145, s10, v236
    v_lshlrev_b32 v144, 16, v236
    v_and_b32 v25, s10, v172
    v_lshlrev_b32 v24, 16, v172
    v_and_b32 v147, s10, v238
    v_lshlrev_b32 v146, 16, v238
    v_and_b32 v27, s10, v173
    v_lshlrev_b32 v26, 16, v173
    v_pk_add_f32 v[144:145], v[144:145], v[24:25]
    v_pk_add_f32 v[146:147], v[146:147], v[26:27]
    v_cvt_pk_bf16_f32 v236, v144, v145
    v_cvt_pk_bf16_f32 v237, v146, v147
    v_and_b32 v161, s10, v240
    v_lshlrev_b32 v160, 16, v240
    v_and_b32 v45, s10, v174
    v_lshlrev_b32 v44, 16, v174
    v_and_b32 v163, s10, v242
    v_lshlrev_b32 v162, 16, v242
    v_and_b32 v47, s10, v175
    v_lshlrev_b32 v46, 16, v175
    v_pk_add_f32 v[160:161], v[160:161], v[44:45]
    v_pk_add_f32 v[162:163], v[162:163], v[46:47]
    v_cvt_pk_bf16_f32 v238, v160, v161
    v_cvt_pk_bf16_f32 v239, v162, v163
    buffer_store_dwordx4 v[236:239], v4, s[28:31], s8 offen offset:0 sc1
    v_and_b32 v105, s10, v244
    v_lshlrev_b32 v104, 16, v244
    v_and_b32 v109, s10, v76
    v_lshlrev_b32 v108, 16, v76
    v_and_b32 v107, s10, v246
    v_lshlrev_b32 v106, 16, v246
    v_and_b32 v111, s10, v77
    v_lshlrev_b32 v110, 16, v77
    v_pk_add_f32 v[104:105], v[104:105], v[108:109]
    v_pk_add_f32 v[106:107], v[106:107], v[110:111]
    v_cvt_pk_bf16_f32 v244, v104, v105
    v_cvt_pk_bf16_f32 v245, v106, v107
    v_and_b32 v133, s10, v248
    v_lshlrev_b32 v132, 16, v248
    v_and_b32 v41, s10, v78
    v_lshlrev_b32 v40, 16, v78
    v_and_b32 v135, s10, v250
    v_lshlrev_b32 v134, 16, v250
    v_and_b32 v43, s10, v79
    v_lshlrev_b32 v42, 16, v79
    v_pk_add_f32 v[132:133], v[132:133], v[40:41]
    v_pk_add_f32 v[134:135], v[134:135], v[42:43]
    v_cvt_pk_bf16_f32 v246, v132, v133
    v_cvt_pk_bf16_f32 v247, v134, v135
    buffer_store_dwordx4 v[244:247], v4, s[28:31], s8 offen offset:64 sc1
    v_and_b32 v169, s10, v252
    v_lshlrev_b32 v168, 16, v252
    v_and_b32 v57, s10, v84
    v_lshlrev_b32 v56, 16, v84
    v_and_b32 v171, s10, v254
    v_lshlrev_b32 v170, 16, v254
    v_and_b32 v59, s10, v85
    v_lshlrev_b32 v58, 16, v85
    v_pk_add_f32 v[168:169], v[168:169], v[56:57]
    v_pk_add_f32 v[170:171], v[170:171], v[58:59]
    v_cvt_pk_bf16_f32 v252, v168, v169
    v_cvt_pk_bf16_f32 v253, v170, v171
    buffer_store_dwordx2 v[252:253], v6, s[28:31], s9 offen sc1
    s_endpgm
RS162:
    s_mov_b32 s83, 200000
SPL166:
    ds_read_b32 v12, v8 offset:88
    s_waitcnt lgkmcnt(0)
    s_nop 0
    v_readfirstlane_b32 s82, v12
    s_sub_u32 s83, s83, 1
    s_cselect_b32 s82, -1, s82
    s_cmp_ge_u32 s82, 4
    s_cbranch_scc1 SPD167
    s_branch SPL166
SPD167:
    ds_read_b128 v[144:147], v1 offset:0
    ds_read_b128 v[24:27], v2 offset:0
    ds_read_b128 v[148:151], v3 offset:0
    ds_read_b128 v[160:163], v1 offset:1024
    ds_read_b128 v[44:47], v2 offset:1024
    ds_read_b128 v[100:103], v3 offset:1024
    ds_read_b128 v[104:107], v1 offset:2048
    ds_read_b128 v[108:111], v2 offset:2048
    ds_read_b128 v[112:115], v3 offset:2048
    ds_read_b128 v[132:135], v1 offset:3072
    ds_read_b128 v[40:43], v2 offset:3072
    ds_read_b128 v[48:51], v3 offset:3072
    ds_read_b128 v[168:171], v1 offset:4096
    ds_read_b128 v[56:59], v2 offset:4096
    ds_read_b128 v[68:71], v3 offset:4096
    s_waitcnt lgkmcnt(14)
    ds_read_b32 v14, v8 offset:92
    s_waitcnt lgkmcnt(0)
    ds_read_b64 v[172:173], v5 offset:0
    ds_read_b64 v[174:175], v5 offset:512
    ds_read_b64 v[76:77], v5 offset:1024
    ds_read_b64 v[78:79], v5 offset:1536
    ds_read_b64 v[84:85], v5 offset:2048
    s_branch RB163
TS164:
    s_mov_b32 s83, 200000
SPL168:
    ds_read_b32 v14, v8 offset:92
    s_waitcnt lgkmcnt(0)
    s_nop 0
    v_readfirstlane_b32 s82, v14
    s_sub_u32 s83, s83, 1
    s_cselect_b32 s82, -1, s82
    s_cmp_ge_u32 s82, 4
    s_cbranch_scc1 SPD169
    s_branch SPL168
SPD169:
    ds_read_b64 v[172:173], v5 offset:0
    ds_read_b64 v[174:175], v5 offset:512
    ds_read_b64 v[76:77], v5 offset:1024
    ds_read_b64 v[78:79], v5 offset:1536
    ds_read_b64 v[84:85], v5 offset:2048
    s_waitcnt lgkmcnt(0)
    s_branch TB165
L_G2T:
    s_lshl_b32 s77, s40, 2
    v_add_u32 v13, s77, v8
    s_mov_b32 s83, 200000
SPL170:
    ds_read_b32 v12, v13 offset:56
    s_waitcnt lgkmcnt(0)
    s_nop 0
    v_readfirstlane_b32 s82, v12
    s_sub_u32 s83, s83, 1
    s_cselect_b32 s82, -1, s82
    s_cmp_ge_u32 s82, 2
    s_cbranch_scc1 SPD171
    s_sleep 4
    s_branch SPL170
SPD171:
    s_cmp_ge_u32 s45, 6
    s_cselect_b32 s77, 4294967290, 0
    s_add_u32 s77, s77, s45
    s_lshl1_add_u32 s77, s77, 1
    s_mul_i32 s77, s77, 40960
    s_add_u32 s77, s77, s41
    s_add_u32 s78, s77, s32
    s_add_u32 m0, s47, 5120
    s_nop 0
    buffer_load_dwordx4 v5, s[24:27], s77 offen offset:0 sc1 lds
    s_add_u32 m0, s47, 5888
    s_nop 0
    buffer_load_dwordx4 v5, s[24:27], s77 offen offset:256 sc1 lds
    s_add_u32 m0, s47, 6656
    s_nop 0
    buffer_load_dwordx4 v5, s[24:27], s77 offen offset:512 sc1 lds
    global_load_dword v11, v14, s[50:51]
    s_add_u32 m0, s47, 7424
    s_nop 0
    buffer_load_dwordx4 v5, s[24:27], s77 offen offset:768 sc1 lds
    s_add_u32 m0, s47, 9216
    s_nop 0
    buffer_load_dwordx4 v5, s[24:27], s78 offen sc1 lds
    s_waitcnt vmcnt(7)
    s_cmp_ge_u32 s45, 5
    s_cselect_b32 s77, 4294967291, 1
    s_add_u32 s77, s77, s45
    s_lshl1_add_u32 s77, s77, 1
    s_mul_i32 s77, s77, 40960
    s_add_u32 s77, s77, s41
    s_add_u32 s78, s77, s32
    s_add_u32 m0, s36, 0
    s_nop 0
    buffer_load_dwordx4 v5, s[24:27], s77 offen offset:0 sc1 lds
    global_load_dword v11, v14, s[50:51]
    s_add_u32 m0, s36, 768
    s_nop 0
    buffer_load_dwordx4 v5, s[24:27], s77 offen offset:256 sc1 lds
    s_add_u32 m0, s36, 1536
    s_nop 0
    buffer_load_dwordx4 v5, s[24:27], s77 offen offset:512 sc1 lds
    s_add_u32 m0, s36, 2304
    s_nop 0
    buffer_load_dwordx4 v5, s[24:27], s77 offen offset:768 sc1 lds
    global_load_dword v11, v14, s[50:51]
    s_add_u32 m0, s36, 4096
    s_nop 0
    buffer_load_dwordx4 v5, s[24:27], s78 offen sc1 lds
    s_mov_b32 s83, 200000
SPL172:
    ds_read_b32 v12, v8 offset:112
    s_waitcnt lgkmcnt(0)
    s_nop 0
    v_readfirstlane_b32 s82, v12
    s_sub_u32 s83, s83, 1
    s_cselect_b32 s82, -1, s82
    s_cmp_ge_u32 s82, 4
    s_cbranch_scc1 SPD173
    s_sleep 2
    s_branch SPL172
SPD173:
    s_cmp_lg_u32 s3, 7
    s_cbranch_scc1 L_NCT
    s_getpc_b64 s[52:53]
L_CT2:
    s_sub_u32 s52, s52, L_CT2-L_G2
    s_subb_u32 s53, s53, 0
    v_lshlrev_b32 v12, 7, v0
    v_min_u32 v12, L_TABLE-L_G2, v12
    global_load_dword v11, v12, s[52:53]
    v_add_u32 v12, 8192, v12
    v_min_u32 v12, L_TABLE-L_G2, v12
    global_load_dword v11, v12, s[52:53]
    v_add_u32 v12, 8192, v12
    v_min_u32 v12, L_TABLE-L_G2, v12
    global_load_dword v11, v12, s[52:53]
    v_add_u32 v12, 8192, v12
    v_min_u32 v12, L_TABLE-L_G2, v12
    global_load_dword v11, v12, s[52:53]
    v_add_u32 v12, 8192, v12
    v_min_u32 v12, L_TABLE-L_G2, v12
    global_load_dword v11, v12, s[52:53]
    v_add_u32 v12, 8192, v12
L_NCT:
    s_waitcnt vmcnt(7)
    s_cmp_ge_u32 s45, 4
    s_cselect_b32 s77, 4294967292, 2
    s_add_u32 s77, s77, s45
    s_lshl1_add_u32 s77, s77, 1
    s_mul_i32 s77, s77, 40960
    s_add_u32 s77, s77, s41
    s_add_u32 s78, s77, s32
    s_add_u32 m0, s47, 0
    s_nop 0
    buffer_load_dwordx4 v5, s[24:27], s77 offen offset:0 sc1 lds
    s_add_u32 m0, s47, 768
    s_nop 0
    buffer_load_dwordx4 v5, s[24:27], s77 offen offset:256 sc1 lds
    global_load_dword v11, v14, s[50:51]
    s_add_u32 m0, s47, 1536
    s_nop 0
    buffer_load_dwordx4 v5, s[24:27], s77 offen offset:512 sc1 lds
    s_add_u32 m0, s47, 2304
    s_nop 0
    buffer_load_dwordx4 v5, s[24:27], s77 offen offset:768 sc1 lds
    s_add_u32 m0, s47, 4096
    s_nop 0
    buffer_load_dwordx4 v5, s[24:27], s78 offen sc1 lds
    global_load_dword v11, v14, s[50:51]
    s_waitcnt vmcnt(7)
    s_cmp_ge_u32 s45, 3
    s_cselect_b32 s77, 4294967293, 3
    s_add_u32 s77, s77, s45
    s_lshl1_add_u32 s77, s77, 1
    s_mul_i32 s77, s77, 40960
    s_add_u32 s77, s77, s41
    s_add_u32 s78, s77, s32
    s_add_u32 m0, s47, 10240
    s_nop 0
    buffer_load_dwordx4 v5, s[24:27], s77 offen offset:0 sc1 lds
    s_add_u32 m0, s47, 11008
    s_nop 0
    buffer_load_dwordx4 v5, s[24:27], s77 offen offset:256 sc1 lds
    s_add_u32 m0, s47, 11776
    s_nop 0
    buffer_load_dwordx4 v5, s[24:27], s77 offen offset:512 sc1 lds
    global_load_dword v11, v14, s[50:51]
    s_add_u32 m0, s47, 12544
    s_nop 0
    buffer_load_dwordx4 v5, s[24:27], s77 offen offset:768 sc1 lds
    s_add_u32 m0, s47, 14336
    s_nop 0
    buffer_load_dwordx4 v5, s[24:27], s78 offen sc1 lds
    s_waitcnt vmcnt(7)
    s_cmp_ge_u32 s45, 2
    s_cselect_b32 s77, 4294967294, 4
    s_add_u32 s77, s77, s45
    s_lshl1_add_u32 s77, s77, 1
    s_mul_i32 s77, s77, 40960
    s_add_u32 s77, s77, s41
    s_add_u32 s78, s77, s32
    s_add_u32 m0, s47, 15360
    s_nop 0
    buffer_load_dwordx4 v5, s[24:27], s77 offen offset:0 sc1 lds
    global_load_dword v11, v14, s[50:51]
    s_add_u32 m0, s47, 16128
    s_nop 0
    buffer_load_dwordx4 v5, s[24:27], s77 offen offset:256 sc1 lds
    s_add_u32 m0, s47, 16896
    s_nop 0
    buffer_load_dwordx4 v5, s[24:27], s77 offen offset:512 sc1 lds
    s_add_u32 m0, s47, 17664
    s_nop 0
    buffer_load_dwordx4 v5, s[24:27], s77 offen offset:768 sc1 lds
    global_load_dword v11, v14, s[50:51]
    s_add_u32 m0, s47, 19456
    s_nop 0
    buffer_load_dwordx4 v5, s[24:27], s78 offen sc1 lds
    s_mov_b32 s48, 0
    s_cmp_ge_u32 s45, 1
    s_cselect_b32 s77, 4294967295, 5
    s_add_u32 s77, s77, s45
    s_lshl1_add_u32 s77, s77, 1
    s_mul_i32 s77, s77, 40960
    s_add_u32 s11, s77, s41
    s_cmp_ge_u32 s45, 6
    s_cselect_b32 s77, 4294967290, 0
    s_add_u32 s77, s77, s45
    s_lshl_b32 s78, 1, s77
    s_andn2_b32 s79, s78, s48
    s_cbranch_scc1 FW174
FB175:
    s_lshl1_add_u32 s77, s77, 0
    s_mul_i32 s46, s77, 131072
    s_add_u32 s46, s46, s42
    buffer_load_dwordx4 v[136:139], v1, s[20:23], s46 offen sc1
    buffer_load_dwordx4 v[140:143], v2, s[20:23], s46 offen sc1
    buffer_load_dwordx4 v[144:147], v3, s[20:23], s46 offen sc1
    buffer_load_dwordx4 v[148:151], v6, s[20:23], s46 offen sc1
    s_cmp_ge_u32 s45, 5
    s_cselect_b32 s77, 4294967291, 1
    s_add_u32 s77, s77, s45
    s_lshl_b32 s78, 1, s77
    s_andn2_b32 s79, s78, s48
    s_cbranch_scc1 FW176
FB177:
    s_lshl1_add_u32 s77, s77, 0
    buffer_load_dword v10, v10, s[16:19], s39 offen sc1
    s_mul_i32 s46, s77, 131072
    s_add_u32 s46, s46, s42
    buffer_load_dwordx4 v[152:155], v1, s[20:23], s46 offen sc1
    buffer_load_dwordx4 v[156:159], v2, s[20:23], s46 offen sc1
    buffer_load_dwordx4 v[160:163], v3, s[20:23], s46 offen sc1
    buffer_load_dwordx4 v[164:167], v6, s[20:23], s46 offen sc1
    s_cmp_ge_u32 s45, 4
    s_cselect_b32 s77, 4294967292, 2
    s_add_u32 s77, s77, s45
    s_lshl_b32 s78, 1, s77
    s_andn2_b32 s79, s78, s48
    s_cbranch_scc1 FW178
FB179:
    s_lshl1_add_u32 s77, s77, 0
    s_mul_i32 s46, s77, 131072
    s_add_u32 s46, s46, s42
    buffer_load_dwordx4 v[168:171], v1, s[20:23], s46 offen sc1
    buffer_load_dwordx4 v[172:175], v2, s[20:23], s46 offen sc1
    s_waitcnt vmcnt(10)
    v_mfma_f32_16x16x32_bf16 v[176:179], v[16:19], v[136:139], 0
    v_mfma_f32_16x16x32_bf16 v[180:183], v[20:23], v[136:139], 0
    v_mfma_f32_16x16x32_bf16 v[184:187], v[24:27], v[136:139], 0
    v_mfma_f32_16x16x32_bf16 v[188:191], v[28:31], v[136:139], 0
    v_mfma_f32_16x16x32_bf16 v[192:195], v[32:35], v[136:139], 0
    s_waitcnt vmcnt(9)
    v_mfma_f32_16x16x32_bf16 v[196:199], v[16:19], v[140:143], 0
    buffer_load_dwordx4 v[136:139], v3, s[20:23], s46 offen sc1
    v_mfma_f32_16x16x32_bf16 v[200:203], v[20:23], v[140:143], 0
    v_mfma_f32_16x16x32_bf16 v[204:207], v[24:27], v[140:143], 0
    v_mfma_f32_16x16x32_bf16 v[208:211], v[28:31], v[140:143], 0
    v_mfma_f32_16x16x32_bf16 v[212:215], v[32:35], v[140:143], 0
    s_waitcnt vmcnt(9)
    v_mfma_f32_16x16x32_bf16 v[216:219], v[16:19], v[144:147], 0
    buffer_load_dwordx4 v[140:143], v6, s[20:23], s46 offen sc1
    v_mfma_f32_16x16x32_bf16 v[220:223], v[20:23], v[144:147], 0
    v_mfma_f32_16x16x32_bf16 v[224:227], v[24:27], v[144:147], 0
    v_mfma_f32_16x16x32_bf16 v[228:231], v[28:31], v[144:147], 0
    v_mfma_f32_16x16x32_bf16 v[232:235], v[32:35], v[144:147], 0
    s_waitcnt vmcnt(9)
    v_mfma_f32_16x16x32_bf16 v[236:239], v[16:19], v[148:151], 0
    buffer_load_dwordx4 v[144:147], v5, s[24:27], s11 offen offset:0 sc1
    v_mfma_f32_16x16x32_bf16 v[240:243], v[20:23], v[148:151], 0
    v_mfma_f32_16x16x32_bf16 v[244:247], v[24:27], v[148:151], 0
    v_mfma_f32_16x16x32_bf16 v[248:251], v[28:31], v[148:151], 0
    v_mfma_f32_16x16x32_bf16 v[252:255], v[32:35], v[148:151], 0
    s_waitcnt vmcnt(8)
    v_mfma_f32_16x16x32_bf16 v[176:179], v[36:39], v[152:155], v[176:179]
    s_cmp_ge_u32 s45, 3
    s_cselect_b32 s77, 4294967293, 3
    s_add_u32 s77, s77, s45
    s_lshl_b32 s78, 1, s77
    s_andn2_b32 s79, s78, s48
    s_cbranch_scc1 FW180
FB181:
    s_lshl1_add_u32 s77, s77, 0
    s_mul_i32 s46, s77, 131072
    s_add_u32 s46, s46, s42
    v_mfma_f32_16x16x32_bf16 v[180:183], v[40:43], v[152:155], v[180:183]
    buffer_load_dwordx4 v[16:19], v1, s[20:23], s46 offen sc1
    v_mfma_f32_16x16x32_bf16 v[184:187], v[44:47], v[152:155], v[184:187]
    buffer_load_dwordx4 v[20:23], v2, s[20:23], s46 offen sc1
    v_mfma_f32_16x16x32_bf16 v[188:191], v[48:51], v[152:155], v[188:191]
    buffer_load_dwordx4 v[24:27], v3, s[20:23], s46 offen sc1
    v_mfma_f32_16x16x32_bf16 v[192:195], v[52:55], v[152:155], v[192:195]
    s_waitcnt vmcnt(10)
    v_mfma_f32_16x16x32_bf16 v[196:199], v[36:39], v[156:159], v[196:199]
    buffer_load_dwordx4 v[28:31], v6, s[20:23], s46 offen sc1
    v_mfma_f32_16x16x32_bf16 v[200:203], v[40:43], v[156:159], v[200:203]
    s_cmp_ge_u32 s45, 2
    s_cselect_b32 s77, 4294967294, 4
    s_add_u32 s77, s77, s45
    s_lshl_b32 s78, 1, s77
    s_andn2_b32 s79, s78, s48
    s_cbranch_scc1 FW182
FB183:
    s_lshl1_add_u32 s77, s77, 0
    s_mul_i32 s46, s77, 131072
    s_add_u32 s46, s46, s42
    v_mfma_f32_16x16x32_bf16 v[204:207], v[44:47], v[156:159], v[204:207]
    buffer_load_dwordx4 v[32:35], v1, s[20:23], s46 offen sc1
    v_mfma_f32_16x16x32_bf16 v[208:211], v[48:51], v[156:159], v[208:211]
    v_mfma_f32_16x16x32_bf16 v[212:215], v[52:55], v[156:159], v[212:215]
    s_waitcnt vmcnt(11)
    v_mfma_f32_16x16x32_bf16 v[216:219], v[36:39], v[160:163], v[216:219]
    buffer_load_dwordx4 v[148:151], v5, s[24:27], s11 offen offset:256 sc1
    v_mfma_f32_16x16x32_bf16 v[220:223], v[40:43], v[160:163], v[220:223]
    buffer_load_dwordx4 v[152:155], v2, s[20:23], s46 offen sc1
    v_mfma_f32_16x16x32_bf16 v[224:227], v[44:47], v[160:163], v[224:227]
    v_mfma_f32_16x16x32_bf16 v[228:231], v[48:51], v[160:163], v[228:231]
    v_mfma_f32_16x16x32_bf16 v[232:235], v[52:55], v[160:163], v[232:235]
    s_waitcnt vmcnt(12)
    v_mfma_f32_16x16x32_bf16 v[236:239], v[36:39], v[164:167], v[236:239]
    buffer_load_dwordx4 v[156:159], v3, s[20:23], s46 offen sc1
    v_mfma_f32_16x16x32_bf16 v[240:243], v[40:43], v[164:167], v[240:243]
    v_mfma_f32_16x16x32_bf16 v[244:247], v[44:47], v[164:167], v[244:247]
    v_mfma_f32_16x16x32_bf16 v[248:251], v[48:51], v[164:167], v[248:251]
    v_mfma_f32_16x16x32_bf16 v[252:255], v[52:55], v[164:167], v[252:255]
    s_waitcnt vmcnt(12)
    v_mfma_f32_16x16x32_bf16 v[176:179], v[56:59], v[168:171], v[176:179]
    buffer_load_dwordx4 v[36:39], v6, s[20:23], s46 offen sc1
    v_mfma_f32_16x16x32_bf16 v[180:183], v[60:63], v[168:171], v[180:183]
    v_mfma_f32_16x16x32_bf16 v[184:187], v[64:67], v[168:171], v[184:187]
    v_mfma_f32_16x16x32_bf16 v[188:191], v[68:71], v[168:171], v[188:191]
    v_mfma_f32_16x16x32_bf16 v[192:195], v[72:75], v[168:171], v[192:195]
    s_waitcnt vmcnt(12)
    v_mfma_f32_16x16x32_bf16 v[196:199], v[56:59], v[172:175], v[196:199]
    s_cmp_ge_u32 s45, 1
    s_cselect_b32 s77, 4294967295, 5
    s_add_u32 s77, s77, s45
    s_lshl_b32 s78, 1, s77
    s_andn2_b32 s79, s78, s48
    s_cbranch_scc1 FW184
FB185:
    s_lshl1_add_u32 s77, s77, 0
    s_mul_i32 s46, s77, 131072
    s_add_u32 s46, s46, s42
    v_mfma_f32_16x16x32_bf16 v[200:203], v[60:63], v[172:175], v[200:203]
    buffer_load_dwordx4 v[40:43], v1, s[20:23], s46 offen sc1
    v_mfma_f32_16x16x32_bf16 v[204:207], v[64:67], v[172:175], v[204:207]
    v_mfma_f32_16x16x32_bf16 v[208:211], v[68:71], v[172:175], v[208:211]
    v_mfma_f32_16x16x32_bf16 v[212:215], v[72:75], v[172:175], v[212:215]
    s_waitcnt vmcnt(12)
    v_mfma_f32_16x16x32_bf16 v[216:219], v[56:59], v[136:139], v[216:219]
    buffer_load_dwordx4 v[44:47], v2, s[20:23], s46 offen sc1
    v_mfma_f32_16x16x32_bf16 v[220:223], v[60:63], v[136:139], v[220:223]
    v_mfma_f32_16x16x32_bf16 v[224:227], v[64:67], v[136:139], v[224:227]
    v_mfma_f32_16x16x32_bf16 v[228:231], v[68:71], v[136:139], v[228:231]
    v_mfma_f32_16x16x32_bf16 v[232:235], v[72:75], v[136:139], v[232:235]
    s_waitcnt vmcnt(12)
    v_mfma_f32_16x16x32_bf16 v[236:239], v[56:59], v[140:143], v[236:239]
    buffer_load_dwordx4 v[48:51], v5, s[24:27], s11 offen offset:512 sc1
    v_mfma_f32_16x16x32_bf16 v[240:243], v[60:63], v[140:143], v[240:243]
    buffer_load_dwordx4 v[52:55], v3, s[20:23], s46 offen sc1
    v_mfma_f32_16x16x32_bf16 v[244:247], v[64:67], v[140:143], v[244:247]
    v_mfma_f32_16x16x32_bf16 v[248:251], v[68:71], v[140:143], v[248:251]
    v_mfma_f32_16x16x32_bf16 v[252:255], v[72:75], v[140:143], v[252:255]
    s_waitcnt vmcnt(12)
    v_mfma_f32_16x16x32_bf16 v[176:179], v[76:79], v[16:19], v[176:179]
    buffer_load_dwordx4 v[56:59], v6, s[20:23], s46 offen sc1
    v_mfma_f32_16x16x32_bf16 v[180:183], v[80:83], v[16:19], v[180:183]
    v_mov_b32 v13, 1
    s_mov_b64 exec, 1
    ds_add_u32 v8, v13 offset:24
    s_mov_b64 exec, -1
    v_mfma_f32_16x16x32_bf16 v[184:187], v[84:87], v[16:19], v[184:187]
    v_mfma_f32_16x16x32_bf16 v[188:191], v[88:91], v[16:19], v[188:191]
    v_mfma_f32_16x16x32_bf16 v[192:195], v[92:95], v[16:19], v[192:195]
    s_waitcnt vmcnt(12)
    v_mfma_f32_16x16x32_bf16 v[196:199], v[76:79], v[20:23], v[196:199]
    s_cmp_ge_u32 s45, 6
    s_cselect_b32 s77, 4294967290, 0
    s_add_u32 s77, s77, s45
    s_lshl_b32 s78, 256, s77
    s_andn2_b32 s79, s78, s48
    s_cbranch_scc1 FW186
FB187:
    s_lshl1_add_u32 s77, s77, 1
    s_mul_i32 s46, s77, 131072
    s_add_u32 s46, s46, s42
    v_mfma_f32_16x16x32_bf16 v[200:203], v[80:83], v[20:23], v[200:203]
    buffer_load_dwordx4 v[60:63], v1, s[20:23], s46 offen sc1
    v_mfma_f32_16x16x32_bf16 v[204:207], v[84:87], v[20:23], v[204:207]
    v_mfma_f32_16x16x32_bf16 v[208:211], v[88:91], v[20:23], v[208:211]
    v_mfma_f32_16x16x32_bf16 v[212:215], v[92:95], v[20:23], v[212:215]
    s_waitcnt vmcnt(12)
    v_mfma_f32_16x16x32_bf16 v[216:219], v[76:79], v[24:27], v[216:219]
    buffer_load_dwordx4 v[64:67], v2, s[20:23], s46 offen sc1
    v_mfma_f32_16x16x32_bf16 v[220:223], v[80:83], v[24:27], v[220:223]
    v_mfma_f32_16x16x32_bf16 v[224:227], v[84:87], v[24:27], v[224:227]
    v_mfma_f32_16x16x32_bf16 v[228:231], v[88:91], v[24:27], v[228:231]
    v_mfma_f32_16x16x32_bf16 v[232:235], v[92:95], v[24:27], v[232:235]
    s_waitcnt vmcnt(12)
    v_mfma_f32_16x16x32_bf16 v[236:239], v[76:79], v[28:31], v[236:239]
    buffer_load_dwordx4 v[68:71], v3, s[20:23], s46 offen sc1
    v_mfma_f32_16x16x32_bf16 v[240:243], v[80:83], v[28:31], v[240:243]
    v_mfma_f32_16x16x32_bf16 v[244:247], v[84:87], v[28:31], v[244:247]
    v_mfma_f32_16x16x32_bf16 v[248:251], v[88:91], v[28:31], v[248:251]
    v_mfma_f32_16x16x32_bf16 v[252:255], v[92:95], v[28:31], v[252:255]
    s_waitcnt vmcnt(12)
    v_mfma_f32_16x16x32_bf16 v[176:179], v[96:99], v[32:35], v[176:179]
    buffer_load_dwordx4 v[76:79], v5, s[24:27], s11 offen offset:768 sc1
    v_mfma_f32_16x16x32_bf16 v[180:183], v[100:103], v[32:35], v[180:183]
    buffer_load_dwordx4 v[80:83], v6, s[20:23], s46 offen sc1
    v_mfma_f32_16x16x32_bf16 v[184:187], v[104:107], v[32:35], v[184:187]
    v_mfma_f32_16x16x32_bf16 v[188:191], v[108:111], v[32:35], v[188:191]
    v_mfma_f32_16x16x32_bf16 v[192:195], v[112:115], v[32:35], v[192:195]
    s_waitcnt vmcnt(12)
    v_mfma_f32_16x16x32_bf16 v[196:199], v[96:99], v[152:155], v[196:199]
    s_cmp_ge_u32 s45, 5
    s_cselect_b32 s77, 4294967291, 1
    s_add_u32 s77, s77, s45
    s_lshl_b32 s78, 256, s77
    s_andn2_b32 s79, s78, s48
    s_cbranch_scc1 FW188
FB189:
    s_lshl1_add_u32 s77, s77, 1
    s_mul_i32 s46, s77, 131072
    s_add_u32 s46, s46, s42
    v_mfma_f32_16x16x32_bf16 v[200:203], v[100:103], v[152:155], v[200:203]
    buffer_load_dwordx4 v[84:87], v1, s[20:23], s46 offen sc1
    v_mfma_f32_16x16x32_bf16 v[204:207], v[104:107], v[152:155], v[204:207]
    v_mfma_f32_16x16x32_bf16 v[208:211], v[108:111], v[152:155], v[208:211]
    v_mfma_f32_16x16x32_bf16 v[212:215], v[112:115], v[152:155], v[212:215]
    s_waitcnt vmcnt(12)
    v_mfma_f32_16x16x32_bf16 v[216:219], v[96:99], v[156:159], v[216:219]
    buffer_load_dwordx4 v[88:91], v2, s[20:23], s46 offen sc1
    v_mfma_f32_16x16x32_bf16 v[220:223], v[100:103], v[156:159], v[220:223]
    v_mfma_f32_16x16x32_bf16 v[224:227], v[104:107], v[156:159], v[224:227]
    v_mfma_f32_16x16x32_bf16 v[228:231], v[108:111], v[156:159], v[228:231]
    v_mfma_f32_16x16x32_bf16 v[232:235], v[112:115], v[156:159], v[232:235]
    s_waitcnt vmcnt(12)
    v_mfma_f32_16x16x32_bf16 v[236:239], v[96:99], v[36:39], v[236:239]
    buffer_load_dwordx4 v[92:95], v3, s[20:23], s46 offen sc1
    v_mfma_f32_16x16x32_bf16 v[240:243], v[100:103], v[36:39], v[240:243]
    v_mfma_f32_16x16x32_bf16 v[244:247], v[104:107], v[36:39], v[244:247]
    v_mfma_f32_16x16x32_bf16 v[248:251], v[108:111], v[36:39], v[248:251]
    v_mfma_f32_16x16x32_bf16 v[252:255], v[112:115], v[36:39], v[252:255]
    s_waitcnt vmcnt(12)
    v_mfma_f32_16x16x32_bf16 v[176:179], v[116:119], v[40:43], v[176:179]
    v_mfma_f32_16x16x32_bf16 v[180:183], v[120:123], v[40:43], v[180:183]
    ds_read_b128 v[96:99], v7 offset:5120
    v_mfma_f32_16x16x32_bf16 v[184:187], v[124:127], v[40:43], v[184:187]
    ds_read_b128 v[100:103], v7 offset:6144
    v_mfma_f32_16x16x32_bf16 v[188:191], v[128:131], v[40:43], v[188:191]
    ds_read_b128 v[104:107], v7 offset:7168
    v_mfma_f32_16x16x32_bf16 v[192:195], v[132:135], v[40:43], v[192:195]
    s_waitcnt vmcnt(11)
    v_mfma_f32_16x16x32_bf16 v[196:199], v[116:119], v[44:47], v[196:199]
    ds_read_b128 v[108:111], v7 offset:8192
    v_mfma_f32_16x16x32_bf16 v[200:203], v[120:123], v[44:47], v[200:203]
    ds_read_b128 v[112:115], v7 offset:9216
    v_mfma_f32_16x16x32_bf16 v[204:207], v[124:127], v[44:47], v[204:207]
    buffer_load_dwordx4 v[72:75], v6, s[20:23], s46 offen sc1
    v_mfma_f32_16x16x32_bf16 v[208:211], v[128:131], v[44:47], v[208:211]
    s_add_u32 s78, s11, s32
    buffer_load_dwordx4 v[160:163], v5, s[24:27], s78 offen sc1
    v_mfma_f32_16x16x32_bf16 v[212:215], v[132:135], v[44:47], v[212:215]
    s_waitcnt vmcnt(11)
    v_mfma_f32_16x16x32_bf16 v[216:219], v[116:119], v[52:55], v[216:219]
    s_cmp_ge_u32 s45, 4
    s_cselect_b32 s77, 4294967292, 2
    s_add_u32 s77, s77, s45
    s_lshl_b32 s78, 256, s77
    s_andn2_b32 s79, s78, s48
    s_cbranch_scc1 FW190
FB191:
    s_lshl1_add_u32 s77, s77, 1
    s_mul_i32 s46, s77, 131072
    s_add_u32 s46, s46, s42
    v_mfma_f32_16x16x32_bf16 v[220:223], v[120:123], v[52:55], v[220:223]
    buffer_load_dwordx4 v[164:167], v1, s[20:23], s46 offen sc1
    v_mfma_f32_16x16x32_bf16 v[224:227], v[124:127], v[52:55], v[224:227]
    buffer_load_dwordx4 v[168:171], v2, s[20:23], s46 offen sc1
    v_mfma_f32_16x16x32_bf16 v[228:231], v[128:131], v[52:55], v[228:231]
    v_mfma_f32_16x16x32_bf16 v[232:235], v[132:135], v[52:55], v[232:235]
    s_waitcnt vmcnt(12)
    v_mfma_f32_16x16x32_bf16 v[236:239], v[116:119], v[56:59], v[236:239]
    buffer_load_dwordx4 v[172:175], v3, s[20:23], s46 offen sc1
    v_mfma_f32_16x16x32_bf16 v[240:243], v[120:123], v[56:59], v[240:243]
    v_mfma_f32_16x16x32_bf16 v[244:247], v[124:127], v[56:59], v[244:247]
    v_mfma_f32_16x16x32_bf16 v[248:251], v[128:131], v[56:59], v[248:251]
    v_mfma_f32_16x16x32_bf16 v[252:255], v[132:135], v[56:59], v[252:255]
    s_waitcnt lgkmcnt(0)
    s_waitcnt vmcnt(12)
    v_mfma_f32_16x16x32_bf16 v[176:179], v[96:99], v[60:63], v[176:179]
    v_mfma_f32_16x16x32_bf16 v[180:183], v[100:103], v[60:63], v[180:183]
    ds_read_b128 v[116:119], v4 offset:0
    v_mfma_f32_16x16x32_bf16 v[184:187], v[104:107], v[60:63], v[184:187]
    ds_read_b128 v[120:123], v4 offset:1024
    v_mfma_f32_16x16x32_bf16 v[188:191], v[108:111], v[60:63], v[188:191]
    ds_read_b128 v[124:127], v4 offset:2048
    v_mfma_f32_16x16x32_bf16 v[192:195], v[112:115], v[60:63], v[192:195]
    s_waitcnt vmcnt(11)
    v_mfma_f32_16x16x32_bf16 v[196:199], v[96:99], v[64:67], v[196:199]
    ds_read_b128 v[128:131], v4 offset:3072
    v_mfma_f32_16x16x32_bf16 v[200:203], v[100:103], v[64:67], v[200:203]
    ds_read_b128 v[132:135], v4 offset:4096
    v_mfma_f32_16x16x32_bf16 v[204:207], v[104:107], v[64:67], v[204:207]
    buffer_load_dwordx4 v[136:139], v6, s[20:23], s46 offen sc1
    v_mfma_f32_16x16x32_bf16 v[208:211], v[108:111], v[64:67], v[208:211]
    v_mov_b32 v13, 1
    s_mov_b64 exec, 1
    ds_add_u32 v8, v13 offset:28
    s_mov_b64 exec, -1
    v_mfma_f32_16x16x32_bf16 v[212:215], v[112:115], v[64:67], v[212:215]
    s_waitcnt vmcnt(11)
    v_mfma_f32_16x16x32_bf16 v[216:219], v[96:99], v[68:71], v[216:219]
    s_cmp_ge_u32 s45, 3
    s_cselect_b32 s77, 4294967293, 3
    s_add_u32 s77, s77, s45
    s_lshl_b32 s78, 256, s77
    s_andn2_b32 s79, s78, s48
    s_cbranch_scc1 FW192
FB193:
    s_lshl1_add_u32 s77, s77, 1
    s_mul_i32 s46, s77, 131072
    s_add_u32 s46, s46, s42
    v_mfma_f32_16x16x32_bf16 v[220:223], v[100:103], v[68:71], v[220:223]
    buffer_load_dwordx4 v[140:143], v1, s[20:23], s46 offen sc1
    v_mfma_f32_16x16x32_bf16 v[224:227], v[104:107], v[68:71], v[224:227]
    s_cmp_ge_u32 s45, 2
    s_cselect_b32 s77, 4294967294, 4
    s_add_u32 s77, s77, s45
    s_lshl_b32 s78, 256, s77
    s_andn2_b32 s79, s78, s48
    s_cbranch_scc1 FW194
FB195:
    s_lshl1_add_u32 s77, s77, 1
    s_mul_i32 s34, s77, 131072
    s_add_u32 s34, s34, s42
    v_mfma_f32_16x16x32_bf16 v[228:231], v[108:111], v[68:71], v[228:231]
    buffer_load_dwordx4 v[16:19], v1, s[20:23], s34 offen sc1
    v_mfma_f32_16x16x32_bf16 v[232:235], v[112:115], v[68:71], v[232:235]
    s_waitcnt vmcnt(11)
    v_mfma_f32_16x16x32_bf16 v[236:239], v[96:99], v[80:83], v[236:239]
    s_cmp_ge_u32 s45, 1
    s_cselect_b32 s77, 4294967295, 5
    s_add_u32 s77, s77, s45
    s_lshl_b32 s78, 256, s77
    s_andn2_b32 s79, s78, s48
    s_cbranch_scc1 FW196
FB197:
    s_lshl1_add_u32 s77, s77, 1
    s_mul_i32 s35, s77, 131072
    s_add_u32 s35, s35, s42
    v_mfma_f32_16x16x32_bf16 v[240:243], v[100:103], v[80:83], v[240:243]
    buffer_load_dwordx4 v[20:23], v1, s[20:23], s35 offen sc1
    v_mfma_f32_16x16x32_bf16 v[244:247], v[104:107], v[80:83], v[244:247]
    v_mfma_f32_16x16x32_bf16 v[248:251], v[108:111], v[80:83], v[248:251]
    v_mfma_f32_16x16x32_bf16 v[252:255], v[112:115], v[80:83], v[252:255]
    s_waitcnt lgkmcnt(1)
    s_waitcnt vmcnt(11)
    v_mfma_f32_16x16x32_bf16 v[176:179], v[116:119], v[84:87], v[176:179]
    v_mfma_f32_16x16x32_bf16 v[180:183], v[120:123], v[84:87], v[180:183]
    ds_read_b128 v[96:99], v7 offset:0
    v_mfma_f32_16x16x32_bf16 v[184:187], v[124:127], v[84:87], v[184:187]
    ds_read_b128 v[100:103], v7 offset:1024
    v_mfma_f32_16x16x32_bf16 v[188:191], v[128:131], v[84:87], v[188:191]
    ds_read_b128 v[104:107], v7 offset:2048
    v_mfma_f32_16x16x32_bf16 v[192:195], v[132:135], v[84:87], v[192:195]
    s_waitcnt vmcnt(10)
    v_mfma_f32_16x16x32_bf16 v[196:199], v[116:119], v[88:91], v[196:199]
    ds_read_b128 v[108:111], v7 offset:3072
    v_mfma_f32_16x16x32_bf16 v[200:203], v[120:123], v[88:91], v[200:203]
    ds_read_b128 v[112:115], v7 offset:4096
    v_mfma_f32_16x16x32_bf16 v[204:207], v[124:127], v[88:91], v[204:207]
    buffer_load_dwordx4 v[24:27], v2, s[20:23], s46 offen sc1
    v_mfma_f32_16x16x32_bf16 v[208:211], v[128:131], v[88:91], v[208:211]
    buffer_load_dwordx4 v[28:31], v2, s[20:23], s34 offen sc1
    v_mfma_f32_16x16x32_bf16 v[212:215], v[132:135], v[88:91], v[212:215]
    s_waitcnt vmcnt(11)
    v_mfma_f32_16x16x32_bf16 v[216:219], v[116:119], v[92:95], v[216:219]
    buffer_load_dwordx4 v[32:35], v2, s[20:23], s35 offen sc1
    v_mfma_f32_16x16x32_bf16 v[220:223], v[120:123], v[92:95], v[220:223]
    v_mfma_f32_16x16x32_bf16 v[224:227], v[124:127], v[92:95], v[224:227]
    v_mfma_f32_16x16x32_bf16 v[228:231], v[128:131], v[92:95], v[228:231]
    v_mfma_f32_16x16x32_bf16 v[232:235], v[132:135], v[92:95], v[232:235]
    s_waitcnt vmcnt(11)
    v_mfma_f32_16x16x32_bf16 v[236:239], v[116:119], v[72:75], v[236:239]
    buffer_load_dwordx4 v[152:155], v3, s[20:23], s46 offen sc1
    v_mfma_f32_16x16x32_bf16 v[240:243], v[120:123], v[72:75], v[240:243]
    v_mfma_f32_16x16x32_bf16 v[244:247], v[124:127], v[72:75], v[244:247]
    v_mfma_f32_16x16x32_bf16 v[248:251], v[128:131], v[72:75], v[248:251]
    v_mfma_f32_16x16x32_bf16 v[252:255], v[132:135], v[72:75], v[252:255]
    s_waitcnt lgkmcnt(0)
    s_waitcnt vmcnt(10)
    v_mfma_f32_16x16x32_bf16 v[176:179], v[96:99], v[164:167], v[176:179]
    v_mfma_f32_16x16x32_bf16 v[180:183], v[100:103], v[164:167], v[180:183]
    ds_read_b128 v[116:119], v7 offset:10240
    v_mfma_f32_16x16x32_bf16 v[184:187], v[104:107], v[164:167], v[184:187]
    ds_read_b128 v[120:123], v7 offset:11264
    v_mfma_f32_16x16x32_bf16 v[188:191], v[108:111], v[164:167], v[188:191]
    ds_read_b128 v[124:127], v7 offset:12288
    v_mfma_f32_16x16x32_bf16 v[192:195], v[112:115], v[164:167], v[192:195]
    s_waitcnt vmcnt(9)
    v_mfma_f32_16x16x32_bf16 v[196:199], v[96:99], v[168:171], v[196:199]
    ds_read_b128 v[128:131], v7 offset:13312
    v_mfma_f32_16x16x32_bf16 v[200:203], v[100:103], v[168:171], v[200:203]
    ds_read_b128 v[132:135], v7 offset:14336
    v_mfma_f32_16x16x32_bf16 v[204:207], v[104:107], v[168:171], v[204:207]
    buffer_load_dwordx4 v[156:159], v3, s[20:23], s34 offen sc1
    v_mfma_f32_16x16x32_bf16 v[208:211], v[108:111], v[168:171], v[208:211]
    v_mfma_f32_16x16x32_bf16 v[212:215], v[112:115], v[168:171], v[212:215]
    ds_read_b128 v[36:39], v7 offset:15360
    s_waitcnt vmcnt(9)
    v_mfma_f32_16x16x32_bf16 v[216:219], v[96:99], v[172:175], v[216:219]
    ds_read_b128 v[40:43], v7 offset:16384
    v_mfma_f32_16x16x32_bf16 v[220:223], v[100:103], v[172:175], v[220:223]
    ds_read_b128 v[44:47], v7 offset:17408
    v_mfma_f32_16x16x32_bf16 v[224:227], v[104:107], v[172:175], v[224:227]
    ds_read_b128 v[52:55], v7 offset:18432
    v_mfma_f32_16x16x32_bf16 v[228:231], v[108:111], v[172:175], v[228:231]
    ds_read_b128 v[56:59], v7 offset:19456
    v_mfma_f32_16x16x32_bf16 v[232:235], v[112:115], v[172:175], v[232:235]
    s_waitcnt vmcnt(8)
    v_mfma_f32_16x16x32_bf16 v[236:239], v[96:99], v[136:139], v[236:239]
    buffer_load_dwordx4 v[60:63], v3, s[20:23], s35 offen sc1
    v_mfma_f32_16x16x32_bf16 v[240:243], v[100:103], v[136:139], v[240:243]
    buffer_load_dwordx4 v[64:67], v6, s[20:23], s46 offen sc1
    v_mfma_f32_16x16x32_bf16 v[244:247], v[104:107], v[136:139], v[244:247]
    buffer_load_dwordx4 v[68:71], v6, s[20:23], s34 offen sc1
    v_mfma_f32_16x16x32_bf16 v[248:251], v[108:111], v[136:139], v[248:251]
    v_mfma_f32_16x16x32_bf16 v[252:255], v[112:115], v[136:139], v[252:255]
    s_waitcnt lgkmcnt(5)
    s_waitcnt vmcnt(10)
    v_mfma_f32_16x16x32_bf16 v[176:179], v[116:119], v[140:143], v[176:179]
    buffer_load_dwordx4 v[96:99], v6, s[20:23], s35 offen sc1
    v_mfma_f32_16x16x32_bf16 v[180:183], v[120:123], v[140:143], v[180:183]
    v_mfma_f32_16x16x32_bf16 v[184:187], v[124:127], v[140:143], v[184:187]
    v_mfma_f32_16x16x32_bf16 v[188:191], v[128:131], v[140:143], v[188:191]
    v_mfma_f32_16x16x32_bf16 v[192:195], v[132:135], v[140:143], v[192:195]
    s_waitcnt lgkmcnt(0)
    s_waitcnt vmcnt(10)
    v_mfma_f32_16x16x32_bf16 v[176:179], v[36:39], v[16:19], v[176:179]
    v_mfma_f32_16x16x32_bf16 v[180:183], v[40:43], v[16:19], v[180:183]
    v_mfma_f32_16x16x32_bf16 v[184:187], v[44:47], v[16:19], v[184:187]
    v_mfma_f32_16x16x32_bf16 v[188:191], v[52:55], v[16:19], v[188:191]
    v_mfma_f32_16x16x32_bf16 v[192:195], v[56:59], v[16:19], v[192:195]
    s_waitcnt vmcnt(9)
    v_mfma_f32_16x16x32_bf16 v[176:179], v[144:147], v[20:23], v[176:179]
    v_mfma_f32_16x16x32_bf16 v[180:183], v[148:151], v[20:23], v[180:183]
    v_mfma_f32_16x16x32_bf16 v[184:187], v[48:51], v[20:23], v[184:187]
    v_mfma_f32_16x16x32_bf16 v[188:191], v[76:79], v[20:23], v[188:191]
    v_mfma_f32_16x16x32_bf16 v[192:195], v[160:163], v[20:23], v[192:195]
    s_waitcnt vmcnt(8)
    v_mfma_f32_16x16x32_bf16 v[196:199], v[116:119], v[24:27], v[196:199]
    v_mfma_f32_16x16x32_bf16 v[200:203], v[120:123], v[24:27], v[200:203]
    v_mfma_f32_16x16x32_bf16 v[204:207], v[124:127], v[24:27], v[204:207]
    v_mfma_f32_16x16x32_bf16 v[208:211], v[128:131], v[24:27], v[208:211]
    v_mfma_f32_16x16x32_bf16 v[212:215], v[132:135], v[24:27], v[212:215]
    s_waitcnt vmcnt(7)
    v_mfma_f32_16x16x32_bf16 v[196:199], v[36:39], v[28:31], v[196:199]
    ds_write_b128 v7, v[176:179] offset:0
    v_mfma_f32_16x16x32_bf16 v[200:203], v[40:43], v[28:31], v[200:203]
    ds_write_b128 v7, v[180:183] offset:1024
    v_mfma_f32_16x16x32_bf16 v[204:207], v[44:47], v[28:31], v[204:207]
    v_mfma_f32_16x16x32_bf16 v[208:211], v[52:55], v[28:31], v[208:211]
    v_mfma_f32_16x16x32_bf16 v[212:215], v[56:59], v[28:31], v[212:215]
    s_waitcnt vmcnt(6)
    v_mfma_f32_16x16x32_bf16 v[196:199], v[144:147], v[32:35], v[196:199]
    ds_write_b128 v7, v[184:187] offset:2048
    v_mfma_f32_16x16x32_bf16 v[200:203], v[148:151], v[32:35], v[200:203]
    ds_write_b128 v7, v[188:191] offset:3072
    v_mfma_f32_16x16x32_bf16 v[204:207], v[48:51], v[32:35], v[204:207]
    v_mfma_f32_16x16x32_bf16 v[208:211], v[76:79], v[32:35], v[208:211]
    v_mfma_f32_16x16x32_bf16 v[212:215], v[160:163], v[32:35], v[212:215]
    s_waitcnt vmcnt(5)
    v_mfma_f32_16x16x32_bf16 v[216:219], v[116:119], v[152:155], v[216:219]
    ds_write_b128 v7, v[192:195] offset:4096
    v_mfma_f32_16x16x32_bf16 v[220:223], v[120:123], v[152:155], v[220:223]
    v_mfma_f32_16x16x32_bf16 v[224:227], v[124:127], v[152:155], v[224:227]
    v_mfma_f32_16x16x32_bf16 v[228:231], v[128:131], v[152:155], v[228:231]
    v_mfma_f32_16x16x32_bf16 v[232:235], v[132:135], v[152:155], v[232:235]
    s_waitcnt vmcnt(4)
    v_mfma_f32_16x16x32_bf16 v[216:219], v[36:39], v[156:159], v[216:219]
    ds_write_b128 v7, v[196:199] offset:5120
    v_mfma_f32_16x16x32_bf16 v[220:223], v[40:43], v[156:159], v[220:223]
    ds_write_b128 v7, v[200:203] offset:6144
    v_mfma_f32_16x16x32_bf16 v[224:227], v[44:47], v[156:159], v[224:227]
    v_mfma_f32_16x16x32_bf16 v[228:231], v[52:55], v[156:159], v[228:231]
    v_mfma_f32_16x16x32_bf16 v[232:235], v[56:59], v[156:159], v[232:235]
    ds_write_b128 v7, v[204:207] offset:7168
    ds_write_b128 v7, v[208:211] offset:8192
    s_waitcnt vmcnt(3)
    v_mfma_f32_16x16x32_bf16 v[216:219], v[144:147], v[60:63], v[216:219]
    v_mbcnt_lo_u32_b32 v9, -1, 0
    v_mbcnt_hi_u32_b32 v9, -1, v9
    v_lshlrev_b32 v3, 4, v9
    v_add_u32 v1, s4, v3
    v_mfma_f32_16x16x32_bf16 v[220:223], v[148:151], v[60:63], v[220:223]
    v_add_u32 v2, s5, v3
    v_add_u32 v3, s6, v3
    v_lshlrev_b32 v5, 3, v9
    v_add_u32 v5, s7, v5
    v_mfma_f32_16x16x32_bf16 v[224:227], v[48:51], v[60:63], v[224:227]
    v_and_b32 v6, 15, v9
    v_mul_u32_u24 v6, 1280, v6
    v_lshrrev_b32 v9, 4, v9
    v_lshl_add_u32 v4, v9, 4, v6
    v_mfma_f32_16x16x32_bf16 v[228:231], v[76:79], v[60:63], v[228:231]
    v_lshl_add_u32 v6, v9, 3, v6
    v_mul_f32 v10, v10, v10
    v_mov_b32 v13, 1
    v_mov_b32 v11, v10
    v_mfma_f32_16x16x32_bf16 v[232:235], v[160:163], v[60:63], v[232:235]
    ds_write_b128 v7, v[212:215] offset:9216
    s_waitcnt vmcnt(2)
    v_mfma_f32_16x16x32_bf16 v[236:239], v[116:119], v[64:67], v[236:239]
    ds_write_b128 v7, v[216:219] offset:10240
    v_mfma_f32_16x16x32_bf16 v[240:243], v[120:123], v[64:67], v[240:243]
    ds_write_b128 v7, v[220:223] offset:11264
    v_mfma_f32_16x16x32_bf16 v[244:247], v[124:127], v[64:67], v[244:247]
    ds_write_b128 v7, v[224:227] offset:12288
    v_mfma_f32_16x16x32_bf16 v[248:251], v[128:131], v[64:67], v[248:251]
    ds_write_b128 v7, v[228:231] offset:13312
    v_mfma_f32_16x16x32_bf16 v[252:255], v[132:135], v[64:67], v[252:255]
    ds_write_b128 v7, v[232:235] offset:14336
    s_mov_b64 exec, 1
    s_waitcnt lgkmcnt(14)
    ds_add_rtn_u32 v12, v8, v13 offset:88
    s_mov_b64 exec, -1
    s_waitcnt vmcnt(1)
    v_mfma_f32_16x16x32_bf16 v[236:239], v[36:39], v[68:71], v[236:239]
    s_waitcnt lgkmcnt(14)
    ds_read_b128 v[116:119], v1 offset:0
    s_waitcnt lgkmcnt(14)
    ds_read_b128 v[120:123], v2 offset:0
    s_waitcnt lgkmcnt(14)
    ds_read_b128 v[124:127], v3 offset:0
    v_mfma_f32_16x16x32_bf16 v[240:243], v[40:43], v[68:71], v[240:243]
    s_waitcnt lgkmcnt(14)
    ds_read_b128 v[128:131], v1 offset:1024
    s_waitcnt lgkmcnt(14)
    ds_read_b128 v[132:135], v2 offset:1024
    s_waitcnt lgkmcnt(14)
    ds_read_b128 v[100:103], v3 offset:1024
    v_mfma_f32_16x16x32_bf16 v[244:247], v[44:47], v[68:71], v[244:247]
    s_waitcnt lgkmcnt(14)
    ds_read_b128 v[104:107], v1 offset:2048
    s_waitcnt lgkmcnt(14)
    ds_read_b128 v[108:111], v2 offset:2048
    s_waitcnt lgkmcnt(14)
    ds_read_b128 v[112:115], v3 offset:2048
    v_mfma_f32_16x16x32_bf16 v[248:251], v[52:55], v[68:71], v[248:251]
    s_waitcnt lgkmcnt(14)
    ds_read_b128 v[80:83], v1 offset:3072
    s_waitcnt lgkmcnt(14)
    ds_read_b128 v[84:87], v2 offset:3072
    s_waitcnt lgkmcnt(14)
    ds_read_b128 v[88:91], v3 offset:3072
    v_mfma_f32_16x16x32_bf16 v[252:255], v[56:59], v[68:71], v[252:255]
    s_waitcnt lgkmcnt(14)
    ds_read_b128 v[92:95], v1 offset:4096
    s_waitcnt lgkmcnt(14)
    ds_read_b128 v[72:75], v2 offset:4096
    s_waitcnt lgkmcnt(14)
    ds_read_b128 v[164:167], v3 offset:4096
    s_waitcnt vmcnt(0)
    v_mfma_f32_16x16x32_bf16 v[236:239], v[144:147], v[96:99], v[236:239]
    s_waitcnt lgkmcnt(14)
    ds_read_b32 v14, v8 offset:92
    s_waitcnt lgkmcnt(14)
    ds_read_b64 v[168:169], v5 offset:0
    v_mfma_f32_16x16x32_bf16 v[240:243], v[148:151], v[96:99], v[240:243]
    s_waitcnt lgkmcnt(14)
    ds_read_b64 v[170:171], v5 offset:512
    s_waitcnt lgkmcnt(14)
    ds_read_b64 v[172:173], v5 offset:1024
    v_mfma_f32_16x16x32_bf16 v[244:247], v[48:51], v[96:99], v[244:247]
    s_waitcnt lgkmcnt(14)
    ds_read_b64 v[174:175], v5 offset:1536
    s_waitcnt lgkmcnt(14)
    ds_read_b64 v[136:137], v5 offset:2048
    v_mfma_f32_16x16x32_bf16 v[248:251], v[76:79], v[96:99], v[248:251]
    v_mfma_f32_16x16x32_bf16 v[252:255], v[160:163], v[96:99], v[252:255]
    v_readfirstlane_b32 s77, v12
    s_cmp_lt_u32 s77, 3
    s_cbranch_scc1 RS198
RB199:
    v_pk_add_f32 v[120:121], v[120:121], v[124:125]
    v_pk_add_f32 v[122:123], v[122:123], v[126:127]
    v_pk_add_f32 v[116:117], v[116:117], v[120:121]
    v_pk_add_f32 v[118:119], v[118:119], v[122:123]
    v_pk_add_f32 v[132:133], v[132:133], v[100:101]
    v_pk_add_f32 v[134:135], v[134:135], v[102:103]
    v_pk_add_f32 v[128:129], v[128:129], v[132:133]
    v_pk_add_f32 v[130:131], v[130:131], v[134:135]
    s_waitcnt lgkmcnt(12)
    v_pk_add_f32 v[108:109], v[108:109], v[112:113]
    v_pk_add_f32 v[110:111], v[110:111], v[114:115]
    v_pk_add_f32 v[104:105], v[104:105], v[108:109]
    v_pk_add_f32 v[106:107], v[106:107], v[110:111]
    s_waitcnt lgkmcnt(9)
    v_pk_add_f32 v[84:85], v[84:85], v[88:89]
    v_pk_add_f32 v[86:87], v[86:87], v[90:91]
    v_pk_add_f32 v[80:81], v[80:81], v[84:85]
    v_pk_add_f32 v[82:83], v[82:83], v[86:87]
    s_waitcnt lgkmcnt(6)
    v_pk_add_f32 v[72:73], v[72:73], v[164:165]
    v_pk_add_f32 v[74:75], v[74:75], v[166:167]
    v_pk_add_f32 v[92:93], v[92:93], v[72:73]
    v_pk_add_f32 v[94:95], v[94:95], v[74:75]
    s_nop 0
    v_pk_add_f32 v[236:237], v[236:237], v[116:117]
    v_pk_add_f32 v[238:239], v[238:239], v[118:119]
    v_pk_mul_f32 v[236:237], v[236:237], v[10:11]
    v_pk_mul_f32 v[238:239], v[238:239], v[10:11]
    v_cvt_pk_bf16_f32 v236, v236, v237
    v_cvt_pk_bf16_f32 v238, v238, v239
    v_pk_add_f32 v[240:241], v[240:241], v[128:129]
    v_pk_add_f32 v[242:243], v[242:243], v[130:131]
    v_pk_mul_f32 v[240:241], v[240:241], v[10:11]
    v_pk_mul_f32 v[242:243], v[242:243], v[10:11]
    v_cvt_pk_bf16_f32 v240, v240, v241
    v_cvt_pk_bf16_f32 v242, v242, v243
    v_pk_add_f32 v[244:245], v[244:245], v[104:105]
    v_pk_add_f32 v[246:247], v[246:247], v[106:107]
    v_pk_mul_f32 v[244:245], v[244:245], v[10:11]
    v_pk_mul_f32 v[246:247], v[246:247], v[10:11]
    v_cvt_pk_bf16_f32 v244, v244, v245
    v_cvt_pk_bf16_f32 v246, v246, v247
    v_pk_add_f32 v[248:249], v[248:249], v[80:81]
    v_pk_add_f32 v[250:251], v[250:251], v[82:83]
    v_pk_mul_f32 v[248:249], v[248:249], v[10:11]
    v_pk_mul_f32 v[250:251], v[250:251], v[10:11]
    v_cvt_pk_bf16_f32 v248, v248, v249
    v_cvt_pk_bf16_f32 v250, v250, v251
    v_pk_add_f32 v[252:253], v[252:253], v[92:93]
    v_pk_add_f32 v[254:255], v[254:255], v[94:95]
    v_pk_mul_f32 v[252:253], v[252:253], v[10:11]
    v_pk_mul_f32 v[254:255], v[254:255], v[10:11]
    v_cvt_pk_bf16_f32 v252, v252, v253
    v_cvt_pk_bf16_f32 v254, v254, v255
    s_waitcnt lgkmcnt(0)
    v_cmp_gt_u32 vcc, 4, v14
    s_cbranch_vccnz TS200
TB201:
    v_and_b32 v117, s10, v236
    v_lshlrev_b32 v116, 16, v236
    v_and_b32 v121, s10, v168
    v_lshlrev_b32 v120, 16, v168
    v_and_b32 v119, s10, v238
    v_lshlrev_b32 v118, 16, v238
    v_and_b32 v123, s10, v169
    v_lshlrev_b32 v122, 16, v169
    v_pk_add_f32 v[116:117], v[116:117], v[120:121]
    v_pk_add_f32 v[118:119], v[118:119], v[122:123]
    v_cvt_pk_bf16_f32 v236, v116, v117
    v_cvt_pk_bf16_f32 v237, v118, v119
    v_and_b32 v129, s10, v240
    v_lshlrev_b32 v128, 16, v240
    v_and_b32 v133, s10, v170
    v_lshlrev_b32 v132, 16, v170
    v_and_b32 v131, s10, v242
    v_lshlrev_b32 v130, 16, v242
    v_and_b32 v135, s10, v171
    v_lshlrev_b32 v134, 16, v171
    v_pk_add_f32 v[128:129], v[128:129], v[132:133]
    v_pk_add_f32 v[130:131], v[130:131], v[134:135]
    v_cvt_pk_bf16_f32 v238, v128, v129
    v_cvt_pk_bf16_f32 v239, v130, v131
    buffer_store_dwordx4 v[236:239], v4, s[28:31], s8 offen offset:0 sc1
    v_and_b32 v105, s10, v244
    v_lshlrev_b32 v104, 16, v244
    v_and_b32 v109, s10, v172
    v_lshlrev_b32 v108, 16, v172
    v_and_b32 v107, s10, v246
    v_lshlrev_b32 v106, 16, v246
    v_and_b32 v111, s10, v173
    v_lshlrev_b32 v110, 16, v173
    v_pk_add_f32 v[104:105], v[104:105], v[108:109]
    v_pk_add_f32 v[106:107], v[106:107], v[110:111]
    v_cvt_pk_bf16_f32 v244, v104, v105
    v_cvt_pk_bf16_f32 v245, v106, v107
    v_and_b32 v81, s10, v248
    v_lshlrev_b32 v80, 16, v248
    v_and_b32 v85, s10, v174
    v_lshlrev_b32 v84, 16, v174
    v_and_b32 v83, s10, v250
    v_lshlrev_b32 v82, 16, v250
    v_and_b32 v87, s10, v175
    v_lshlrev_b32 v86, 16, v175
    v_pk_add_f32 v[80:81], v[80:81], v[84:85]
    v_pk_add_f32 v[82:83], v[82:83], v[86:87]
    v_cvt_pk_bf16_f32 v246, v80, v81
    v_cvt_pk_bf16_f32 v247, v82, v83
    buffer_store_dwordx4 v[244:247], v4, s[28:31], s8 offen offset:64 sc1
    v_and_b32 v93, s10, v252
    v_lshlrev_b32 v92, 16, v252
    v_and_b32 v73, s10, v136
    v_lshlrev_b32 v72, 16, v136
    v_and_b32 v95, s10, v254
    v_lshlrev_b32 v94, 16, v254
    v_and_b32 v75, s10, v137
    v_lshlrev_b32 v74, 16, v137
    v_pk_add_f32 v[92:93], v[92:93], v[72:73]
    v_pk_add_f32 v[94:95], v[94:95], v[74:75]
    v_cvt_pk_bf16_f32 v252, v92, v93
    v_cvt_pk_bf16_f32 v253, v94, v95
    buffer_store_dwordx2 v[252:253], v6, s[28:31], s9 offen sc1
    s_endpgm
RS198:
    s_mov_b32 s83, 200000
SPL202:
    ds_read_b32 v12, v8 offset:88
    s_waitcnt lgkmcnt(0)
    s_nop 0
    v_readfirstlane_b32 s82, v12
    s_sub_u32 s83, s83, 1
    s_cselect_b32 s82, -1, s82
    s_cmp_ge_u32 s82, 4
    s_cbranch_scc1 SPD203
    s_branch SPL202
SPD203:
    ds_read_b128 v[116:119], v1 offset:0
    ds_read_b128 v[120:123], v2 offset:0
    ds_read_b128 v[124:127], v3 offset:0
    ds_read_b128 v[128:131], v1 offset:1024
    ds_read_b128 v[132:135], v2 offset:1024
    ds_read_b128 v[100:103], v3 offset:1024
    ds_read_b128 v[104:107], v1 offset:2048
    ds_read_b128 v[108:111], v2 offset:2048
    ds_read_b128 v[112:115], v3 offset:2048
    ds_read_b128 v[80:83], v1 offset:3072
    ds_read_b128 v[84:87], v2 offset:3072
    ds_read_b128 v[88:91], v3 offset:3072
    ds_read_b128 v[92:95], v1 offset:4096
    ds_read_b128 v[72:75], v2 offset:4096
    ds_read_b128 v[164:167], v3 offset:4096
    s_waitcnt lgkmcnt(14)
    ds_read_b32 v14, v8 offset:92
    s_waitcnt lgkmcnt(0)
    ds_read_b64 v[168:169], v5 offset:0
    ds_read_b64 v[170:171], v5 offset:512
    ds_read_b64 v[172:173], v5 offset:1024
    ds_read_b64 v[174:175], v5 offset:1536
    ds_read_b64 v[136:137], v5 offset:2048
    s_branch RB199
TS200:
    s_mov_b32 s83, 200000
SPL204:
    ds_read_b32 v14, v8 offset:92
    s_waitcnt lgkmcnt(0)
    s_nop 0
    v_readfirstlane_b32 s82, v14
    s_sub_u32 s83, s83, 1
    s_cselect_b32 s82, -1, s82
    s_cmp_ge_u32 s82, 4
    s_cbranch_scc1 SPD205
    s_branch SPL204
SPD205:
    ds_read_b64 v[168:169], v5 offset:0
    ds_read_b64 v[170:171], v5 offset:512
    ds_read_b64 v[172:173], v5 offset:1024
    ds_read_b64 v[174:175], v5 offset:1536
    ds_read_b64 v[136:137], v5 offset:2048
    s_waitcnt lgkmcnt(0)
    s_branch TB201
L_C:
    s_mov_b32 s34, 0
    s_mov_b32 s35, 0
    v_mov_b64 v[0:1], 0
    v_mov_b64 v[2:3], 0
    v_mov_b64 v[4:5], 0
    v_mov_b64 v[6:7], 0
    v_mov_b64 v[8:9], 0
    s_mov_b32 s83, 200000
SPL206:
    ds_read2_b32 v[12:13], v15 offset0:32 offset1:96
    s_waitcnt lgkmcnt(0)
    v_min_u32 v12, v12, v13
    s_nop 0
    v_readfirstlane_b32 s82, v12
    s_sub_u32 s83, s83, 1
    s_cselect_b32 s82, -1, s82
    s_cmp_ge_u32 s82, 2
    s_cbranch_scc1 SPD207
    s_sleep 1
    s_branch SPL206
SPD207:
    v_mov_b32 v13, v11
    v_mov_b64 v[10:11], 0
    ds_read_b64_tr_b16 v[16:17], v112 offset:0
    ds_read_b64_tr_b16 v[18:19], v112 offset:1024
    ds_read_b128 v[48:51], v116 offset:0
    ds_read_b64_tr_b16 v[20:21], v113 offset:0
    ds_read_b64_tr_b16 v[22:23], v113 offset:1024
    ds_read_b64_tr_b16 v[32:33], v112 offset:8192
    ds_read_b64_tr_b16 v[34:35], v112 offset:9216
    ds_read_b64_tr_b16 v[36:37], v113 offset:8192
    ds_read_b64_tr_b16 v[38:39], v113 offset:9216
    ds_read_b128 v[52:55], v116 offset:2048
    ds_read_b128 v[56:59], v116 offset:4096
    ds_read_b128 v[60:63], v116 offset:6144
    ds_read_b64_tr_b16 v[24:25], v114 offset:0
    ds_read_b64_tr_b16 v[26:27], v114 offset:1024
    ds_read_b64_tr_b16 v[28:29], v115 offset:0
    s_waitcnt lgkmcnt(14)
    ds_read_b64_tr_b16 v[30:31], v115 offset:1024
    s_waitcnt lgkmcnt(14)
    ds_read_b64_tr_b16 v[40:41], v114 offset:8192
    s_waitcnt lgkmcnt(14)
    ds_read_b64_tr_b16 v[42:43], v114 offset:9216
    s_waitcnt lgkmcnt(14)
    ds_read_b64_tr_b16 v[44:45], v115 offset:8192
    s_waitcnt lgkmcnt(14)
    ds_read_b64_tr_b16 v[46:47], v115 offset:9216
    v_mfma_f32_16x16x32_bf16 v[128:131], v[16:19], v[48:51], 0
    v_add_u32 v14, 1, v14
    v_mfma_f32_16x16x32_bf16 v[144:147], v[20:23], v[48:51], 0
    s_add_u32 s5, s5, s5
    s_cselect_b32 s8, s30, 16384
    s_waitcnt lgkmcnt(0)
    ds_write_b32 v118, v14
    v_mfma_f32_16x16x32_bf16 v[192:195], v[32:35], v[48:51], 0
    v_add_u32 v116, s8, v116
    ds_read_b32 v12, v119
    v_mfma_f32_16x16x32_bf16 v[208:211], v[36:39], v[48:51], 0
    v_mfma_f32_16x16x32_bf16 v[132:135], v[16:19], v[52:55], 0
    v_mfma_f32_16x16x32_bf16 v[148:151], v[20:23], v[52:55], 0
    v_mfma_f32_16x16x32_bf16 v[196:199], v[32:35], v[52:55], 0
    v_mfma_f32_16x16x32_bf16 v[212:215], v[36:39], v[52:55], 0
    s_waitcnt lgkmcnt(0)
    v_cmp_le_u32 vcc, v12, v14
    v_mfma_f32_16x16x32_bf16 v[136:139], v[16:19], v[56:59], 0
    s_cbranch_vccnz CS208
    ds_read_b64_tr_b16 v[64:65], v112 offset:16384
    v_mfma_f32_16x16x32_bf16 v[152:155], v[20:23], v[56:59], 0
    ds_read_b64_tr_b16 v[66:67], v112 offset:17408
    v_mfma_f32_16x16x32_bf16 v[200:203], v[32:35], v[56:59], 0
    ds_read_b128 v[96:99], v117 offset:0
    v_mfma_f32_16x16x32_bf16 v[216:219], v[36:39], v[56:59], 0
    ds_read_b64_tr_b16 v[68:69], v113 offset:16384
    v_mfma_f32_16x16x32_bf16 v[140:143], v[16:19], v[60:63], 0
    ds_read_b64_tr_b16 v[70:71], v113 offset:17408
    v_mfma_f32_16x16x32_bf16 v[156:159], v[20:23], v[60:63], 0
    ds_read_b64_tr_b16 v[80:81], v112 offset:24576
    v_mfma_f32_16x16x32_bf16 v[204:207], v[32:35], v[60:63], 0
    ds_read_b64_tr_b16 v[82:83], v112 offset:25600
    v_mfma_f32_16x16x32_bf16 v[220:223], v[36:39], v[60:63], 0
    ds_read_b64_tr_b16 v[84:85], v113 offset:24576
    v_mfma_f32_16x16x32_bf16 v[160:163], v[24:27], v[48:51], 0
    ds_read_b64_tr_b16 v[86:87], v113 offset:25600
    v_mfma_f32_16x16x32_bf16 v[176:179], v[28:31], v[48:51], 0
    ds_read_b128 v[100:103], v117 offset:2048
    v_mfma_f32_16x16x32_bf16 v[224:227], v[40:43], v[48:51], 0
    ds_read_b128 v[104:107], v117 offset:4096
    v_mfma_f32_16x16x32_bf16 v[240:243], v[44:47], v[48:51], 0
    ds_read_b128 v[108:111], v117 offset:6144
    v_mfma_f32_16x16x32_bf16 v[164:167], v[24:27], v[52:55], 0
    ds_read_b64_tr_b16 v[72:73], v114 offset:16384
    v_mfma_f32_16x16x32_bf16 v[180:183], v[28:31], v[52:55], 0
    ds_read_b64_tr_b16 v[74:75], v114 offset:17408
    v_mfma_f32_16x16x32_bf16 v[228:231], v[40:43], v[52:55], 0
    ds_read_b64_tr_b16 v[76:77], v115 offset:16384
    v_mfma_f32_16x16x32_bf16 v[244:247], v[44:47], v[52:55], 0
    s_waitcnt lgkmcnt(14)
    ds_read_b64_tr_b16 v[78:79], v115 offset:17408
    v_mfma_f32_16x16x32_bf16 v[168:171], v[24:27], v[56:59], 0
    s_waitcnt lgkmcnt(14)
    ds_read_b64_tr_b16 v[88:89], v114 offset:24576
    v_mfma_f32_16x16x32_bf16 v[184:187], v[28:31], v[56:59], 0
    s_waitcnt lgkmcnt(14)
    ds_read_b64_tr_b16 v[90:91], v114 offset:25600
    v_mfma_f32_16x16x32_bf16 v[232:235], v[40:43], v[56:59], 0
    s_waitcnt lgkmcnt(14)
    ds_read_b64_tr_b16 v[92:93], v115 offset:24576
    v_mfma_f32_16x16x32_bf16 v[248:251], v[44:47], v[56:59], 0
    s_waitcnt lgkmcnt(14)
    ds_read_b64_tr_b16 v[94:95], v115 offset:25600
    v_mfma_f32_16x16x32_bf16 v[172:175], v[24:27], v[60:63], 0
    v_mfma_f32_16x16x32_bf16 v[188:191], v[28:31], v[60:63], 0
    v_mfma_f32_16x16x32_bf16 v[236:239], v[40:43], v[60:63], 0
    v_mfma_f32_16x16x32_bf16 v[252:255], v[44:47], v[60:63], 0
CS208r:
    s_cmp_ge_u32 s31, 5
    s_cbranch_scc1 XS209
    s_cmp_eq_u32 s29, 1
    s_cbranch_scc1 XU210
    v_mfma_f32_16x16x32_bf16 v[0:3], v[16:19], v[124:127], v[0:3]
    v_mfma_f32_16x16x32_bf16 v[4:7], v[20:23], v[124:127], v[4:7]
    v_mfma_f32_16x16x32_bf16 v[8:11], v[24:27], v[124:127], v[8:11]
    v_mfma_f32_16x16x32_bf16 v[120:123], v[28:31], v[124:127], v[120:123]
    s_branch XS209
XU210:
    v_mfma_f32_16x16x32_bf16 v[0:3], v[32:35], v[124:127], v[0:3]
    v_mfma_f32_16x16x32_bf16 v[4:7], v[36:39], v[124:127], v[4:7]
    v_mfma_f32_16x16x32_bf16 v[8:11], v[40:43], v[124:127], v[8:11]
    v_mfma_f32_16x16x32_bf16 v[120:123], v[44:47], v[124:127], v[120:123]
XS209:
    v_mfma_f32_16x16x32_bf16 v[128:131], v[64:67], v[96:99], v[128:131]
    v_add_u32 v14, 1, v14
    v_mfma_f32_16x16x32_bf16 v[144:147], v[68:71], v[96:99], v[144:147]
    s_waitcnt lgkmcnt(0)
    ds_write_b32 v118, v14
    v_mfma_f32_16x16x32_bf16 v[192:195], v[80:83], v[96:99], v[192:195]
    v_add_u32 v117, s8, v117
    ds_read_b32 v12, v119
    v_mfma_f32_16x16x32_bf16 v[208:211], v[84:87], v[96:99], v[208:211]
    v_mfma_f32_16x16x32_bf16 v[132:135], v[64:67], v[100:103], v[132:135]
    v_mfma_f32_16x16x32_bf16 v[148:151], v[68:71], v[100:103], v[148:151]
    v_mfma_f32_16x16x32_bf16 v[196:199], v[80:83], v[100:103], v[196:199]
    v_mfma_f32_16x16x32_bf16 v[212:215], v[84:87], v[100:103], v[212:215]
    s_waitcnt lgkmcnt(0)
    v_cmp_le_u32 vcc, v12, v14
    v_mfma_f32_16x16x32_bf16 v[136:139], v[64:67], v[104:107], v[136:139]
    s_cbranch_vccnz CS211
    ds_read_b64_tr_b16 v[16:17], v112 offset:32768
    v_mfma_f32_16x16x32_bf16 v[152:155], v[68:71], v[104:107], v[152:155]
    ds_read_b64_tr_b16 v[18:19], v112 offset:33792
    v_mfma_f32_16x16x32_bf16 v[200:203], v[80:83], v[104:107], v[200:203]
    ds_read_b128 v[48:51], v116 offset:0
    v_mfma_f32_16x16x32_bf16 v[216:219], v[84:87], v[104:107], v[216:219]
    ds_read_b64_tr_b16 v[20:21], v113 offset:32768
    v_mfma_f32_16x16x32_bf16 v[140:143], v[64:67], v[108:111], v[140:143]
    ds_read_b64_tr_b16 v[22:23], v113 offset:33792
    v_mfma_f32_16x16x32_bf16 v[156:159], v[68:71], v[108:111], v[156:159]
    ds_read_b64_tr_b16 v[32:33], v112 offset:40960
    v_mfma_f32_16x16x32_bf16 v[204:207], v[80:83], v[108:111], v[204:207]
    ds_read_b64_tr_b16 v[34:35], v112 offset:41984
    v_mfma_f32_16x16x32_bf16 v[220:223], v[84:87], v[108:111], v[220:223]
    ds_read_b64_tr_b16 v[36:37], v113 offset:40960
    v_mfma_f32_16x16x32_bf16 v[160:163], v[72:75], v[96:99], v[160:163]
    ds_read_b64_tr_b16 v[38:39], v113 offset:41984
    v_mfma_f32_16x16x32_bf16 v[176:179], v[76:79], v[96:99], v[176:179]
    ds_read_b128 v[52:55], v116 offset:2048
    v_mfma_f32_16x16x32_bf16 v[224:227], v[88:91], v[96:99], v[224:227]
    ds_read_b128 v[56:59], v116 offset:4096
    v_mfma_f32_16x16x32_bf16 v[240:243], v[92:95], v[96:99], v[240:243]
    ds_read_b128 v[60:63], v116 offset:6144
    v_mfma_f32_16x16x32_bf16 v[164:167], v[72:75], v[100:103], v[164:167]
    ds_read_b64_tr_b16 v[24:25], v114 offset:32768
    v_mfma_f32_16x16x32_bf16 v[180:183], v[76:79], v[100:103], v[180:183]
    ds_read_b64_tr_b16 v[26:27], v114 offset:33792
    v_mfma_f32_16x16x32_bf16 v[228:231], v[88:91], v[100:103], v[228:231]
    ds_read_b64_tr_b16 v[28:29], v115 offset:32768
    v_mfma_f32_16x16x32_bf16 v[244:247], v[92:95], v[100:103], v[244:247]
    s_waitcnt lgkmcnt(14)
    ds_read_b64_tr_b16 v[30:31], v115 offset:33792
    v_mfma_f32_16x16x32_bf16 v[168:171], v[72:75], v[104:107], v[168:171]
    s_waitcnt lgkmcnt(14)
    ds_read_b64_tr_b16 v[40:41], v114 offset:40960
    v_mfma_f32_16x16x32_bf16 v[184:187], v[76:79], v[104:107], v[184:187]
    s_waitcnt lgkmcnt(14)
    ds_read_b64_tr_b16 v[42:43], v114 offset:41984
    v_mfma_f32_16x16x32_bf16 v[232:235], v[88:91], v[104:107], v[232:235]
    s_waitcnt lgkmcnt(14)
    ds_read_b64_tr_b16 v[44:45], v115 offset:40960
    v_mfma_f32_16x16x32_bf16 v[248:251], v[92:95], v[104:107], v[248:251]
    s_waitcnt lgkmcnt(14)
    ds_read_b64_tr_b16 v[46:47], v115 offset:41984
    v_mfma_f32_16x16x32_bf16 v[172:175], v[72:75], v[108:111], v[172:175]
    v_mfma_f32_16x16x32_bf16 v[188:191], v[76:79], v[108:111], v[188:191]
    v_mfma_f32_16x16x32_bf16 v[236:239], v[88:91], v[108:111], v[236:239]
    v_mfma_f32_16x16x32_bf16 v[252:255], v[92:95], v[108:111], v[252:255]
CS211r:
    s_cmp_lt_u32 s31, 3
    s_cbranch_scc1 XS212
    s_cmp_eq_u32 s29, 1
    s_cbranch_scc1 XU213
    v_mfma_f32_16x16x32_bf16 v[0:3], v[64:67], v[124:127], v[0:3]
    v_mfma_f32_16x16x32_bf16 v[4:7], v[68:71], v[124:127], v[4:7]
    v_mfma_f32_16x16x32_bf16 v[8:11], v[72:75], v[124:127], v[8:11]
    v_mfma_f32_16x16x32_bf16 v[120:123], v[76:79], v[124:127], v[120:123]
    s_branch XS212
XU213:
    v_mfma_f32_16x16x32_bf16 v[0:3], v[80:83], v[124:127], v[0:3]
    v_mfma_f32_16x16x32_bf16 v[4:7], v[84:87], v[124:127], v[4:7]
    v_mfma_f32_16x16x32_bf16 v[8:11], v[88:91], v[124:127], v[8:11]
    v_mfma_f32_16x16x32_bf16 v[120:123], v[92:95], v[124:127], v[120:123]
XS212:
    v_mfma_f32_16x16x32_bf16 v[128:131], v[16:19], v[48:51], v[128:131]
    v_add_u32 v14, 1, v14
    v_mfma_f32_16x16x32_bf16 v[144:147], v[20:23], v[48:51], v[144:147]
    s_add_u32 s5, s5, s5
    s_cselect_b32 s8, s30, 16384
    s_waitcnt lgkmcnt(0)
    ds_write_b32 v118, v14
    v_mfma_f32_16x16x32_bf16 v[192:195], v[32:35], v[48:51], v[192:195]
    v_add_u32 v116, s8, v116
    v_mfma_f32_16x16x32_bf16 v[208:211], v[36:39], v[48:51], v[208:211]
    s_lshl_b32 s24, s29, 9
    v_add_u32 v124, s24, v13
    v_mfma_f32_16x16x32_bf16 v[132:135], v[16:19], v[52:55], v[132:135]
    v_mfma_f32_16x16x32_bf16 v[148:151], v[20:23], v[52:55], v[148:151]
    ds_read_b32 v12, v119
    s_mov_b32 exec_lo, 0x00010001
    s_mov_b32 exec_hi, 0x00010001
    ds_write_b128 v124, v[0:3] offset:0
    ds_write_b128 v124, v[4:7] offset:64
    s_mov_b64 exec, -1
    v_mfma_f32_16x16x32_bf16 v[196:199], v[32:35], v[52:55], v[196:199]
    s_mov_b32 exec_lo, 0x00010001
    s_mov_b32 exec_hi, 0x00010001
    ds_write_b128 v124, v[8:11] offset:128
    ds_write_b128 v124, v[120:123] offset:192
    s_mov_b64 exec, -1
    v_mfma_f32_16x16x32_bf16 v[212:215], v[36:39], v[52:55], v[212:215]
    v_mov_b32 v125, 1
    s_mov_b64 exec, 1
    ds_add_u32 v15, v125 offset:16
    s_mov_b64 exec, -1
    v_mfma_f32_16x16x32_bf16 v[136:139], v[16:19], v[56:59], v[136:139]
    v_mbcnt_lo_u32_b32 v0, -1, 0
    v_mbcnt_hi_u32_b32 v0, -1, v0
    v_mfma_f32_16x16x32_bf16 v[152:155], v[20:23], v[56:59], v[152:155]
    v_and_b32 v2, 15, v0
    s_lshl_b32 s24, s29, 8
    s_add_u32 s24, s24, 160768
    v_mfma_f32_16x16x32_bf16 v[200:203], v[32:35], v[56:59], v[200:203]
    v_lshl_add_u32 v120, v2, 2, s24
    v_lshlrev_b32 v122, 4, v0
    s_waitcnt lgkmcnt(0)
    v_cmp_le_u32 vcc, v12, v14
    v_mfma_f32_16x16x32_bf16 v[216:219], v[36:39], v[56:59], v[216:219]
    s_cbranch_vccnz CS214
    ds_read_b64_tr_b16 v[64:65], v112 offset:49152
    v_mfma_f32_16x16x32_bf16 v[140:143], v[16:19], v[60:63], v[140:143]
    ds_read_b64_tr_b16 v[66:67], v112 offset:50176
    v_mfma_f32_16x16x32_bf16 v[156:159], v[20:23], v[60:63], v[156:159]
    ds_read_b128 v[96:99], v117 offset:0
    v_mfma_f32_16x16x32_bf16 v[204:207], v[32:35], v[60:63], v[204:207]
    ds_read_b64_tr_b16 v[68:69], v113 offset:49152
    v_mfma_f32_16x16x32_bf16 v[220:223], v[36:39], v[60:63], v[220:223]
    ds_read_b64_tr_b16 v[70:71], v113 offset:50176
    v_mfma_f32_16x16x32_bf16 v[160:163], v[24:27], v[48:51], v[160:163]
    ds_read_b64_tr_b16 v[80:81], v112 offset:57344
    v_mfma_f32_16x16x32_bf16 v[176:179], v[28:31], v[48:51], v[176:179]
    ds_read_b64_tr_b16 v[82:83], v112 offset:58368
    v_mfma_f32_16x16x32_bf16 v[224:227], v[40:43], v[48:51], v[224:227]
    ds_read_b64_tr_b16 v[84:85], v113 offset:57344
    v_mfma_f32_16x16x32_bf16 v[240:243], v[44:47], v[48:51], v[240:243]
    ds_read_b64_tr_b16 v[86:87], v113 offset:58368
    v_mfma_f32_16x16x32_bf16 v[164:167], v[24:27], v[52:55], v[164:167]
    ds_read_b128 v[100:103], v117 offset:2048
    v_mfma_f32_16x16x32_bf16 v[180:183], v[28:31], v[52:55], v[180:183]
    ds_read_b128 v[104:107], v117 offset:4096
    v_mfma_f32_16x16x32_bf16 v[228:231], v[40:43], v[52:55], v[228:231]
    ds_read_b128 v[108:111], v117 offset:6144
    v_mfma_f32_16x16x32_bf16 v[244:247], v[44:47], v[52:55], v[244:247]
    ds_read_b64_tr_b16 v[72:73], v114 offset:49152
    v_mfma_f32_16x16x32_bf16 v[168:171], v[24:27], v[56:59], v[168:171]
    ds_read_b64_tr_b16 v[74:75], v114 offset:50176
    v_mfma_f32_16x16x32_bf16 v[184:187], v[28:31], v[56:59], v[184:187]
    ds_read_b64_tr_b16 v[76:77], v115 offset:49152
    v_mfma_f32_16x16x32_bf16 v[232:235], v[40:43], v[56:59], v[232:235]
    s_waitcnt lgkmcnt(14)
    ds_read_b64_tr_b16 v[78:79], v115 offset:50176
    v_mfma_f32_16x16x32_bf16 v[248:251], v[44:47], v[56:59], v[248:251]
    s_waitcnt lgkmcnt(14)
    ds_read_b64_tr_b16 v[88:89], v114 offset:57344
    v_mfma_f32_16x16x32_bf16 v[172:175], v[24:27], v[60:63], v[172:175]
    s_waitcnt lgkmcnt(14)
    ds_read_b64_tr_b16 v[90:91], v114 offset:58368
    v_mfma_f32_16x16x32_bf16 v[188:191], v[28:31], v[60:63], v[188:191]
    s_waitcnt lgkmcnt(14)
    ds_read_b64_tr_b16 v[92:93], v115 offset:57344
    v_mfma_f32_16x16x32_bf16 v[236:239], v[40:43], v[60:63], v[236:239]
    s_waitcnt lgkmcnt(14)
    ds_read_b64_tr_b16 v[94:95], v115 offset:58368
    v_mfma_f32_16x16x32_bf16 v[252:255], v[44:47], v[60:63], v[252:255]
CS214r:
    .p2alignl 3, 0xbf800000
L_CLOOP:
    v_mfma_f32_16x16x32_bf16 v[128:131], v[64:67], v[96:99], v[128:131]
    v_add_u32 v14, 1, v14
    v_mfma_f32_16x16x32_bf16 v[144:147], v[68:71], v[96:99], v[144:147]
    s_waitcnt lgkmcnt(0)
    ds_write_b32 v118, v14
    v_mfma_f32_16x16x32_bf16 v[192:195], v[80:83], v[96:99], v[192:195]
    v_add_u32 v117, s8, v117
    ds_read_b32 v12, v119
    v_mfma_f32_16x16x32_bf16 v[208:211], v[84:87], v[96:99], v[208:211]
    v_mfma_f32_16x16x32_bf16 v[132:135], v[64:67], v[100:103], v[132:135]
    v_mfma_f32_16x16x32_bf16 v[148:151], v[68:71], v[100:103], v[148:151]
    v_mfma_f32_16x16x32_bf16 v[196:199], v[80:83], v[100:103], v[196:199]
    v_mfma_f32_16x16x32_bf16 v[212:215], v[84:87], v[100:103], v[212:215]
    s_waitcnt lgkmcnt(0)
    v_cmp_le_u32 vcc, v12, v14
    v_mfma_f32_16x16x32_bf16 v[136:139], v[64:67], v[104:107], v[136:139]
    s_cbranch_vccnz CS215
    ds_read_b64_tr_b16 v[16:17], v112 offset:0
    v_mfma_f32_16x16x32_bf16 v[152:155], v[68:71], v[104:107], v[152:155]
    ds_read_b64_tr_b16 v[18:19], v112 offset:1024
    v_mfma_f32_16x16x32_bf16 v[200:203], v[80:83], v[104:107], v[200:203]
    ds_read_b128 v[48:51], v116 offset:0
    v_mfma_f32_16x16x32_bf16 v[216:219], v[84:87], v[104:107], v[216:219]
    ds_read_b64_tr_b16 v[20:21], v113 offset:0
    v_mfma_f32_16x16x32_bf16 v[140:143], v[64:67], v[108:111], v[140:143]
    ds_read_b64_tr_b16 v[22:23], v113 offset:1024
    v_mfma_f32_16x16x32_bf16 v[156:159], v[68:71], v[108:111], v[156:159]
    ds_read_b64_tr_b16 v[32:33], v112 offset:8192
    v_mfma_f32_16x16x32_bf16 v[204:207], v[80:83], v[108:111], v[204:207]
    ds_read_b64_tr_b16 v[34:35], v112 offset:9216
    v_mfma_f32_16x16x32_bf16 v[220:223], v[84:87], v[108:111], v[220:223]
    ds_read_b64_tr_b16 v[36:37], v113 offset:8192
    v_mfma_f32_16x16x32_bf16 v[160:163], v[72:75], v[96:99], v[160:163]
    ds_read_b64_tr_b16 v[38:39], v113 offset:9216
    v_mfma_f32_16x16x32_bf16 v[176:179], v[76:79], v[96:99], v[176:179]
    ds_read_b128 v[52:55], v116 offset:2048
    v_mfma_f32_16x16x32_bf16 v[224:227], v[88:91], v[96:99], v[224:227]
    ds_read_b128 v[56:59], v116 offset:4096
    v_mfma_f32_16x16x32_bf16 v[240:243], v[92:95], v[96:99], v[240:243]
    ds_read_b128 v[60:63], v116 offset:6144
    v_mfma_f32_16x16x32_bf16 v[164:167], v[72:75], v[100:103], v[164:167]
    ds_read_b64_tr_b16 v[24:25], v114 offset:0
    v_mfma_f32_16x16x32_bf16 v[180:183], v[76:79], v[100:103], v[180:183]
    ds_read_b64_tr_b16 v[26:27], v114 offset:1024
    v_mfma_f32_16x16x32_bf16 v[228:231], v[88:91], v[100:103], v[228:231]
    ds_read_b64_tr_b16 v[28:29], v115 offset:0
    v_mfma_f32_16x16x32_bf16 v[244:247], v[92:95], v[100:103], v[244:247]
    s_waitcnt lgkmcnt(14)
    ds_read_b64_tr_b16 v[30:31], v115 offset:1024
    v_mfma_f32_16x16x32_bf16 v[168:171], v[72:75], v[104:107], v[168:171]
    s_waitcnt lgkmcnt(14)
    ds_read_b64_tr_b16 v[40:41], v114 offset:8192
    v_mfma_f32_16x16x32_bf16 v[184:187], v[76:79], v[104:107], v[184:187]
    s_waitcnt lgkmcnt(14)
    ds_read_b64_tr_b16 v[42:43], v114 offset:9216
    v_mfma_f32_16x16x32_bf16 v[232:235], v[88:91], v[104:107], v[232:235]
    s_waitcnt lgkmcnt(14)
    ds_read_b64_tr_b16 v[44:45], v115 offset:8192
    v_mfma_f32_16x16x32_bf16 v[248:251], v[92:95], v[104:107], v[248:251]
    s_waitcnt lgkmcnt(14)
    ds_read_b64_tr_b16 v[46:47], v115 offset:9216
    v_mfma_f32_16x16x32_bf16 v[172:175], v[72:75], v[108:111], v[172:175]
    v_mfma_f32_16x16x32_bf16 v[188:191], v[76:79], v[108:111], v[188:191]
    v_mfma_f32_16x16x32_bf16 v[236:239], v[88:91], v[108:111], v[236:239]
    v_mfma_f32_16x16x32_bf16 v[252:255], v[92:95], v[108:111], v[252:255]
CS215r:
    v_mfma_f32_16x16x32_bf16 v[128:131], v[16:19], v[48:51], v[128:131]
    v_add_u32 v14, 1, v14
    v_mfma_f32_16x16x32_bf16 v[144:147], v[20:23], v[48:51], v[144:147]
    s_add_u32 s5, s5, s5
    s_cselect_b32 s8, s30, 16384
    s_waitcnt lgkmcnt(0)
    ds_write_b32 v118, v14
    v_mfma_f32_16x16x32_bf16 v[192:195], v[32:35], v[48:51], v[192:195]
    v_add_u32 v116, s8, v116
    ds_read_b32 v12, v119
    v_mfma_f32_16x16x32_bf16 v[208:211], v[36:39], v[48:51], v[208:211]
    v_mfma_f32_16x16x32_bf16 v[132:135], v[16:19], v[52:55], v[132:135]
    v_mfma_f32_16x16x32_bf16 v[148:151], v[20:23], v[52:55], v[148:151]
    v_mfma_f32_16x16x32_bf16 v[196:199], v[32:35], v[52:55], v[196:199]
    v_mfma_f32_16x16x32_bf16 v[212:215], v[36:39], v[52:55], v[212:215]
    s_waitcnt lgkmcnt(0)
    v_cmp_le_u32 vcc, v12, v14
    v_mfma_f32_16x16x32_bf16 v[136:139], v[16:19], v[56:59], v[136:139]
    s_cbranch_vccnz CS216
    ds_read_b64_tr_b16 v[64:65], v112 offset:16384
    v_mfma_f32_16x16x32_bf16 v[152:155], v[20:23], v[56:59], v[152:155]
    ds_read_b64_tr_b16 v[66:67], v112 offset:17408
    v_mfma_f32_16x16x32_bf16 v[200:203], v[32:35], v[56:59], v[200:203]
    ds_read_b128 v[96:99], v117 offset:0
    v_mfma_f32_16x16x32_bf16 v[216:219], v[36:39], v[56:59], v[216:219]
    ds_read_b64_tr_b16 v[68:69], v113 offset:16384
    v_mfma_f32_16x16x32_bf16 v[140:143], v[16:19], v[60:63], v[140:143]
    ds_read_b64_tr_b16 v[70:71], v113 offset:17408
    v_mfma_f32_16x16x32_bf16 v[156:159], v[20:23], v[60:63], v[156:159]
    ds_read_b64_tr_b16 v[80:81], v112 offset:24576
    v_mfma_f32_16x16x32_bf16 v[204:207], v[32:35], v[60:63], v[204:207]
    ds_read_b64_tr_b16 v[82:83], v112 offset:25600
    v_mfma_f32_16x16x32_bf16 v[220:223], v[36:39], v[60:63], v[220:223]
    ds_read_b64_tr_b16 v[84:85], v113 offset:24576
    v_mfma_f32_16x16x32_bf16 v[160:163], v[24:27], v[48:51], v[160:163]
    ds_read_b64_tr_b16 v[86:87], v113 offset:25600
    v_mfma_f32_16x16x32_bf16 v[176:179], v[28:31], v[48:51], v[176:179]
    ds_read_b128 v[100:103], v117 offset:2048
    v_mfma_f32_16x16x32_bf16 v[224:227], v[40:43], v[48:51], v[224:227]
    ds_read_b128 v[104:107], v117 offset:4096
    v_mfma_f32_16x16x32_bf16 v[240:243], v[44:47], v[48:51], v[240:243]
    ds_read_b128 v[108:111], v117 offset:6144
    v_mfma_f32_16x16x32_bf16 v[164:167], v[24:27], v[52:55], v[164:167]
    ds_read_b64_tr_b16 v[72:73], v114 offset:16384
    v_mfma_f32_16x16x32_bf16 v[180:183], v[28:31], v[52:55], v[180:183]
    ds_read_b64_tr_b16 v[74:75], v114 offset:17408
    v_mfma_f32_16x16x32_bf16 v[228:231], v[40:43], v[52:55], v[228:231]
    ds_read_b64_tr_b16 v[76:77], v115 offset:16384
    v_mfma_f32_16x16x32_bf16 v[244:247], v[44:47], v[52:55], v[244:247]
    s_waitcnt lgkmcnt(14)
    ds_read_b64_tr_b16 v[78:79], v115 offset:17408
    v_mfma_f32_16x16x32_bf16 v[168:171], v[24:27], v[56:59], v[168:171]
    s_waitcnt lgkmcnt(14)
    ds_read_b64_tr_b16 v[88:89], v114 offset:24576
    v_mfma_f32_16x16x32_bf16 v[184:187], v[28:31], v[56:59], v[184:187]
    s_waitcnt lgkmcnt(14)
    ds_read_b64_tr_b16 v[90:91], v114 offset:25600
    v_mfma_f32_16x16x32_bf16 v[232:235], v[40:43], v[56:59], v[232:235]
    s_waitcnt lgkmcnt(14)
    ds_read_b64_tr_b16 v[92:93], v115 offset:24576
    v_mfma_f32_16x16x32_bf16 v[248:251], v[44:47], v[56:59], v[248:251]
    s_waitcnt lgkmcnt(14)
    ds_read_b64_tr_b16 v[94:95], v115 offset:25600
    v_mfma_f32_16x16x32_bf16 v[172:175], v[24:27], v[60:63], v[172:175]
    v_mfma_f32_16x16x32_bf16 v[188:191], v[28:31], v[60:63], v[188:191]
    v_mfma_f32_16x16x32_bf16 v[236:239], v[40:43], v[60:63], v[236:239]
    v_mfma_f32_16x16x32_bf16 v[252:255], v[44:47], v[60:63], v[252:255]
CS216r:
    v_mfma_f32_16x16x32_bf16 v[128:131], v[64:67], v[96:99], v[128:131]
    v_add_u32 v14, 1, v14
    v_mfma_f32_16x16x32_bf16 v[144:147], v[68:71], v[96:99], v[144:147]
    s_waitcnt lgkmcnt(0)
    ds_write_b32 v118, v14
    v_mfma_f32_16x16x32_bf16 v[192:195], v[80:83], v[96:99], v[192:195]
    v_add_u32 v117, s8, v117
    ds_read_b32 v12, v119
    v_mfma_f32_16x16x32_bf16 v[208:211], v[84:87], v[96:99], v[208:211]
    v_mfma_f32_16x16x32_bf16 v[132:135], v[64:67], v[100:103], v[132:135]
    v_mfma_f32_16x16x32_bf16 v[148:151], v[68:71], v[100:103], v[148:151]
    v_mfma_f32_16x16x32_bf16 v[196:199], v[80:83], v[100:103], v[196:199]
    v_mfma_f32_16x16x32_bf16 v[212:215], v[84:87], v[100:103], v[212:215]
    s_waitcnt lgkmcnt(0)
    v_cmp_le_u32 vcc, v12, v14
    v_mfma_f32_16x16x32_bf16 v[136:139], v[64:67], v[104:107], v[136:139]
    s_cbranch_vccnz CS217
    ds_read_b64_tr_b16 v[16:17], v112 offset:32768
    v_mfma_f32_16x16x32_bf16 v[152:155], v[68:71], v[104:107], v[152:155]
    ds_read_b64_tr_b16 v[18:19], v112 offset:33792
    v_mfma_f32_16x16x32_bf16 v[200:203], v[80:83], v[104:107], v[200:203]
    ds_read_b128 v[48:51], v116 offset:0
    v_mfma_f32_16x16x32_bf16 v[216:219], v[84:87], v[104:107], v[216:219]
    ds_read_b64_tr_b16 v[20:21], v113 offset:32768
    v_mfma_f32_16x16x32_bf16 v[140:143], v[64:67], v[108:111], v[140:143]
    ds_read_b64_tr_b16 v[22:23], v113 offset:33792
    v_mfma_f32_16x16x32_bf16 v[156:159], v[68:71], v[108:111], v[156:159]
    ds_read_b64_tr_b16 v[32:33], v112 offset:40960
    v_mfma_f32_16x16x32_bf16 v[204:207], v[80:83], v[108:111], v[204:207]
    ds_read_b64_tr_b16 v[34:35], v112 offset:41984
    v_mfma_f32_16x16x32_bf16 v[220:223], v[84:87], v[108:111], v[220:223]
    ds_read_b64_tr_b16 v[36:37], v113 offset:40960
    v_mfma_f32_16x16x32_bf16 v[160:163], v[72:75], v[96:99], v[160:163]
    ds_read_b64_tr_b16 v[38:39], v113 offset:41984
    v_mfma_f32_16x16x32_bf16 v[176:179], v[76:79], v[96:99], v[176:179]
    ds_read_b128 v[52:55], v116 offset:2048
    v_mfma_f32_16x16x32_bf16 v[224:227], v[88:91], v[96:99], v[224:227]
    ds_read_b128 v[56:59], v116 offset:4096
    v_mfma_f32_16x16x32_bf16 v[240:243], v[92:95], v[96:99], v[240:243]
    ds_read_b128 v[60:63], v116 offset:6144
    v_mfma_f32_16x16x32_bf16 v[164:167], v[72:75], v[100:103], v[164:167]
    ds_read_b64_tr_b16 v[24:25], v114 offset:32768
    v_mfma_f32_16x16x32_bf16 v[180:183], v[76:79], v[100:103], v[180:183]
    ds_read_b64_tr_b16 v[26:27], v114 offset:33792
    v_mfma_f32_16x16x32_bf16 v[228:231], v[88:91], v[100:103], v[228:231]
    ds_read_b64_tr_b16 v[28:29], v115 offset:32768
    v_mfma_f32_16x16x32_bf16 v[244:247], v[92:95], v[100:103], v[244:247]
    s_waitcnt lgkmcnt(14)
    ds_read_b64_tr_b16 v[30:31], v115 offset:33792
    v_mfma_f32_16x16x32_bf16 v[168:171], v[72:75], v[104:107], v[168:171]
    s_waitcnt lgkmcnt(14)
    ds_read_b64_tr_b16 v[40:41], v114 offset:40960
    v_mfma_f32_16x16x32_bf16 v[184:187], v[76:79], v[104:107], v[184:187]
    s_waitcnt lgkmcnt(14)
    ds_read_b64_tr_b16 v[42:43], v114 offset:41984
    v_mfma_f32_16x16x32_bf16 v[232:235], v[88:91], v[104:107], v[232:235]
    s_waitcnt lgkmcnt(14)
    ds_read_b64_tr_b16 v[44:45], v115 offset:40960
    v_mfma_f32_16x16x32_bf16 v[248:251], v[92:95], v[104:107], v[248:251]
    s_waitcnt lgkmcnt(14)
    ds_read_b64_tr_b16 v[46:47], v115 offset:41984
    v_mfma_f32_16x16x32_bf16 v[172:175], v[72:75], v[108:111], v[172:175]
    v_mfma_f32_16x16x32_bf16 v[188:191], v[76:79], v[108:111], v[188:191]
    v_mfma_f32_16x16x32_bf16 v[236:239], v[88:91], v[108:111], v[236:239]
    v_mfma_f32_16x16x32_bf16 v[252:255], v[92:95], v[108:111], v[252:255]
CS217r:
    v_mfma_f32_16x16x32_bf16 v[128:131], v[16:19], v[48:51], v[128:131]
    v_add_u32 v14, 1, v14
    v_mfma_f32_16x16x32_bf16 v[144:147], v[20:23], v[48:51], v[144:147]
    s_add_u32 s5, s5, s5
    s_cselect_b32 s8, s30, 16384
    s_waitcnt lgkmcnt(0)
    ds_write_b32 v118, v14
    v_mfma_f32_16x16x32_bf16 v[192:195], v[32:35], v[48:51], v[192:195]
    v_add_u32 v116, s8, v116
    ds_read_b32 v12, v119
    v_mfma_f32_16x16x32_bf16 v[208:211], v[36:39], v[48:51], v[208:211]
    v_mfma_f32_16x16x32_bf16 v[132:135], v[16:19], v[52:55], v[132:135]
    v_mfma_f32_16x16x32_bf16 v[148:151], v[20:23], v[52:55], v[148:151]
    v_mfma_f32_16x16x32_bf16 v[196:199], v[32:35], v[52:55], v[196:199]
    v_mfma_f32_16x16x32_bf16 v[212:215], v[36:39], v[52:55], v[212:215]
    s_waitcnt lgkmcnt(0)
    v_cmp_le_u32 vcc, v12, v14
    v_mfma_f32_16x16x32_bf16 v[136:139], v[16:19], v[56:59], v[136:139]
    s_cbranch_vccnz CS218
    ds_read_b64_tr_b16 v[64:65], v112 offset:49152
    v_mfma_f32_16x16x32_bf16 v[152:155], v[20:23], v[56:59], v[152:155]
    ds_read_b64_tr_b16 v[66:67], v112 offset:50176
    v_mfma_f32_16x16x32_bf16 v[200:203], v[32:35], v[56:59], v[200:203]
    ds_read_b128 v[96:99], v117 offset:0
    v_mfma_f32_16x16x32_bf16 v[216:219], v[36:39], v[56:59], v[216:219]
    ds_read_b64_tr_b16 v[68:69], v113 offset:49152
    v_mfma_f32_16x16x32_bf16 v[140:143], v[16:19], v[60:63], v[140:143]
    ds_read_b64_tr_b16 v[70:71], v113 offset:50176
    v_mfma_f32_16x16x32_bf16 v[156:159], v[20:23], v[60:63], v[156:159]
    ds_read_b64_tr_b16 v[80:81], v112 offset:57344
    v_mfma_f32_16x16x32_bf16 v[204:207], v[32:35], v[60:63], v[204:207]
    ds_read_b64_tr_b16 v[82:83], v112 offset:58368
    v_mfma_f32_16x16x32_bf16 v[220:223], v[36:39], v[60:63], v[220:223]
    ds_read_b64_tr_b16 v[84:85], v113 offset:57344
    v_mfma_f32_16x16x32_bf16 v[160:163], v[24:27], v[48:51], v[160:163]
    ds_read_b64_tr_b16 v[86:87], v113 offset:58368
    v_mfma_f32_16x16x32_bf16 v[176:179], v[28:31], v[48:51], v[176:179]
    ds_read_b128 v[100:103], v117 offset:2048
    v_mfma_f32_16x16x32_bf16 v[224:227], v[40:43], v[48:51], v[224:227]
    ds_read_b128 v[104:107], v117 offset:4096
    v_mfma_f32_16x16x32_bf16 v[240:243], v[44:47], v[48:51], v[240:243]
    ds_read_b128 v[108:111], v117 offset:6144
    v_mfma_f32_16x16x32_bf16 v[164:167], v[24:27], v[52:55], v[164:167]
    ds_read_b64_tr_b16 v[72:73], v114 offset:49152
    v_mfma_f32_16x16x32_bf16 v[180:183], v[28:31], v[52:55], v[180:183]
    ds_read_b64_tr_b16 v[74:75], v114 offset:50176
    v_mfma_f32_16x16x32_bf16 v[228:231], v[40:43], v[52:55], v[228:231]
    ds_read_b64_tr_b16 v[76:77], v115 offset:49152
    v_mfma_f32_16x16x32_bf16 v[244:247], v[44:47], v[52:55], v[244:247]
    s_waitcnt lgkmcnt(14)
    ds_read_b64_tr_b16 v[78:79], v115 offset:50176
    v_mfma_f32_16x16x32_bf16 v[168:171], v[24:27], v[56:59], v[168:171]
    s_waitcnt lgkmcnt(14)
    ds_read_b64_tr_b16 v[88:89], v114 offset:57344
    v_mfma_f32_16x16x32_bf16 v[184:187], v[28:31], v[56:59], v[184:187]
    s_waitcnt lgkmcnt(14)
    ds_read_b64_tr_b16 v[90:91], v114 offset:58368
    v_mfma_f32_16x16x32_bf16 v[232:235], v[40:43], v[56:59], v[232:235]
    s_waitcnt lgkmcnt(14)
    ds_read_b64_tr_b16 v[92:93], v115 offset:57344
    v_mfma_f32_16x16x32_bf16 v[248:251], v[44:47], v[56:59], v[248:251]
    s_waitcnt lgkmcnt(14)
    ds_read_b64_tr_b16 v[94:95], v115 offset:58368
    v_mfma_f32_16x16x32_bf16 v[172:175], v[24:27], v[60:63], v[172:175]
    v_mfma_f32_16x16x32_bf16 v[188:191], v[28:31], v[60:63], v[188:191]
    s_sub_u32 s4, s4, 1
    v_mfma_f32_16x16x32_bf16 v[236:239], v[40:43], v[60:63], v[236:239]
    v_mfma_f32_16x16x32_bf16 v[252:255], v[44:47], v[60:63], v[252:255]
CS218r:
    s_cbranch_scc0 L_CLOOP
    v_mfma_f32_16x16x32_bf16 v[128:131], v[64:67], v[96:99], v[128:131]
    s_waitcnt lgkmcnt(14)
    ds_read_b32 v12, v15 offset:40
    s_waitcnt lgkmcnt(14)
    ds_read_b32 v7, v15 offset:20
    s_waitcnt lgkmcnt(14)
    ds_read_b32 v48, v120 offset:0
    s_waitcnt lgkmcnt(14)
    ds_read_b32 v50, v120 offset:64
    s_waitcnt lgkmcnt(14)
    ds_read_b32 v52, v120 offset:128
    s_waitcnt lgkmcnt(14)
    ds_read_b32 v54, v120 offset:192
    v_mfma_f32_16x16x32_bf16 v[144:147], v[68:71], v[96:99], v[144:147]
    v_mfma_f32_16x16x32_bf16 v[192:195], v[80:83], v[96:99], v[192:195]
    v_mfma_f32_16x16x32_bf16 v[208:211], v[84:87], v[96:99], v[208:211]
    s_waitcnt lgkmcnt(14)
    ds_read_b128 v[16:19], v13 offset:0
    s_waitcnt lgkmcnt(14)
    ds_read_b128 v[20:23], v13 offset:64
    s_waitcnt lgkmcnt(14)
    ds_read_b128 v[32:35], v13 offset:512
    s_waitcnt lgkmcnt(14)
    ds_read_b128 v[36:39], v13 offset:576
    v_mfma_f32_16x16x32_bf16 v[132:135], v[64:67], v[100:103], v[132:135]
    v_mfma_f32_16x16x32_bf16 v[148:151], v[68:71], v[100:103], v[148:151]
    v_mfma_f32_16x16x32_bf16 v[196:199], v[80:83], v[100:103], v[196:199]
    s_waitcnt lgkmcnt(14)
    ds_read_b128 v[24:27], v13 offset:128
    s_waitcnt lgkmcnt(14)
    ds_read_b128 v[28:31], v13 offset:192
    s_waitcnt lgkmcnt(14)
    ds_read_b128 v[40:43], v13 offset:640
    s_waitcnt lgkmcnt(14)
    ds_read_b128 v[44:47], v13 offset:704
    v_mfma_f32_16x16x32_bf16 v[212:215], v[84:87], v[100:103], v[212:215]
    v_mfma_f32_16x16x32_bf16 v[136:139], v[64:67], v[104:107], v[136:139]
    s_waitcnt lgkmcnt(13)
    v_cmp_gt_u32 vcc, 2, v12
    v_mfma_f32_16x16x32_bf16 v[152:155], v[68:71], v[104:107], v[152:155]
    s_cbranch_vccnz L_EPS
L_EPB:
    v_mfma_f32_16x16x32_bf16 v[200:203], v[80:83], v[104:107], v[200:203]
    s_waitcnt lgkmcnt(0)
    v_fma_f32 v128, -v48, v16, v128
    v_fma_f32 v129, -v48, v17, v129
    v_fma_f32 v130, -v48, v18, v130
    v_mfma_f32_16x16x32_bf16 v[216:219], v[84:87], v[104:107], v[216:219]
    v_fma_f32 v131, -v48, v19, v131
    v_fma_f32 v144, -v48, v20, v144
    v_fma_f32 v145, -v48, v21, v145
    v_mfma_f32_16x16x32_bf16 v[140:143], v[64:67], v[108:111], v[140:143]
    v_fma_f32 v146, -v48, v22, v146
    v_fma_f32 v147, -v48, v23, v147
    v_fma_f32 v192, -v48, v32, v192
    v_mfma_f32_16x16x32_bf16 v[156:159], v[68:71], v[108:111], v[156:159]
    v_fma_f32 v193, -v48, v33, v193
    v_fma_f32 v194, -v48, v34, v194
    v_fma_f32 v195, -v48, v35, v195
    v_mfma_f32_16x16x32_bf16 v[204:207], v[80:83], v[108:111], v[204:207]
    v_fma_f32 v208, -v48, v36, v208
    v_fma_f32 v209, -v48, v37, v209
    v_fma_f32 v210, -v48, v38, v210
    v_mfma_f32_16x16x32_bf16 v[220:223], v[84:87], v[108:111], v[220:223]
    v_fma_f32 v211, -v48, v39, v211
    v_max_f32 v128, 0, v128
    v_max_f32 v129, 0, v129
    v_mfma_f32_16x16x32_bf16 v[160:163], v[72:75], v[96:99], v[160:163]
    v_max_f32 v130, 0, v130
    v_max_f32 v131, 0, v131
    v_max_f32 v144, 0, v144
    v_mfma_f32_16x16x32_bf16 v[176:179], v[76:79], v[96:99], v[176:179]
    v_max_f32 v145, 0, v145
    v_max_f32 v146, 0, v146
    v_max_f32 v147, 0, v147
    v_mfma_f32_16x16x32_bf16 v[224:227], v[88:91], v[96:99], v[224:227]
    v_mul_f32 v128, v128, v192
    v_mul_f32 v129, v129, v193
    v_mul_f32 v130, v130, v194
    v_mfma_f32_16x16x32_bf16 v[240:243], v[92:95], v[96:99], v[240:243]
    v_mul_f32 v131, v131, v195
    v_mul_f32 v144, v144, v208
    v_mul_f32 v145, v145, v209
    v_mfma_f32_16x16x32_bf16 v[164:167], v[72:75], v[100:103], v[164:167]
    v_mul_f32 v146, v146, v210
    v_mul_f32 v147, v147, v211
    v_cvt_pk_bf16_f32 v192, v128, v129
    v_mfma_f32_16x16x32_bf16 v[180:183], v[76:79], v[100:103], v[180:183]
    v_cvt_pk_bf16_f32 v193, v130, v131
    v_cvt_pk_bf16_f32 v194, v144, v145
    v_cvt_pk_bf16_f32 v195, v146, v147
    v_mfma_f32_16x16x32_bf16 v[228:231], v[88:91], v[100:103], v[228:231]
    buffer_store_dwordx4 v[192:195], v122, s[20:23], s27 offen offset:0 sc1
    v_fma_f32 v132, -v50, v16, v132
    v_fma_f32 v133, -v50, v17, v133
    v_mfma_f32_16x16x32_bf16 v[244:247], v[92:95], v[100:103], v[244:247]
    v_fma_f32 v134, -v50, v18, v134
    v_fma_f32 v135, -v50, v19, v135
    v_fma_f32 v148, -v50, v20, v148
    v_mfma_f32_16x16x32_bf16 v[168:171], v[72:75], v[104:107], v[168:171]
    v_fma_f32 v149, -v50, v21, v149
    v_fma_f32 v150, -v50, v22, v150
    v_fma_f32 v151, -v50, v23, v151
    v_mfma_f32_16x16x32_bf16 v[184:187], v[76:79], v[104:107], v[184:187]
    v_fma_f32 v196, -v50, v32, v196
    v_fma_f32 v197, -v50, v33, v197
    v_fma_f32 v198, -v50, v34, v198
    v_mfma_f32_16x16x32_bf16 v[232:235], v[88:91], v[104:107], v[232:235]
    v_fma_f32 v199, -v50, v35, v199
    v_fma_f32 v212, -v50, v36, v212
    v_fma_f32 v213, -v50, v37, v213
    v_mfma_f32_16x16x32_bf16 v[248:251], v[92:95], v[104:107], v[248:251]
    v_fma_f32 v214, -v50, v38, v214
    v_fma_f32 v215, -v50, v39, v215
    v_max_f32 v132, 0, v132
    v_mfma_f32_16x16x32_bf16 v[172:175], v[72:75], v[108:111], v[172:175]
    v_max_f32 v133, 0, v133
    v_max_f32 v134, 0, v134
    v_max_f32 v135, 0, v135
    v_mfma_f32_16x16x32_bf16 v[188:191], v[76:79], v[108:111], v[188:191]
    v_max_f32 v148, 0, v148
    v_max_f32 v149, 0, v149
    v_max_f32 v150, 0, v150
    v_mfma_f32_16x16x32_bf16 v[236:239], v[88:91], v[108:111], v[236:239]
    v_max_f32 v151, 0, v151
    v_mul_f32 v132, v132, v196
    v_mul_f32 v133, v133, v197
    v_mfma_f32_16x16x32_bf16 v[252:255], v[92:95], v[108:111], v[252:255]
    v_mul_f32 v134, v134, v198
    v_mul_f32 v135, v135, v199
    v_mul_f32 v148, v148, v212
    v_mov_b32 v49, v48
    v_mov_b32 v51, v50
    v_mov_b32 v53, v52
    v_mov_b32 v55, v54
    v_mul_f32 v149, v149, v213
    v_mul_f32 v150, v150, v214
    v_mul_f32 v151, v151, v215
    v_cvt_pk_bf16_f32 v196, v132, v133
    v_cvt_pk_bf16_f32 v197, v134, v135
    v_cvt_pk_bf16_f32 v198, v148, v149
    v_cvt_pk_bf16_f32 v199, v150, v151
    buffer_store_dwordx4 v[196:199], v122, s[20:23], s27 offen offset:1024 sc1
    v_pk_fma_f32 v[136:137], v[52:53], v[16:17], v[136:137] neg_lo:[1,0,0] neg_hi:[1,0,0]
    v_pk_fma_f32 v[138:139], v[52:53], v[18:19], v[138:139] neg_lo:[1,0,0] neg_hi:[1,0,0]
    v_pk_fma_f32 v[152:153], v[52:53], v[20:21], v[152:153] neg_lo:[1,0,0] neg_hi:[1,0,0]
    v_pk_fma_f32 v[154:155], v[52:53], v[22:23], v[154:155] neg_lo:[1,0,0] neg_hi:[1,0,0]
    v_pk_fma_f32 v[200:201], v[52:53], v[32:33], v[200:201] neg_lo:[1,0,0] neg_hi:[1,0,0]
    v_pk_fma_f32 v[202:203], v[52:53], v[34:35], v[202:203] neg_lo:[1,0,0] neg_hi:[1,0,0]
    v_pk_fma_f32 v[216:217], v[52:53], v[36:37], v[216:217] neg_lo:[1,0,0] neg_hi:[1,0,0]
    v_pk_fma_f32 v[218:219], v[52:53], v[38:39], v[218:219] neg_lo:[1,0,0] neg_hi:[1,0,0]
    v_max_f32 v136, 0, v136
    v_max_f32 v137, 0, v137
    v_max_f32 v138, 0, v138
    v_max_f32 v139, 0, v139
    v_max_f32 v152, 0, v152
    v_max_f32 v153, 0, v153
    v_max_f32 v154, 0, v154
    v_max_f32 v155, 0, v155
    v_pk_mul_f32 v[136:137], v[136:137], v[200:201]
    v_pk_mul_f32 v[138:139], v[138:139], v[202:203]
    v_pk_mul_f32 v[152:153], v[152:153], v[216:217]
    v_pk_mul_f32 v[154:155], v[154:155], v[218:219]
    v_cvt_pk_bf16_f32 v200, v136, v137
    v_cvt_pk_bf16_f32 v201, v138, v139
    v_cvt_pk_bf16_f32 v202, v152, v153
    v_cvt_pk_bf16_f32 v203, v154, v155
    buffer_store_dwordx4 v[200:203], v122, s[20:23], s27 offen offset:2048 sc1
    v_pk_fma_f32 v[140:141], v[54:55], v[16:17], v[140:141] neg_lo:[1,0,0] neg_hi:[1,0,0]
    v_pk_fma_f32 v[142:143], v[54:55], v[18:19], v[142:143] neg_lo:[1,0,0] neg_hi:[1,0,0]
    v_pk_fma_f32 v[156:157], v[54:55], v[20:21], v[156:157] neg_lo:[1,0,0] neg_hi:[1,0,0]
    v_pk_fma_f32 v[158:159], v[54:55], v[22:23], v[158:159] neg_lo:[1,0,0] neg_hi:[1,0,0]
    v_pk_fma_f32 v[204:205], v[54:55], v[32:33], v[204:205] neg_lo:[1,0,0] neg_hi:[1,0,0]
    v_pk_fma_f32 v[206:207], v[54:55], v[34:35], v[206:207] neg_lo:[1,0,0] neg_hi:[1,0,0]
    v_pk_fma_f32 v[220:221], v[54:55], v[36:37], v[220:221] neg_lo:[1,0,0] neg_hi:[1,0,0]
    v_pk_fma_f32 v[222:223], v[54:55], v[38:39], v[222:223] neg_lo:[1,0,0] neg_hi:[1,0,0]
    v_max_f32 v140, 0, v140
    v_max_f32 v141, 0, v141
    v_max_f32 v142, 0, v142
    v_max_f32 v143, 0, v143
    v_max_f32 v156, 0, v156
    v_max_f32 v157, 0, v157
    v_max_f32 v158, 0, v158
    v_max_f32 v159, 0, v159
    v_pk_mul_f32 v[140:141], v[140:141], v[204:205]
    v_pk_mul_f32 v[142:143], v[142:143], v[206:207]
    v_pk_mul_f32 v[156:157], v[156:157], v[220:221]
    v_pk_mul_f32 v[158:159], v[158:159], v[222:223]
    v_cvt_pk_bf16_f32 v204, v140, v141
    v_cvt_pk_bf16_f32 v205, v142, v143
    v_cvt_pk_bf16_f32 v206, v156, v157
    v_cvt_pk_bf16_f32 v207, v158, v159
    buffer_store_dwordx4 v[204:207], v122, s[20:23], s27 offen offset:3072 sc1
    s_add_u32 s27, s27, 131072
    v_pk_fma_f32 v[160:161], v[48:49], v[24:25], v[160:161] neg_lo:[1,0,0] neg_hi:[1,0,0]
    v_pk_fma_f32 v[162:163], v[48:49], v[26:27], v[162:163] neg_lo:[1,0,0] neg_hi:[1,0,0]
    v_pk_fma_f32 v[176:177], v[48:49], v[28:29], v[176:177] neg_lo:[1,0,0] neg_hi:[1,0,0]
    v_pk_fma_f32 v[178:179], v[48:49], v[30:31], v[178:179] neg_lo:[1,0,0] neg_hi:[1,0,0]
    v_pk_fma_f32 v[224:225], v[48:49], v[40:41], v[224:225] neg_lo:[1,0,0] neg_hi:[1,0,0]
    v_pk_fma_f32 v[226:227], v[48:49], v[42:43], v[226:227] neg_lo:[1,0,0] neg_hi:[1,0,0]
    v_pk_fma_f32 v[240:241], v[48:49], v[44:45], v[240:241] neg_lo:[1,0,0] neg_hi:[1,0,0]
    v_pk_fma_f32 v[242:243], v[48:49], v[46:47], v[242:243] neg_lo:[1,0,0] neg_hi:[1,0,0]
    v_max_f32 v160, 0, v160
    v_max_f32 v161, 0, v161
    v_max_f32 v162, 0, v162
    v_max_f32 v163, 0, v163
    v_max_f32 v176, 0, v176
    v_max_f32 v177, 0, v177
    v_max_f32 v178, 0, v178
    v_max_f32 v179, 0, v179
    v_pk_mul_f32 v[160:161], v[160:161], v[224:225]
    v_pk_mul_f32 v[162:163], v[162:163], v[226:227]
    v_pk_mul_f32 v[176:177], v[176:177], v[240:241]
    v_pk_mul_f32 v[178:179], v[178:179], v[242:243]
    v_cvt_pk_bf16_f32 v224, v160, v161
    v_cvt_pk_bf16_f32 v225, v162, v163
    v_cvt_pk_bf16_f32 v226, v176, v177
    v_cvt_pk_bf16_f32 v227, v178, v179
    buffer_store_dwordx4 v[224:227], v122, s[20:23], s27 offen offset:0 sc1
    v_pk_fma_f32 v[164:165], v[50:51], v[24:25], v[164:165] neg_lo:[1,0,0] neg_hi:[1,0,0]
    v_pk_fma_f32 v[166:167], v[50:51], v[26:27], v[166:167] neg_lo:[1,0,0] neg_hi:[1,0,0]
    v_pk_fma_f32 v[180:181], v[50:51], v[28:29], v[180:181] neg_lo:[1,0,0] neg_hi:[1,0,0]
    v_pk_fma_f32 v[182:183], v[50:51], v[30:31], v[182:183] neg_lo:[1,0,0] neg_hi:[1,0,0]
    v_pk_fma_f32 v[228:229], v[50:51], v[40:41], v[228:229] neg_lo:[1,0,0] neg_hi:[1,0,0]
    v_pk_fma_f32 v[230:231], v[50:51], v[42:43], v[230:231] neg_lo:[1,0,0] neg_hi:[1,0,0]
    v_pk_fma_f32 v[244:245], v[50:51], v[44:45], v[244:245] neg_lo:[1,0,0] neg_hi:[1,0,0]
    v_pk_fma_f32 v[246:247], v[50:51], v[46:47], v[246:247] neg_lo:[1,0,0] neg_hi:[1,0,0]
    v_max_f32 v164, 0, v164
    v_max_f32 v165, 0, v165
    v_max_f32 v166, 0, v166
    v_max_f32 v167, 0, v167
    v_max_f32 v180, 0, v180
    v_max_f32 v181, 0, v181
    v_max_f32 v182, 0, v182
    v_max_f32 v183, 0, v183
    v_pk_mul_f32 v[164:165], v[164:165], v[228:229]
    v_pk_mul_f32 v[166:167], v[166:167], v[230:231]
    v_pk_mul_f32 v[180:181], v[180:181], v[244:245]
    v_pk_mul_f32 v[182:183], v[182:183], v[246:247]
    v_cvt_pk_bf16_f32 v228, v164, v165
    v_cvt_pk_bf16_f32 v229, v166, v167
    v_cvt_pk_bf16_f32 v230, v180, v181
    v_cvt_pk_bf16_f32 v231, v182, v183
    buffer_store_dwordx4 v[228:231], v122, s[20:23], s27 offen offset:1024 sc1
    v_pk_fma_f32 v[168:169], v[52:53], v[24:25], v[168:169] neg_lo:[1,0,0] neg_hi:[1,0,0]
    v_pk_fma_f32 v[170:171], v[52:53], v[26:27], v[170:171] neg_lo:[1,0,0] neg_hi:[1,0,0]
    v_pk_fma_f32 v[184:185], v[52:53], v[28:29], v[184:185] neg_lo:[1,0,0] neg_hi:[1,0,0]
    v_pk_fma_f32 v[186:187], v[52:53], v[30:31], v[186:187] neg_lo:[1,0,0] neg_hi:[1,0,0]
    v_pk_fma_f32 v[232:233], v[52:53], v[40:41], v[232:233] neg_lo:[1,0,0] neg_hi:[1,0,0]
    v_pk_fma_f32 v[234:235], v[52:53], v[42:43], v[234:235] neg_lo:[1,0,0] neg_hi:[1,0,0]
    v_pk_fma_f32 v[248:249], v[52:53], v[44:45], v[248:249] neg_lo:[1,0,0] neg_hi:[1,0,0]
    v_pk_fma_f32 v[250:251], v[52:53], v[46:47], v[250:251] neg_lo:[1,0,0] neg_hi:[1,0,0]
    v_max_f32 v168, 0, v168
    v_max_f32 v169, 0, v169
    v_max_f32 v170, 0, v170
    v_max_f32 v171, 0, v171
    v_max_f32 v184, 0, v184
    v_max_f32 v185, 0, v185
    v_max_f32 v186, 0, v186
    v_max_f32 v187, 0, v187
    v_pk_mul_f32 v[168:169], v[168:169], v[232:233]
    v_pk_mul_f32 v[170:171], v[170:171], v[234:235]
    v_pk_mul_f32 v[184:185], v[184:185], v[248:249]
    v_pk_mul_f32 v[186:187], v[186:187], v[250:251]
    v_cvt_pk_bf16_f32 v232, v168, v169
    v_cvt_pk_bf16_f32 v233, v170, v171
    v_cvt_pk_bf16_f32 v234, v184, v185
    v_cvt_pk_bf16_f32 v235, v186, v187
    buffer_store_dwordx4 v[232:235], v122, s[20:23], s27 offen offset:2048 sc1
    v_pk_fma_f32 v[172:173], v[54:55], v[24:25], v[172:173] neg_lo:[1,0,0] neg_hi:[1,0,0]
    v_pk_fma_f32 v[174:175], v[54:55], v[26:27], v[174:175] neg_lo:[1,0,0] neg_hi:[1,0,0]
    v_pk_fma_f32 v[188:189], v[54:55], v[28:29], v[188:189] neg_lo:[1,0,0] neg_hi:[1,0,0]
    v_pk_fma_f32 v[190:191], v[54:55], v[30:31], v[190:191] neg_lo:[1,0,0] neg_hi:[1,0,0]
    v_pk_fma_f32 v[236:237], v[54:55], v[40:41], v[236:237] neg_lo:[1,0,0] neg_hi:[1,0,0]
    v_pk_fma_f32 v[238:239], v[54:55], v[42:43], v[238:239] neg_lo:[1,0,0] neg_hi:[1,0,0]
    v_pk_fma_f32 v[252:253], v[54:55], v[44:45], v[252:253] neg_lo:[1,0,0] neg_hi:[1,0,0]
    v_pk_fma_f32 v[254:255], v[54:55], v[46:47], v[254:255] neg_lo:[1,0,0] neg_hi:[1,0,0]
    v_max_f32 v172, 0, v172
    v_max_f32 v173, 0, v173
    v_max_f32 v174, 0, v174
    v_max_f32 v175, 0, v175
    v_max_f32 v188, 0, v188
    v_max_f32 v189, 0, v189
    v_max_f32 v190, 0, v190
    v_max_f32 v191, 0, v191
    v_pk_mul_f32 v[172:173], v[172:173], v[236:237]
    v_pk_mul_f32 v[174:175], v[174:175], v[238:239]
    v_pk_mul_f32 v[188:189], v[188:189], v[252:253]
    v_pk_mul_f32 v[190:191], v[190:191], v[254:255]
    v_cvt_pk_bf16_f32 v236, v172, v173
    v_cvt_pk_bf16_f32 v237, v174, v175
    v_cvt_pk_bf16_f32 v238, v188, v189
    v_cvt_pk_bf16_f32 v239, v190, v191
    buffer_store_dwordx4 v[236:239], v122, s[20:23], s27 offen offset:3072 sc1
    v_readfirstlane_b32 s54, v7
    v_mov_b32 v1, 161280
    v_mov_b32 v3, 1
    s_mov_b64 exec, 1
    ds_add_u32 v1, v3 offset:108
    s_mov_b64 exec, -1
    s_mov_b32 s27, 5
    s_mov_b32 s9, 1
    s_branch L_CONVR
L_EPS:
    s_mov_b32 s83, 200000
SPL219:
    ds_read_b32 v12, v15 offset:40
    s_waitcnt lgkmcnt(0)
    s_nop 0
    v_readfirstlane_b32 s82, v12
    s_sub_u32 s83, s83, 1
    s_cselect_b32 s82, -1, s82
    s_cmp_ge_u32 s82, 2
    s_cbranch_scc1 SPD220
    s_branch SPL219
SPD220:
    ds_read_b32 v7, v15 offset:20
    ds_read_b32 v48, v120 offset:0
    ds_read_b32 v50, v120 offset:64
    ds_read_b32 v52, v120 offset:128
    ds_read_b32 v54, v120 offset:192
    ds_read_b128 v[16:19], v13 offset:0
    ds_read_b128 v[20:23], v13 offset:64
    ds_read_b128 v[24:27], v13 offset:128
    ds_read_b128 v[28:31], v13 offset:192
    ds_read_b128 v[32:35], v13 offset:512
    ds_read_b128 v[36:39], v13 offset:576
    ds_read_b128 v[40:43], v13 offset:640
    ds_read_b128 v[44:47], v13 offset:704
    s_waitcnt lgkmcnt(0)
    s_branch L_EPB
CS208:
    v_mfma_f32_16x16x32_bf16 v[152:155], v[20:23], v[56:59], 0
    v_mfma_f32_16x16x32_bf16 v[200:203], v[32:35], v[56:59], 0
    v_mfma_f32_16x16x32_bf16 v[216:219], v[36:39], v[56:59], 0
    v_mfma_f32_16x16x32_bf16 v[140:143], v[16:19], v[60:63], 0
    ds_read_b32 v12, v119
    v_mfma_f32_16x16x32_bf16 v[156:159], v[20:23], v[60:63], 0
    v_mfma_f32_16x16x32_bf16 v[204:207], v[32:35], v[60:63], 0
    v_mfma_f32_16x16x32_bf16 v[220:223], v[36:39], v[60:63], 0
    v_mfma_f32_16x16x32_bf16 v[160:163], v[24:27], v[48:51], 0
    v_mfma_f32_16x16x32_bf16 v[176:179], v[28:31], v[48:51], 0
    v_mfma_f32_16x16x32_bf16 v[224:227], v[40:43], v[48:51], 0
    s_waitcnt lgkmcnt(0)
    v_cmp_le_u32 vcc, v12, v14
    v_mfma_f32_16x16x32_bf16 v[240:243], v[44:47], v[48:51], 0
    s_cbranch_vccz CS208k
    v_mfma_f32_16x16x32_bf16 v[164:167], v[24:27], v[52:55], 0
    v_mfma_f32_16x16x32_bf16 v[180:183], v[28:31], v[52:55], 0
    v_mfma_f32_16x16x32_bf16 v[228:231], v[40:43], v[52:55], 0
    v_mfma_f32_16x16x32_bf16 v[244:247], v[44:47], v[52:55], 0
    v_mfma_f32_16x16x32_bf16 v[168:171], v[24:27], v[56:59], 0
    v_mfma_f32_16x16x32_bf16 v[184:187], v[28:31], v[56:59], 0
    v_mfma_f32_16x16x32_bf16 v[232:235], v[40:43], v[56:59], 0
    ds_read_b32 v12, v119
    v_mfma_f32_16x16x32_bf16 v[248:251], v[44:47], v[56:59], 0
    v_mfma_f32_16x16x32_bf16 v[172:175], v[24:27], v[60:63], 0
    v_mfma_f32_16x16x32_bf16 v[188:191], v[28:31], v[60:63], 0
    v_mfma_f32_16x16x32_bf16 v[236:239], v[40:43], v[60:63], 0
    v_mfma_f32_16x16x32_bf16 v[252:255], v[44:47], v[60:63], 0
    s_mov_b32 s83, 200000
    s_waitcnt lgkmcnt(0)
    s_branch CS208t
CS208s:
    ds_read_b32 v12, v119
    s_waitcnt lgkmcnt(0)
CS208t:
    v_cmp_le_u32 vcc, v12, v14
    s_sub_u32 s83, s83, 1
    s_cbranch_scc1 CS208u
    s_cbranch_vccnz CS208s
CS208u:
    ds_read_b64_tr_b16 v[64:65], v112 offset:16384
    ds_read_b64_tr_b16 v[66:67], v112 offset:17408
    ds_read_b128 v[96:99], v117 offset:0
    ds_read_b64_tr_b16 v[68:69], v113 offset:16384
    ds_read_b64_tr_b16 v[70:71], v113 offset:17408
    ds_read_b64_tr_b16 v[80:81], v112 offset:24576
    ds_read_b64_tr_b16 v[82:83], v112 offset:25600
    ds_read_b64_tr_b16 v[84:85], v113 offset:24576
    ds_read_b64_tr_b16 v[86:87], v113 offset:25600
    ds_read_b128 v[100:103], v117 offset:2048
    ds_read_b128 v[104:107], v117 offset:4096
    ds_read_b128 v[108:111], v117 offset:6144
    ds_read_b64_tr_b16 v[72:73], v114 offset:16384
    ds_read_b64_tr_b16 v[74:75], v114 offset:17408
    ds_read_b64_tr_b16 v[76:77], v115 offset:16384
    s_waitcnt lgkmcnt(14)
    ds_read_b64_tr_b16 v[78:79], v115 offset:17408
    s_waitcnt lgkmcnt(14)
    ds_read_b64_tr_b16 v[88:89], v114 offset:24576
    s_waitcnt lgkmcnt(14)
    ds_read_b64_tr_b16 v[90:91], v114 offset:25600
    s_waitcnt lgkmcnt(14)
    ds_read_b64_tr_b16 v[92:93], v115 offset:24576
    s_waitcnt lgkmcnt(14)
    ds_read_b64_tr_b16 v[94:95], v115 offset:25600
    s_branch CS208r
CS208k:
    ds_read_b64_tr_b16 v[64:65], v112 offset:16384
    ds_read_b64_tr_b16 v[66:67], v112 offset:17408
    v_mfma_f32_16x16x32_bf16 v[164:167], v[24:27], v[52:55], 0
    ds_read_b128 v[96:99], v117 offset:0
    ds_read_b64_tr_b16 v[68:69], v113 offset:16384
    v_mfma_f32_16x16x32_bf16 v[180:183], v[28:31], v[52:55], 0
    ds_read_b64_tr_b16 v[70:71], v113 offset:17408
    ds_read_b64_tr_b16 v[80:81], v112 offset:24576
    v_mfma_f32_16x16x32_bf16 v[228:231], v[40:43], v[52:55], 0
    ds_read_b64_tr_b16 v[82:83], v112 offset:25600
    ds_read_b64_tr_b16 v[84:85], v113 offset:24576
    v_mfma_f32_16x16x32_bf16 v[244:247], v[44:47], v[52:55], 0
    ds_read_b64_tr_b16 v[86:87], v113 offset:25600
    ds_read_b128 v[100:103], v117 offset:2048
    v_mfma_f32_16x16x32_bf16 v[168:171], v[24:27], v[56:59], 0
    ds_read_b128 v[104:107], v117 offset:4096
    ds_read_b128 v[108:111], v117 offset:6144
    v_mfma_f32_16x16x32_bf16 v[184:187], v[28:31], v[56:59], 0
    ds_read_b64_tr_b16 v[72:73], v114 offset:16384
    ds_read_b64_tr_b16 v[74:75], v114 offset:17408
    v_mfma_f32_16x16x32_bf16 v[232:235], v[40:43], v[56:59], 0
    ds_read_b64_tr_b16 v[76:77], v115 offset:16384
    v_mfma_f32_16x16x32_bf16 v[248:251], v[44:47], v[56:59], 0
    s_waitcnt lgkmcnt(14)
    ds_read_b64_tr_b16 v[78:79], v115 offset:17408
    v_mfma_f32_16x16x32_bf16 v[172:175], v[24:27], v[60:63], 0
    s_waitcnt lgkmcnt(14)
    ds_read_b64_tr_b16 v[88:89], v114 offset:24576
    v_mfma_f32_16x16x32_bf16 v[188:191], v[28:31], v[60:63], 0
    s_waitcnt lgkmcnt(14)
    ds_read_b64_tr_b16 v[90:91], v114 offset:25600
    v_mfma_f32_16x16x32_bf16 v[236:239], v[40:43], v[60:63], 0
    s_waitcnt lgkmcnt(14)
    ds_read_b64_tr_b16 v[92:93], v115 offset:24576
    v_mfma_f32_16x16x32_bf16 v[252:255], v[44:47], v[60:63], 0
    s_waitcnt lgkmcnt(14)
    ds_read_b64_tr_b16 v[94:95], v115 offset:25600
    s_branch CS208r
CS211:
    v_mfma_f32_16x16x32_bf16 v[152:155], v[68:71], v[104:107], v[152:155]
    v_mfma_f32_16x16x32_bf16 v[200:203], v[80:83], v[104:107], v[200:203]
    v_mfma_f32_16x16x32_bf16 v[216:219], v[84:87], v[104:107], v[216:219]
    v_mfma_f32_16x16x32_bf16 v[140:143], v[64:67], v[108:111], v[140:143]
    ds_read_b32 v12, v119
    v_mfma_f32_16x16x32_bf16 v[156:159], v[68:71], v[108:111], v[156:159]
    v_mfma_f32_16x16x32_bf16 v[204:207], v[80:83], v[108:111], v[204:207]
    v_mfma_f32_16x16x32_bf16 v[220:223], v[84:87], v[108:111], v[220:223]
    v_mfma_f32_16x16x32_bf16 v[160:163], v[72:75], v[96:99], v[160:163]
    v_mfma_f32_16x16x32_bf16 v[176:179], v[76:79], v[96:99], v[176:179]
    v_mfma_f32_16x16x32_bf16 v[224:227], v[88:91], v[96:99], v[224:227]
    s_waitcnt lgkmcnt(0)
    v_cmp_le_u32 vcc, v12, v14
    v_mfma_f32_16x16x32_bf16 v[240:243], v[92:95], v[96:99], v[240:243]
    s_cbranch_vccz CS211k
    v_mfma_f32_16x16x32_bf16 v[164:167], v[72:75], v[100:103], v[164:167]
    v_mfma_f32_16x16x32_bf16 v[180:183], v[76:79], v[100:103], v[180:183]
    v_mfma_f32_16x16x32_bf16 v[228:231], v[88:91], v[100:103], v[228:231]
    v_mfma_f32_16x16x32_bf16 v[244:247], v[92:95], v[100:103], v[244:247]
    v_mfma_f32_16x16x32_bf16 v[168:171], v[72:75], v[104:107], v[168:171]
    v_mfma_f32_16x16x32_bf16 v[184:187], v[76:79], v[104:107], v[184:187]
    v_mfma_f32_16x16x32_bf16 v[232:235], v[88:91], v[104:107], v[232:235]
    ds_read_b32 v12, v119
    v_mfma_f32_16x16x32_bf16 v[248:251], v[92:95], v[104:107], v[248:251]
    v_mfma_f32_16x16x32_bf16 v[172:175], v[72:75], v[108:111], v[172:175]
    v_mfma_f32_16x16x32_bf16 v[188:191], v[76:79], v[108:111], v[188:191]
    v_mfma_f32_16x16x32_bf16 v[236:239], v[88:91], v[108:111], v[236:239]
    v_mfma_f32_16x16x32_bf16 v[252:255], v[92:95], v[108:111], v[252:255]
    s_mov_b32 s83, 200000
    s_waitcnt lgkmcnt(0)
    s_branch CS211t
CS211s:
    ds_read_b32 v12, v119
    s_waitcnt lgkmcnt(0)
CS211t:
    v_cmp_le_u32 vcc, v12, v14
    s_sub_u32 s83, s83, 1
    s_cbranch_scc1 CS211u
    s_cbranch_vccnz CS211s
CS211u:
    ds_read_b64_tr_b16 v[16:17], v112 offset:32768
    ds_read_b64_tr_b16 v[18:19], v112 offset:33792
    ds_read_b128 v[48:51], v116 offset:0
    ds_read_b64_tr_b16 v[20:21], v113 offset:32768
    ds_read_b64_tr_b16 v[22:23], v113 offset:33792
    ds_read_b64_tr_b16 v[32:33], v112 offset:40960
    ds_read_b64_tr_b16 v[34:35], v112 offset:41984
    ds_read_b64_tr_b16 v[36:37], v113 offset:40960
    ds_read_b64_tr_b16 v[38:39], v113 offset:41984
    ds_read_b128 v[52:55], v116 offset:2048
    ds_read_b128 v[56:59], v116 offset:4096
    ds_read_b128 v[60:63], v116 offset:6144
    ds_read_b64_tr_b16 v[24:25], v114 offset:32768
    ds_read_b64_tr_b16 v[26:27], v114 offset:33792
    ds_read_b64_tr_b16 v[28:29], v115 offset:32768
    s_waitcnt lgkmcnt(14)
    ds_read_b64_tr_b16 v[30:31], v115 offset:33792
    s_waitcnt lgkmcnt(14)
    ds_read_b64_tr_b16 v[40:41], v114 offset:40960
    s_waitcnt lgkmcnt(14)
    ds_read_b64_tr_b16 v[42:43], v114 offset:41984
    s_waitcnt lgkmcnt(14)
    ds_read_b64_tr_b16 v[44:45], v115 offset:40960
    s_waitcnt lgkmcnt(14)
    ds_read_b64_tr_b16 v[46:47], v115 offset:41984
    s_branch CS211r
CS211k:
    ds_read_b64_tr_b16 v[16:17], v112 offset:32768
    ds_read_b64_tr_b16 v[18:19], v112 offset:33792
    v_mfma_f32_16x16x32_bf16 v[164:167], v[72:75], v[100:103], v[164:167]
    ds_read_b128 v[48:51], v116 offset:0
    ds_read_b64_tr_b16 v[20:21], v113 offset:32768
    v_mfma_f32_16x16x32_bf16 v[180:183], v[76:79], v[100:103], v[180:183]
    ds_read_b64_tr_b16 v[22:23], v113 offset:33792
    ds_read_b64_tr_b16 v[32:33], v112 offset:40960
    v_mfma_f32_16x16x32_bf16 v[228:231], v[88:91], v[100:103], v[228:231]
    ds_read_b64_tr_b16 v[34:35], v112 offset:41984
    ds_read_b64_tr_b16 v[36:37], v113 offset:40960
    v_mfma_f32_16x16x32_bf16 v[244:247], v[92:95], v[100:103], v[244:247]
    ds_read_b64_tr_b16 v[38:39], v113 offset:41984
    ds_read_b128 v[52:55], v116 offset:2048
    v_mfma_f32_16x16x32_bf16 v[168:171], v[72:75], v[104:107], v[168:171]
    ds_read_b128 v[56:59], v116 offset:4096
    ds_read_b128 v[60:63], v116 offset:6144
    v_mfma_f32_16x16x32_bf16 v[184:187], v[76:79], v[104:107], v[184:187]
    ds_read_b64_tr_b16 v[24:25], v114 offset:32768
    ds_read_b64_tr_b16 v[26:27], v114 offset:33792
    v_mfma_f32_16x16x32_bf16 v[232:235], v[88:91], v[104:107], v[232:235]
    ds_read_b64_tr_b16 v[28:29], v115 offset:32768
    v_mfma_f32_16x16x32_bf16 v[248:251], v[92:95], v[104:107], v[248:251]
    s_waitcnt lgkmcnt(14)
    ds_read_b64_tr_b16 v[30:31], v115 offset:33792
    v_mfma_f32_16x16x32_bf16 v[172:175], v[72:75], v[108:111], v[172:175]
    s_waitcnt lgkmcnt(14)
    ds_read_b64_tr_b16 v[40:41], v114 offset:40960
    v_mfma_f32_16x16x32_bf16 v[188:191], v[76:79], v[108:111], v[188:191]
    s_waitcnt lgkmcnt(14)
    ds_read_b64_tr_b16 v[42:43], v114 offset:41984
    v_mfma_f32_16x16x32_bf16 v[236:239], v[88:91], v[108:111], v[236:239]
    s_waitcnt lgkmcnt(14)
    ds_read_b64_tr_b16 v[44:45], v115 offset:40960
    v_mfma_f32_16x16x32_bf16 v[252:255], v[92:95], v[108:111], v[252:255]
    s_waitcnt lgkmcnt(14)
    ds_read_b64_tr_b16 v[46:47], v115 offset:41984
    s_branch CS211r
CS214:
    v_mfma_f32_16x16x32_bf16 v[140:143], v[16:19], v[60:63], v[140:143]
    v_mfma_f32_16x16x32_bf16 v[156:159], v[20:23], v[60:63], v[156:159]
    v_mfma_f32_16x16x32_bf16 v[204:207], v[32:35], v[60:63], v[204:207]
    v_mfma_f32_16x16x32_bf16 v[220:223], v[36:39], v[60:63], v[220:223]
    ds_read_b32 v12, v119
    v_mfma_f32_16x16x32_bf16 v[160:163], v[24:27], v[48:51], v[160:163]
    v_mfma_f32_16x16x32_bf16 v[176:179], v[28:31], v[48:51], v[176:179]
    v_mfma_f32_16x16x32_bf16 v[224:227], v[40:43], v[48:51], v[224:227]
    v_mfma_f32_16x16x32_bf16 v[240:243], v[44:47], v[48:51], v[240:243]
    v_mfma_f32_16x16x32_bf16 v[164:167], v[24:27], v[52:55], v[164:167]
    v_mfma_f32_16x16x32_bf16 v[180:183], v[28:31], v[52:55], v[180:183]
    s_waitcnt lgkmcnt(0)
    v_cmp_le_u32 vcc, v12, v14
    v_mfma_f32_16x16x32_bf16 v[228:231], v[40:43], v[52:55], v[228:231]
    s_cbranch_vccz CS214k
    v_mfma_f32_16x16x32_bf16 v[244:247], v[44:47], v[52:55], v[244:247]
    v_mfma_f32_16x16x32_bf16 v[168:171], v[24:27], v[56:59], v[168:171]
    v_mfma_f32_16x16x32_bf16 v[184:187], v[28:31], v[56:59], v[184:187]
    v_mfma_f32_16x16x32_bf16 v[232:235], v[40:43], v[56:59], v[232:235]
    ds_read_b32 v12, v119
    v_mfma_f32_16x16x32_bf16 v[248:251], v[44:47], v[56:59], v[248:251]
    v_mfma_f32_16x16x32_bf16 v[172:175], v[24:27], v[60:63], v[172:175]
    v_mfma_f32_16x16x32_bf16 v[188:191], v[28:31], v[60:63], v[188:191]
    v_mfma_f32_16x16x32_bf16 v[236:239], v[40:43], v[60:63], v[236:239]
    v_mfma_f32_16x16x32_bf16 v[252:255], v[44:47], v[60:63], v[252:255]
    s_mov_b32 s83, 200000
    s_waitcnt lgkmcnt(0)
    s_branch CS214t
CS214s:
    ds_read_b32 v12, v119
    s_waitcnt lgkmcnt(0)
CS214t:
    v_cmp_le_u32 vcc, v12, v14
    s_sub_u32 s83, s83, 1
    s_cbranch_scc1 CS214u
    s_cbranch_vccnz CS214s
CS214u:
    ds_read_b64_tr_b16 v[64:65], v112 offset:49152
    ds_read_b64_tr_b16 v[66:67], v112 offset:50176
    ds_read_b128 v[96:99], v117 offset:0
    ds_read_b64_tr_b16 v[68:69], v113 offset:49152
    ds_read_b64_tr_b16 v[70:71], v113 offset:50176
    ds_read_b64_tr_b16 v[80:81], v112 offset:57344
    ds_read_b64_tr_b16 v[82:83], v112 offset:58368
    ds_read_b64_tr_b16 v[84:85], v113 offset:57344
    ds_read_b64_tr_b16 v[86:87], v113 offset:58368
    ds_read_b128 v[100:103], v117 offset:2048
    ds_read_b128 v[104:107], v117 offset:4096
    ds_read_b128 v[108:111], v117 offset:6144
    ds_read_b64_tr_b16 v[72:73], v114 offset:49152
    ds_read_b64_tr_b16 v[74:75], v114 offset:50176
    ds_read_b64_tr_b16 v[76:77], v115 offset:49152
    s_waitcnt lgkmcnt(14)
    ds_read_b64_tr_b16 v[78:79], v115 offset:50176
    s_waitcnt lgkmcnt(14)
    ds_read_b64_tr_b16 v[88:89], v114 offset:57344
    s_waitcnt lgkmcnt(14)
    ds_read_b64_tr_b16 v[90:91], v114 offset:58368
    s_waitcnt lgkmcnt(14)
    ds_read_b64_tr_b16 v[92:93], v115 offset:57344
    s_waitcnt lgkmcnt(14)
    ds_read_b64_tr_b16 v[94:95], v115 offset:58368
    s_branch CS214r
CS214k:
    ds_read_b64_tr_b16 v[64:65], v112 offset:49152
    ds_read_b64_tr_b16 v[66:67], v112 offset:50176
    v_mfma_f32_16x16x32_bf16 v[244:247], v[44:47], v[52:55], v[244:247]
    ds_read_b128 v[96:99], v117 offset:0
    ds_read_b64_tr_b16 v[68:69], v113 offset:49152
    v_mfma_f32_16x16x32_bf16 v[168:171], v[24:27], v[56:59], v[168:171]
    ds_read_b64_tr_b16 v[70:71], v113 offset:50176
    ds_read_b64_tr_b16 v[80:81], v112 offset:57344
    v_mfma_f32_16x16x32_bf16 v[184:187], v[28:31], v[56:59], v[184:187]
    ds_read_b64_tr_b16 v[82:83], v112 offset:58368
    ds_read_b64_tr_b16 v[84:85], v113 offset:57344
    v_mfma_f32_16x16x32_bf16 v[232:235], v[40:43], v[56:59], v[232:235]
    ds_read_b64_tr_b16 v[86:87], v113 offset:58368
    ds_read_b128 v[100:103], v117 offset:2048
    v_mfma_f32_16x16x32_bf16 v[248:251], v[44:47], v[56:59], v[248:251]
    ds_read_b128 v[104:107], v117 offset:4096
    ds_read_b128 v[108:111], v117 offset:6144
    v_mfma_f32_16x16x32_bf16 v[172:175], v[24:27], v[60:63], v[172:175]
    ds_read_b64_tr_b16 v[72:73], v114 offset:49152
    ds_read_b64_tr_b16 v[74:75], v114 offset:50176
    v_mfma_f32_16x16x32_bf16 v[188:191], v[28:31], v[60:63], v[188:191]
    ds_read_b64_tr_b16 v[76:77], v115 offset:49152
    s_waitcnt lgkmcnt(14)
    ds_read_b64_tr_b16 v[78:79], v115 offset:50176
    v_mfma_f32_16x16x32_bf16 v[236:239], v[40:43], v[60:63], v[236:239]
    s_waitcnt lgkmcnt(14)
    ds_read_b64_tr_b16 v[88:89], v114 offset:57344
    s_waitcnt lgkmcnt(14)
    ds_read_b64_tr_b16 v[90:91], v114 offset:58368
    v_mfma_f32_16x16x32_bf16 v[252:255], v[44:47], v[60:63], v[252:255]
    s_waitcnt lgkmcnt(14)
    ds_read_b64_tr_b16 v[92:93], v115 offset:57344
    s_waitcnt lgkmcnt(14)
    ds_read_b64_tr_b16 v[94:95], v115 offset:58368
    s_branch CS214r
CS215:
    v_mfma_f32_16x16x32_bf16 v[152:155], v[68:71], v[104:107], v[152:155]
    v_mfma_f32_16x16x32_bf16 v[200:203], v[80:83], v[104:107], v[200:203]
    v_mfma_f32_16x16x32_bf16 v[216:219], v[84:87], v[104:107], v[216:219]
    v_mfma_f32_16x16x32_bf16 v[140:143], v[64:67], v[108:111], v[140:143]
    ds_read_b32 v12, v119
    v_mfma_f32_16x16x32_bf16 v[156:159], v[68:71], v[108:111], v[156:159]
    v_mfma_f32_16x16x32_bf16 v[204:207], v[80:83], v[108:111], v[204:207]
    v_mfma_f32_16x16x32_bf16 v[220:223], v[84:87], v[108:111], v[220:223]
    v_mfma_f32_16x16x32_bf16 v[160:163], v[72:75], v[96:99], v[160:163]
    v_mfma_f32_16x16x32_bf16 v[176:179], v[76:79], v[96:99], v[176:179]
    v_mfma_f32_16x16x32_bf16 v[224:227], v[88:91], v[96:99], v[224:227]
    s_waitcnt lgkmcnt(0)
    v_cmp_le_u32 vcc, v12, v14
    v_mfma_f32_16x16x32_bf16 v[240:243], v[92:95], v[96:99], v[240:243]
    s_cbranch_vccz CS215k
    v_mfma_f32_16x16x32_bf16 v[164:167], v[72:75], v[100:103], v[164:167]
    v_mfma_f32_16x16x32_bf16 v[180:183], v[76:79], v[100:103], v[180:183]
    v_mfma_f32_16x16x32_bf16 v[228:231], v[88:91], v[100:103], v[228:231]
    v_mfma_f32_16x16x32_bf16 v[244:247], v[92:95], v[100:103], v[244:247]
    v_mfma_f32_16x16x32_bf16 v[168:171], v[72:75], v[104:107], v[168:171]
    v_mfma_f32_16x16x32_bf16 v[184:187], v[76:79], v[104:107], v[184:187]
    v_mfma_f32_16x16x32_bf16 v[232:235], v[88:91], v[104:107], v[232:235]
    ds_read_b32 v12, v119
    v_mfma_f32_16x16x32_bf16 v[248:251], v[92:95], v[104:107], v[248:251]
    v_mfma_f32_16x16x32_bf16 v[172:175], v[72:75], v[108:111], v[172:175]
    v_mfma_f32_16x16x32_bf16 v[188:191], v[76:79], v[108:111], v[188:191]
    v_mfma_f32_16x16x32_bf16 v[236:239], v[88:91], v[108:111], v[236:239]
    v_mfma_f32_16x16x32_bf16 v[252:255], v[92:95], v[108:111], v[252:255]
    s_mov_b32 s83, 200000
    s_waitcnt lgkmcnt(0)
    s_branch CS215t
CS215s:
    ds_read_b32 v12, v119
    s_waitcnt lgkmcnt(0)
CS215t:
    v_cmp_le_u32 vcc, v12, v14
    s_sub_u32 s83, s83, 1
    s_cbranch_scc1 CS215u
    s_cbranch_vccnz CS215s
CS215u:
    ds_read_b64_tr_b16 v[16:17], v112 offset:0
    ds_read_b64_tr_b16 v[18:19], v112 offset:1024
    ds_read_b128 v[48:51], v116 offset:0
    ds_read_b64_tr_b16 v[20:21], v113 offset:0
    ds_read_b64_tr_b16 v[22:23], v113 offset:1024
    ds_read_b64_tr_b16 v[32:33], v112 offset:8192
    ds_read_b64_tr_b16 v[34:35], v112 offset:9216
    ds_read_b64_tr_b16 v[36:37], v113 offset:8192
    ds_read_b64_tr_b16 v[38:39], v113 offset:9216
    ds_read_b128 v[52:55], v116 offset:2048
    ds_read_b128 v[56:59], v116 offset:4096
    ds_read_b128 v[60:63], v116 offset:6144
    ds_read_b64_tr_b16 v[24:25], v114 offset:0
    ds_read_b64_tr_b16 v[26:27], v114 offset:1024
    ds_read_b64_tr_b16 v[28:29], v115 offset:0
    s_waitcnt lgkmcnt(14)
    ds_read_b64_tr_b16 v[30:31], v115 offset:1024
    s_waitcnt lgkmcnt(14)
    ds_read_b64_tr_b16 v[40:41], v114 offset:8192
    s_waitcnt lgkmcnt(14)
    ds_read_b64_tr_b16 v[42:43], v114 offset:9216
    s_waitcnt lgkmcnt(14)
    ds_read_b64_tr_b16 v[44:45], v115 offset:8192
    s_waitcnt lgkmcnt(14)
    ds_read_b64_tr_b16 v[46:47], v115 offset:9216
    s_branch CS215r
CS215k:
    ds_read_b64_tr_b16 v[16:17], v112 offset:0
    ds_read_b64_tr_b16 v[18:19], v112 offset:1024
    v_mfma_f32_16x16x32_bf16 v[164:167], v[72:75], v[100:103], v[164:167]
    ds_read_b128 v[48:51], v116 offset:0
    ds_read_b64_tr_b16 v[20:21], v113 offset:0
    v_mfma_f32_16x16x32_bf16 v[180:183], v[76:79], v[100:103], v[180:183]
    ds_read_b64_tr_b16 v[22:23], v113 offset:1024
    ds_read_b64_tr_b16 v[32:33], v112 offset:8192
    v_mfma_f32_16x16x32_bf16 v[228:231], v[88:91], v[100:103], v[228:231]
    ds_read_b64_tr_b16 v[34:35], v112 offset:9216
    ds_read_b64_tr_b16 v[36:37], v113 offset:8192
    v_mfma_f32_16x16x32_bf16 v[244:247], v[92:95], v[100:103], v[244:247]
    ds_read_b64_tr_b16 v[38:39], v113 offset:9216
    ds_read_b128 v[52:55], v116 offset:2048
    v_mfma_f32_16x16x32_bf16 v[168:171], v[72:75], v[104:107], v[168:171]
    ds_read_b128 v[56:59], v116 offset:4096
    ds_read_b128 v[60:63], v116 offset:6144
    v_mfma_f32_16x16x32_bf16 v[184:187], v[76:79], v[104:107], v[184:187]
    ds_read_b64_tr_b16 v[24:25], v114 offset:0
    ds_read_b64_tr_b16 v[26:27], v114 offset:1024
    v_mfma_f32_16x16x32_bf16 v[232:235], v[88:91], v[104:107], v[232:235]
    ds_read_b64_tr_b16 v[28:29], v115 offset:0
    v_mfma_f32_16x16x32_bf16 v[248:251], v[92:95], v[104:107], v[248:251]
    s_waitcnt lgkmcnt(14)
    ds_read_b64_tr_b16 v[30:31], v115 offset:1024
    v_mfma_f32_16x16x32_bf16 v[172:175], v[72:75], v[108:111], v[172:175]
    s_waitcnt lgkmcnt(14)
    ds_read_b64_tr_b16 v[40:41], v114 offset:8192
    v_mfma_f32_16x16x32_bf16 v[188:191], v[76:79], v[108:111], v[188:191]
    s_waitcnt lgkmcnt(14)
    ds_read_b64_tr_b16 v[42:43], v114 offset:9216
    v_mfma_f32_16x16x32_bf16 v[236:239], v[88:91], v[108:111], v[236:239]
    s_waitcnt lgkmcnt(14)
    ds_read_b64_tr_b16 v[44:45], v115 offset:8192
    v_mfma_f32_16x16x32_bf16 v[252:255], v[92:95], v[108:111], v[252:255]
    s_waitcnt lgkmcnt(14)
    ds_read_b64_tr_b16 v[46:47], v115 offset:9216
    s_branch CS215r
CS216:
    v_mfma_f32_16x16x32_bf16 v[152:155], v[20:23], v[56:59], v[152:155]
    v_mfma_f32_16x16x32_bf16 v[200:203], v[32:35], v[56:59], v[200:203]
    v_mfma_f32_16x16x32_bf16 v[216:219], v[36:39], v[56:59], v[216:219]
    v_mfma_f32_16x16x32_bf16 v[140:143], v[16:19], v[60:63], v[140:143]
    ds_read_b32 v12, v119
    v_mfma_f32_16x16x32_bf16 v[156:159], v[20:23], v[60:63], v[156:159]
    v_mfma_f32_16x16x32_bf16 v[204:207], v[32:35], v[60:63], v[204:207]
    v_mfma_f32_16x16x32_bf16 v[220:223], v[36:39], v[60:63], v[220:223]
    v_mfma_f32_16x16x32_bf16 v[160:163], v[24:27], v[48:51], v[160:163]
    v_mfma_f32_16x16x32_bf16 v[176:179], v[28:31], v[48:51], v[176:179]
    v_mfma_f32_16x16x32_bf16 v[224:227], v[40:43], v[48:51], v[224:227]
    s_waitcnt lgkmcnt(0)
    v_cmp_le_u32 vcc, v12, v14
    v_mfma_f32_16x16x32_bf16 v[240:243], v[44:47], v[48:51], v[240:243]
    s_cbranch_vccz CS216k
    v_mfma_f32_16x16x32_bf16 v[164:167], v[24:27], v[52:55], v[164:167]
    v_mfma_f32_16x16x32_bf16 v[180:183], v[28:31], v[52:55], v[180:183]
    v_mfma_f32_16x16x32_bf16 v[228:231], v[40:43], v[52:55], v[228:231]
    v_mfma_f32_16x16x32_bf16 v[244:247], v[44:47], v[52:55], v[244:247]
    v_mfma_f32_16x16x32_bf16 v[168:171], v[24:27], v[56:59], v[168:171]
    v_mfma_f32_16x16x32_bf16 v[184:187], v[28:31], v[56:59], v[184:187]
    v_mfma_f32_16x16x32_bf16 v[232:235], v[40:43], v[56:59], v[232:235]
    ds_read_b32 v12, v119
    v_mfma_f32_16x16x32_bf16 v[248:251], v[44:47], v[56:59], v[248:251]
    v_mfma_f32_16x16x32_bf16 v[172:175], v[24:27], v[60:63], v[172:175]
    v_mfma_f32_16x16x32_bf16 v[188:191], v[28:31], v[60:63], v[188:191]
    v_mfma_f32_16x16x32_bf16 v[236:239], v[40:43], v[60:63], v[236:239]
    v_mfma_f32_16x16x32_bf16 v[252:255], v[44:47], v[60:63], v[252:255]
    s_mov_b32 s83, 200000
    s_waitcnt lgkmcnt(0)
    s_branch CS216t
CS216s:
    ds_read_b32 v12, v119
    s_waitcnt lgkmcnt(0)
CS216t:
    v_cmp_le_u32 vcc, v12, v14
    s_sub_u32 s83, s83, 1
    s_cbranch_scc1 CS216u
    s_cbranch_vccnz CS216s
CS216u:
    ds_read_b64_tr_b16 v[64:65], v112 offset:16384
    ds_read_b64_tr_b16 v[66:67], v112 offset:17408
    ds_read_b128 v[96:99], v117 offset:0
    ds_read_b64_tr_b16 v[68:69], v113 offset:16384
    ds_read_b64_tr_b16 v[70:71], v113 offset:17408
    ds_read_b64_tr_b16 v[80:81], v112 offset:24576
    ds_read_b64_tr_b16 v[82:83], v112 offset:25600
    ds_read_b64_tr_b16 v[84:85], v113 offset:24576
    ds_read_b64_tr_b16 v[86:87], v113 offset:25600
    ds_read_b128 v[100:103], v117 offset:2048
    ds_read_b128 v[104:107], v117 offset:4096
    ds_read_b128 v[108:111], v117 offset:6144
    ds_read_b64_tr_b16 v[72:73], v114 offset:16384
    ds_read_b64_tr_b16 v[74:75], v114 offset:17408
    ds_read_b64_tr_b16 v[76:77], v115 offset:16384
    s_waitcnt lgkmcnt(14)
    ds_read_b64_tr_b16 v[78:79], v115 offset:17408
    s_waitcnt lgkmcnt(14)
    ds_read_b64_tr_b16 v[88:89], v114 offset:24576
    s_waitcnt lgkmcnt(14)
    ds_read_b64_tr_b16 v[90:91], v114 offset:25600
    s_waitcnt lgkmcnt(14)
    ds_read_b64_tr_b16 v[92:93], v115 offset:24576
    s_waitcnt lgkmcnt(14)
    ds_read_b64_tr_b16 v[94:95], v115 offset:25600
    s_branch CS216r
CS216k:
    ds_read_b64_tr_b16 v[64:65], v112 offset:16384
    ds_read_b64_tr_b16 v[66:67], v112 offset:17408
    v_mfma_f32_16x16x32_bf16 v[164:167], v[24:27], v[52:55], v[164:167]
    ds_read_b128 v[96:99], v117 offset:0
    ds_read_b64_tr_b16 v[68:69], v113 offset:16384
    v_mfma_f32_16x16x32_bf16 v[180:183], v[28:31], v[52:55], v[180:183]
    ds_read_b64_tr_b16 v[70:71], v113 offset:17408
    ds_read_b64_tr_b16 v[80:81], v112 offset:24576
    v_mfma_f32_16x16x32_bf16 v[228:231], v[40:43], v[52:55], v[228:231]
    ds_read_b64_tr_b16 v[82:83], v112 offset:25600
    ds_read_b64_tr_b16 v[84:85], v113 offset:24576
    v_mfma_f32_16x16x32_bf16 v[244:247], v[44:47], v[52:55], v[244:247]
    ds_read_b64_tr_b16 v[86:87], v113 offset:25600
    ds_read_b128 v[100:103], v117 offset:2048
    v_mfma_f32_16x16x32_bf16 v[168:171], v[24:27], v[56:59], v[168:171]
    ds_read_b128 v[104:107], v117 offset:4096
    ds_read_b128 v[108:111], v117 offset:6144
    v_mfma_f32_16x16x32_bf16 v[184:187], v[28:31], v[56:59], v[184:187]
    ds_read_b64_tr_b16 v[72:73], v114 offset:16384
    ds_read_b64_tr_b16 v[74:75], v114 offset:17408
    v_mfma_f32_16x16x32_bf16 v[232:235], v[40:43], v[56:59], v[232:235]
    ds_read_b64_tr_b16 v[76:77], v115 offset:16384
    v_mfma_f32_16x16x32_bf16 v[248:251], v[44:47], v[56:59], v[248:251]
    s_waitcnt lgkmcnt(14)
    ds_read_b64_tr_b16 v[78:79], v115 offset:17408
    v_mfma_f32_16x16x32_bf16 v[172:175], v[24:27], v[60:63], v[172:175]
    s_waitcnt lgkmcnt(14)
    ds_read_b64_tr_b16 v[88:89], v114 offset:24576
    v_mfma_f32_16x16x32_bf16 v[188:191], v[28:31], v[60:63], v[188:191]
    s_waitcnt lgkmcnt(14)
    ds_read_b64_tr_b16 v[90:91], v114 offset:25600
    v_mfma_f32_16x16x32_bf16 v[236:239], v[40:43], v[60:63], v[236:239]
    s_waitcnt lgkmcnt(14)
    ds_read_b64_tr_b16 v[92:93], v115 offset:24576
    v_mfma_f32_16x16x32_bf16 v[252:255], v[44:47], v[60:63], v[252:255]
    s_waitcnt lgkmcnt(14)
    ds_read_b64_tr_b16 v[94:95], v115 offset:25600
    s_branch CS216r
CS217:
    v_mfma_f32_16x16x32_bf16 v[152:155], v[68:71], v[104:107], v[152:155]
    v_mfma_f32_16x16x32_bf16 v[200:203], v[80:83], v[104:107], v[200:203]
    v_mfma_f32_16x16x32_bf16 v[216:219], v[84:87], v[104:107], v[216:219]
    v_mfma_f32_16x16x32_bf16 v[140:143], v[64:67], v[108:111], v[140:143]
    ds_read_b32 v12, v119
    v_mfma_f32_16x16x32_bf16 v[156:159], v[68:71], v[108:111], v[156:159]
    v_mfma_f32_16x16x32_bf16 v[204:207], v[80:83], v[108:111], v[204:207]
    v_mfma_f32_16x16x32_bf16 v[220:223], v[84:87], v[108:111], v[220:223]
    v_mfma_f32_16x16x32_bf16 v[160:163], v[72:75], v[96:99], v[160:163]
    v_mfma_f32_16x16x32_bf16 v[176:179], v[76:79], v[96:99], v[176:179]
    v_mfma_f32_16x16x32_bf16 v[224:227], v[88:91], v[96:99], v[224:227]
    s_waitcnt lgkmcnt(0)
    v_cmp_le_u32 vcc, v12, v14
    v_mfma_f32_16x16x32_bf16 v[240:243], v[92:95], v[96:99], v[240:243]
    s_cbranch_vccz CS217k
    v_mfma_f32_16x16x32_bf16 v[164:167], v[72:75], v[100:103], v[164:167]
    v_mfma_f32_16x16x32_bf16 v[180:183], v[76:79], v[100:103], v[180:183]
    v_mfma_f32_16x16x32_bf16 v[228:231], v[88:91], v[100:103], v[228:231]
    v_mfma_f32_16x16x32_bf16 v[244:247], v[92:95], v[100:103], v[244:247]
    v_mfma_f32_16x16x32_bf16 v[168:171], v[72:75], v[104:107], v[168:171]
    v_mfma_f32_16x16x32_bf16 v[184:187], v[76:79], v[104:107], v[184:187]
    v_mfma_f32_16x16x32_bf16 v[232:235], v[88:91], v[104:107], v[232:235]
    ds_read_b32 v12, v119
    v_mfma_f32_16x16x32_bf16 v[248:251], v[92:95], v[104:107], v[248:251]
    v_mfma_f32_16x16x32_bf16 v[172:175], v[72:75], v[108:111], v[172:175]
    v_mfma_f32_16x16x32_bf16 v[188:191], v[76:79], v[108:111], v[188:191]
    v_mfma_f32_16x16x32_bf16 v[236:239], v[88:91], v[108:111], v[236:239]
    v_mfma_f32_16x16x32_bf16 v[252:255], v[92:95], v[108:111], v[252:255]
    s_mov_b32 s83, 200000
    s_waitcnt lgkmcnt(0)
    s_branch CS217t
CS217s:
    ds_read_b32 v12, v119
    s_waitcnt lgkmcnt(0)
CS217t:
    v_cmp_le_u32 vcc, v12, v14
    s_sub_u32 s83, s83, 1
    s_cbranch_scc1 CS217u
    s_cbranch_vccnz CS217s
CS217u:
    ds_read_b64_tr_b16 v[16:17], v112 offset:32768
    ds_read_b64_tr_b16 v[18:19], v112 offset:33792
    ds_read_b128 v[48:51], v116 offset:0
    ds_read_b64_tr_b16 v[20:21], v113 offset:32768
    ds_read_b64_tr_b16 v[22:23], v113 offset:33792
    ds_read_b64_tr_b16 v[32:33], v112 offset:40960
    ds_read_b64_tr_b16 v[34:35], v112 offset:41984
    ds_read_b64_tr_b16 v[36:37], v113 offset:40960
    ds_read_b64_tr_b16 v[38:39], v113 offset:41984
    ds_read_b128 v[52:55], v116 offset:2048
    ds_read_b128 v[56:59], v116 offset:4096
    ds_read_b128 v[60:63], v116 offset:6144
    ds_read_b64_tr_b16 v[24:25], v114 offset:32768
    ds_read_b64_tr_b16 v[26:27], v114 offset:33792
    ds_read_b64_tr_b16 v[28:29], v115 offset:32768
    s_waitcnt lgkmcnt(14)
    ds_read_b64_tr_b16 v[30:31], v115 offset:33792
    s_waitcnt lgkmcnt(14)
    ds_read_b64_tr_b16 v[40:41], v114 offset:40960
    s_waitcnt lgkmcnt(14)
    ds_read_b64_tr_b16 v[42:43], v114 offset:41984
    s_waitcnt lgkmcnt(14)
    ds_read_b64_tr_b16 v[44:45], v115 offset:40960
    s_waitcnt lgkmcnt(14)
    ds_read_b64_tr_b16 v[46:47], v115 offset:41984
    s_branch CS217r
CS217k:
    ds_read_b64_tr_b16 v[16:17], v112 offset:32768
    ds_read_b64_tr_b16 v[18:19], v112 offset:33792
    v_mfma_f32_16x16x32_bf16 v[164:167], v[72:75], v[100:103], v[164:167]
    ds_read_b128 v[48:51], v116 offset:0
    ds_read_b64_tr_b16 v[20:21], v113 offset:32768
    v_mfma_f32_16x16x32_bf16 v[180:183], v[76:79], v[100:103], v[180:183]
    ds_read_b64_tr_b16 v[22:23], v113 offset:33792
    ds_read_b64_tr_b16 v[32:33], v112 offset:40960
    v_mfma_f32_16x16x32_bf16 v[228:231], v[88:91], v[100:103], v[228:231]
    ds_read_b64_tr_b16 v[34:35], v112 offset:41984
    ds_read_b64_tr_b16 v[36:37], v113 offset:40960
    v_mfma_f32_16x16x32_bf16 v[244:247], v[92:95], v[100:103], v[244:247]
    ds_read_b64_tr_b16 v[38:39], v113 offset:41984
    ds_read_b128 v[52:55], v116 offset:2048
    v_mfma_f32_16x16x32_bf16 v[168:171], v[72:75], v[104:107], v[168:171]
    ds_read_b128 v[56:59], v116 offset:4096
    ds_read_b128 v[60:63], v116 offset:6144
    v_mfma_f32_16x16x32_bf16 v[184:187], v[76:79], v[104:107], v[184:187]
    ds_read_b64_tr_b16 v[24:25], v114 offset:32768
    ds_read_b64_tr_b16 v[26:27], v114 offset:33792
    v_mfma_f32_16x16x32_bf16 v[232:235], v[88:91], v[104:107], v[232:235]
    ds_read_b64_tr_b16 v[28:29], v115 offset:32768
    v_mfma_f32_16x16x32_bf16 v[248:251], v[92:95], v[104:107], v[248:251]
    s_waitcnt lgkmcnt(14)
    ds_read_b64_tr_b16 v[30:31], v115 offset:33792
    v_mfma_f32_16x16x32_bf16 v[172:175], v[72:75], v[108:111], v[172:175]
    s_waitcnt lgkmcnt(14)
    ds_read_b64_tr_b16 v[40:41], v114 offset:40960
    v_mfma_f32_16x16x32_bf16 v[188:191], v[76:79], v[108:111], v[188:191]
    s_waitcnt lgkmcnt(14)
    ds_read_b64_tr_b16 v[42:43], v114 offset:41984
    v_mfma_f32_16x16x32_bf16 v[236:239], v[88:91], v[108:111], v[236:239]
    s_waitcnt lgkmcnt(14)
    ds_read_b64_tr_b16 v[44:45], v115 offset:40960
    v_mfma_f32_16x16x32_bf16 v[252:255], v[92:95], v[108:111], v[252:255]
    s_waitcnt lgkmcnt(14)
    ds_read_b64_tr_b16 v[46:47], v115 offset:41984
    s_branch CS217r
CS218:
    v_mfma_f32_16x16x32_bf16 v[152:155], v[20:23], v[56:59], v[152:155]
    v_mfma_f32_16x16x32_bf16 v[200:203], v[32:35], v[56:59], v[200:203]
    v_mfma_f32_16x16x32_bf16 v[216:219], v[36:39], v[56:59], v[216:219]
    v_mfma_f32_16x16x32_bf16 v[140:143], v[16:19], v[60:63], v[140:143]
    ds_read_b32 v12, v119
    v_mfma_f32_16x16x32_bf16 v[156:159], v[20:23], v[60:63], v[156:159]
    v_mfma_f32_16x16x32_bf16 v[204:207], v[32:35], v[60:63], v[204:207]
    v_mfma_f32_16x16x32_bf16 v[220:223], v[36:39], v[60:63], v[220:223]
    v_mfma_f32_16x16x32_bf16 v[160:163], v[24:27], v[48:51], v[160:163]
    v_mfma_f32_16x16x32_bf16 v[176:179], v[28:31], v[48:51], v[176:179]
    v_mfma_f32_16x16x32_bf16 v[224:227], v[40:43], v[48:51], v[224:227]
    s_waitcnt lgkmcnt(0)
    v_cmp_le_u32 vcc, v12, v14
    v_mfma_f32_16x16x32_bf16 v[240:243], v[44:47], v[48:51], v[240:243]
    s_cbranch_vccz CS218k
    v_mfma_f32_16x16x32_bf16 v[164:167], v[24:27], v[52:55], v[164:167]
    v_mfma_f32_16x16x32_bf16 v[180:183], v[28:31], v[52:55], v[180:183]
    v_mfma_f32_16x16x32_bf16 v[228:231], v[40:43], v[52:55], v[228:231]
    v_mfma_f32_16x16x32_bf16 v[244:247], v[44:47], v[52:55], v[244:247]
    v_mfma_f32_16x16x32_bf16 v[168:171], v[24:27], v[56:59], v[168:171]
    v_mfma_f32_16x16x32_bf16 v[184:187], v[28:31], v[56:59], v[184:187]
    v_mfma_f32_16x16x32_bf16 v[232:235], v[40:43], v[56:59], v[232:235]
    ds_read_b32 v12, v119
    v_mfma_f32_16x16x32_bf16 v[248:251], v[44:47], v[56:59], v[248:251]
    v_mfma_f32_16x16x32_bf16 v[172:175], v[24:27], v[60:63], v[172:175]
    v_mfma_f32_16x16x32_bf16 v[188:191], v[28:31], v[60:63], v[188:191]
    v_mfma_f32_16x16x32_bf16 v[236:239], v[40:43], v[60:63], v[236:239]
    v_mfma_f32_16x16x32_bf16 v[252:255], v[44:47], v[60:63], v[252:255]
    s_mov_b32 s83, 200000
    s_waitcnt lgkmcnt(0)
    s_branch CS218t
CS218s:
    ds_read_b32 v12, v119
    s_waitcnt lgkmcnt(0)
CS218t:
    v_cmp_le_u32 vcc, v12, v14
    s_sub_u32 s83, s83, 1
    s_cbranch_scc1 CS218u
    s_cbranch_vccnz CS218s
CS218u:
    ds_read_b64_tr_b16 v[64:65], v112 offset:49152
    ds_read_b64_tr_b16 v[66:67], v112 offset:50176
    ds_read_b128 v[96:99], v117 offset:0
    ds_read_b64_tr_b16 v[68:69], v113 offset:49152
    ds_read_b64_tr_b16 v[70:71], v113 offset:50176
    ds_read_b64_tr_b16 v[80:81], v112 offset:57344
    ds_read_b64_tr_b16 v[82:83], v112 offset:58368
    ds_read_b64_tr_b16 v[84:85], v113 offset:57344
    ds_read_b64_tr_b16 v[86:87], v113 offset:58368
    ds_read_b128 v[100:103], v117 offset:2048
    ds_read_b128 v[104:107], v117 offset:4096
    ds_read_b128 v[108:111], v117 offset:6144
    ds_read_b64_tr_b16 v[72:73], v114 offset:49152
    ds_read_b64_tr_b16 v[74:75], v114 offset:50176
    ds_read_b64_tr_b16 v[76:77], v115 offset:49152
    s_waitcnt lgkmcnt(14)
    ds_read_b64_tr_b16 v[78:79], v115 offset:50176
    s_waitcnt lgkmcnt(14)
    ds_read_b64_tr_b16 v[88:89], v114 offset:57344
    s_waitcnt lgkmcnt(14)
    ds_read_b64_tr_b16 v[90:91], v114 offset:58368
    s_waitcnt lgkmcnt(14)
    ds_read_b64_tr_b16 v[92:93], v115 offset:57344
    s_waitcnt lgkmcnt(14)
    ds_read_b64_tr_b16 v[94:95], v115 offset:58368
    s_sub_u32 s4, s4, 1
    s_branch CS218r
CS218k:
    ds_read_b64_tr_b16 v[64:65], v112 offset:49152
    ds_read_b64_tr_b16 v[66:67], v112 offset:50176
    v_mfma_f32_16x16x32_bf16 v[164:167], v[24:27], v[52:55], v[164:167]
    ds_read_b128 v[96:99], v117 offset:0
    ds_read_b64_tr_b16 v[68:69], v113 offset:49152
    v_mfma_f32_16x16x32_bf16 v[180:183], v[28:31], v[52:55], v[180:183]
    ds_read_b64_tr_b16 v[70:71], v113 offset:50176
    ds_read_b64_tr_b16 v[80:81], v112 offset:57344
    v_mfma_f32_16x16x32_bf16 v[228:231], v[40:43], v[52:55], v[228:231]
    ds_read_b64_tr_b16 v[82:83], v112 offset:58368
    ds_read_b64_tr_b16 v[84:85], v113 offset:57344
    v_mfma_f32_16x16x32_bf16 v[244:247], v[44:47], v[52:55], v[244:247]
    ds_read_b64_tr_b16 v[86:87], v113 offset:58368
    ds_read_b128 v[100:103], v117 offset:2048
    v_mfma_f32_16x16x32_bf16 v[168:171], v[24:27], v[56:59], v[168:171]
    ds_read_b128 v[104:107], v117 offset:4096
    ds_read_b128 v[108:111], v117 offset:6144
    v_mfma_f32_16x16x32_bf16 v[184:187], v[28:31], v[56:59], v[184:187]
    ds_read_b64_tr_b16 v[72:73], v114 offset:49152
    ds_read_b64_tr_b16 v[74:75], v114 offset:50176
    v_mfma_f32_16x16x32_bf16 v[232:235], v[40:43], v[56:59], v[232:235]
    ds_read_b64_tr_b16 v[76:77], v115 offset:49152
    v_mfma_f32_16x16x32_bf16 v[248:251], v[44:47], v[56:59], v[248:251]
    s_waitcnt lgkmcnt(14)
    ds_read_b64_tr_b16 v[78:79], v115 offset:50176
    v_mfma_f32_16x16x32_bf16 v[172:175], v[24:27], v[60:63], v[172:175]
    s_waitcnt lgkmcnt(14)
    ds_read_b64_tr_b16 v[88:89], v114 offset:57344
    v_mfma_f32_16x16x32_bf16 v[188:191], v[28:31], v[60:63], v[188:191]
    s_waitcnt lgkmcnt(14)
    ds_read_b64_tr_b16 v[90:91], v114 offset:58368
    v_mfma_f32_16x16x32_bf16 v[236:239], v[40:43], v[60:63], v[236:239]
    s_waitcnt lgkmcnt(14)
    ds_read_b64_tr_b16 v[92:93], v115 offset:57344
    v_mfma_f32_16x16x32_bf16 v[252:255], v[44:47], v[60:63], v[252:255]
    s_waitcnt lgkmcnt(14)
    ds_read_b64_tr_b16 v[94:95], v115 offset:58368
    s_sub_u32 s4, s4, 1
    s_branch CS218r
L_CONVH:
    s_and_b32 s28, s3, 1
    s_lshr_b32 s29, s3, 1
    s_mul_i32 s15, s3, 22528
    s_add_u32 s14, s75, s3
    s_mov_b32 s27, 0
    s_mov_b32 s9, 2
    v_mov_b32 v15, 161280
    s_mov_b32 s83, 200000
SPL221:
    ds_read_b32 v12, v15 offset:20
    s_waitcnt lgkmcnt(0)
    s_nop 0
    v_readfirstlane_b32 s82, v12
    s_sub_u32 s83, s83, 1
    s_cselect_b32 s82, -1, s82
    s_cmp_ge_u32 s82, 1
    s_cbranch_scc1 SPD222
    s_sleep 2
    s_branch SPL221
SPD222:
    s_mov_b32 s54, s82
L_CONVR:
    s_lshl_b32 s24, s28, 8
    s_cmp_eq_u32 s9, 2
    s_cselect_b32 s24, 0, s24
    s_cselect_b32 s25, 4, 2
    s_sub_u32 s8, s14, s75
    s_lshl_b32 s8, s8, 2
    s_add_u32 s8, s8, 161280
    v_mov_b32 v5, s8
    s_mov_b32 s83, 200000
L_KRS:
    ds_read_b32 v11, v5 offset:56
    s_getreg_b32 s34, hwreg(HW_REG_IB_STS, 0, 4)
    s_cmp_lt_u32 s34, s27
    s_cbranch_scc1 L_F2P0
L_F2B0:
    s_waitcnt lgkmcnt(0)
    v_cmp_gt_u32 vcc, 2, v11
    s_sub_u32 s83, s83, 1
    s_cbranch_scc1 L_KRD
    s_cbranch_vccnz L_KRS
L_KRD:
    s_cmp_lg_u32 s9, 2
    s_cbranch_scc1 L_NT3
    s_mov_b32 s4, s40
    s_and_b32 s5, s41, 0xffff
    s_mov_b32 s6, 2621440
    s_mov_b32 s7, 0x00020000
    v_and_b32 v1, 15, v0
    v_lshrrev_b32 v2, 4, v0
    v_mul_u32_u24 v3, 1280, v1
    v_lshl_add_u32 v3, v2, 3, v3
    s_lshl_b32 s77, s72, 2
    s_add_u32 s77, s77, s3
    s_mul_i32 s78, s77, 20480
    s_mul_i32 s79, s73, 160
    s_add_u32 s78, s78, s79
    s_and_b32 s80, s73, 1
    s_cselect_b32 s81, 0, 128
    s_lshl_b32 s80, s80, 5
    s_add_u32 s82, s78, s81
    s_add_u32 s78, s78, s80
    v_lshl_add_u32 v4, v2, 3, v3
    buffer_load_dwordx4 v[224:227], v4, s[4:7], s78 offen offset:0
    buffer_load_dwordx4 v[228:231], v4, s[4:7], s78 offen offset:64
    buffer_load_dwordx2 v[232:233], v3, s[4:7], s82 offen
    s_add_u32 s80, s80, s79
    s_add_u32 s81, s81, s79
    v_lshlrev_b32 v3, 4, v2
    v_add_u32 v3, s80, v3
    v_lshlrev_b32 v4, 3, v2
    v_add_u32 v4, s81, v4
    global_load_dwordx4 v[234:237], v3, s[52:53] offset:0
    global_load_dwordx4 v[238:241], v3, s[52:53] offset:64
    global_load_dwordx2 v[242:243], v4, s[52:53]
    v_lshlrev_b32 v3, 4, v1
    s_lshl_b32 s78, s77, 8
    s_add_u32 s78, s78, 16777216
    buffer_load_dwordx4 v[244:247], v3, s[16:19], s78 offen sc1
L_NT3:
    v_and_b32 v1, 15, v0
    v_lshrrev_b32 v2, 4, v0
    v_and_b32 v3, 1, v0
    v_lshlrev_b32 v4, 3, v2
    v_sub_u32 v4, v4, v1
    v_add_u32 v4, v4, v3
    v_lshlrev_b32 v4, 1, v4
    v_mul_u32_u24 v3, 4416, v3
    v_add_u32 v4, v4, v3
    s_sub_u32 s78, s15, s24
    s_add_u32 s79, s78, 17760
    v_add_u32 v4, s79, v4
    v_subrev_u32 v60, 512, v4
    v_subrev_u32 v61, 1536, v4
    v_subrev_u32 v62, 2560, v4
    v_subrev_u32 v63, 3584, v4
    v_lshl_add_u32 v4, v1, 1, v2
    v_lshlrev_b32 v4, 4, v4
    s_add_u32 s78, s78, 480
    v_add_u32 v59, s78, v4
    v_lshlrev_b32 v57, 5, v1
    v_lshl_add_u32 v57, v2, 3, v57
    ds_read2_b32 v[64:65], v60 offset0:128 offset1:129
    ds_read2_b32 v[66:67], v60 offset0:130 offset1:131
    ds_read_b128 v[160:163], v59 offset:0
    ds_read2_b32 v[68:69], v60 offset0:0 offset1:1
    ds_read2_b32 v[70:71], v60 offset0:2 offset1:3
    ds_read_b128 v[164:167], v59 offset:512
    s_getreg_b32 s34, hwreg(HW_REG_IB_STS, 0, 4)
    s_cmp_lt_u32 s34, s27
    s_cbranch_scc1 L_F2P1
L_F2B1:
    ds_read2_b32 v[72:73], v61 offset0:128 offset1:129
    ds_read2_b32 v[74:75], v61 offset0:130 offset1:131
    ds_read_b128 v[168:171], v59 offset:1024
    ds_read2_b32 v[76:77], v61 offset0:0 offset1:1
    ds_read2_b32 v[78:79], v61 offset0:2 offset1:3
    ds_read_b128 v[172:175], v59 offset:1536
    s_getreg_b32 s34, hwreg(HW_REG_IB_STS, 0, 4)
    s_cmp_lt_u32 s34, s27
    s_cbranch_scc1 L_F2P2
L_F2B2:
    ds_read2_b32 v[80:81], v62 offset0:128 offset1:129
    ds_read2_b32 v[82:83], v62 offset0:130 offset1:131
    ds_read_b128 v[176:179], v59 offset:2048
    s_waitcnt lgkmcnt(14)
    ds_read2_b32 v[84:85], v62 offset0:0 offset1:1
    s_waitcnt lgkmcnt(14)
    ds_read2_b32 v[86:87], v62 offset0:2 offset1:3
    s_waitcnt lgkmcnt(14)
    ds_read_b128 v[180:183], v59 offset:2560
    s_getreg_b32 s34, hwreg(HW_REG_IB_STS, 0, 4)
    s_cmp_lt_u32 s34, s27
    s_cbranch_scc1 L_F2P3
L_F2B3:
    s_waitcnt lgkmcnt(14)
    ds_read2_b32 v[88:89], v63 offset0:128 offset1:129
    s_waitcnt lgkmcnt(14)
    ds_read2_b32 v[90:91], v63 offset0:130 offset1:131
    s_waitcnt lgkmcnt(14)
    ds_read_b128 v[184:187], v59 offset:3072
    s_waitcnt lgkmcnt(14)
    ds_read2_b32 v[92:93], v63 offset0:0 offset1:1
    s_waitcnt lgkmcnt(14)
    ds_read2_b32 v[94:95], v63 offset0:2 offset1:3
    s_waitcnt lgkmcnt(14)
    ds_read_b128 v[188:191], v59 offset:3584
    s_getreg_b32 s34, hwreg(HW_REG_IB_STS, 0, 4)
    s_cmp_lt_u32 s34, s27
    s_cbranch_scc1 L_F2P4
L_F2B4:
    v_mov_b64 v[128:129], 0
    v_mov_b64 v[130:131], 0
    v_mov_b64 v[132:133], 0
    v_mov_b64 v[134:135], 0
    v_mov_b64 v[136:137], 0
    v_mov_b64 v[138:139], 0
    v_mov_b64 v[140:141], 0
    v_mov_b64 v[142:143], 0
    v_mov_b64 v[144:145], 0
    v_mov_b64 v[146:147], 0
    v_mov_b64 v[148:149], 0
    v_mov_b64 v[150:151], 0
    v_mov_b64 v[152:153], 0
    v_mov_b64 v[154:155], 0
    v_mov_b64 v[156:157], 0
    v_mov_b64 v[158:159], 0
    v_subrev_u32 v60, 64, v60
    v_subrev_u32 v61, 64, v61
    v_subrev_u32 v62, 64, v62
    v_subrev_u32 v63, 64, v63
    v_subrev_u32 v59, 64, v59
    s_getreg_b32 s34, hwreg(HW_REG_IB_STS, 0, 4)
    s_cmp_lt_u32 s34, s27
    s_cbranch_scc1 L_F2P5
L_F2B5:
    s_waitcnt lgkmcnt(0)
    s_cmp_eq_u32 s27, 0
    s_cbranch_scc1 L_CONV2
    .p2alignl 3, 0xbf800000
L_CONV:
    v_mfma_f32_16x16x32_bf16 v[128:131], v[64:67], v[160:163], v[128:131]
    v_mfma_f32_16x16x32_bf16 v[132:135], v[68:71], v[160:163], v[132:135]
    s_getreg_b32 s34, hwreg(HW_REG_IB_STS, 0, 4)
    s_cmp_lt_u32 s34, s27
    s_cbranch_scc1 L_F2P6
L_F2B6:
    v_mfma_f32_16x16x32_bf16 v[132:135], v[64:67], v[164:167], v[132:135]
    s_waitcnt lgkmcnt(14)
    ds_read2_b32 v[96:97], v60 offset0:128 offset1:129
    s_waitcnt lgkmcnt(14)
    ds_read2_b32 v[98:99], v60 offset0:130 offset1:131
    v_mfma_f32_16x16x32_bf16 v[136:139], v[68:71], v[164:167], v[136:139]
    v_mfma_f32_16x16x32_bf16 v[136:139], v[72:75], v[160:163], v[136:139]
    s_waitcnt lgkmcnt(14)
    ds_read_b128 v[192:195], v59 offset:0
    v_mfma_f32_16x16x32_bf16 v[140:143], v[72:75], v[164:167], v[140:143]
    v_mfma_f32_16x16x32_bf16 v[136:139], v[64:67], v[168:171], v[136:139]
    s_waitcnt lgkmcnt(14)
    ds_read2_b32 v[100:101], v60 offset0:0 offset1:1
    s_waitcnt lgkmcnt(14)
    ds_read2_b32 v[102:103], v60 offset0:2 offset1:3
    v_mfma_f32_16x16x32_bf16 v[140:143], v[68:71], v[168:171], v[140:143]
    s_getreg_b32 s34, hwreg(HW_REG_IB_STS, 0, 4)
    s_cmp_lt_u32 s34, s27
    s_cbranch_scc1 L_F2P7
L_F2B7:
    v_mfma_f32_16x16x32_bf16 v[144:147], v[72:75], v[168:171], v[144:147]
    s_waitcnt lgkmcnt(14)
    ds_read_b128 v[196:199], v59 offset:512
    v_mfma_f32_16x16x32_bf16 v[140:143], v[76:79], v[160:163], v[140:143]
    v_mfma_f32_16x16x32_bf16 v[144:147], v[76:79], v[164:167], v[144:147]
    s_waitcnt lgkmcnt(14)
    ds_read2_b32 v[104:105], v61 offset0:128 offset1:129
    s_waitcnt lgkmcnt(14)
    ds_read2_b32 v[106:107], v61 offset0:130 offset1:131
    v_mfma_f32_16x16x32_bf16 v[148:151], v[76:79], v[168:171], v[148:151]
    v_mfma_f32_16x16x32_bf16 v[140:143], v[64:67], v[172:175], v[140:143]
    s_waitcnt lgkmcnt(14)
    ds_read_b128 v[200:203], v59 offset:1024
    v_mfma_f32_16x16x32_bf16 v[144:147], v[68:71], v[172:175], v[144:147]
    s_getreg_b32 s34, hwreg(HW_REG_IB_STS, 0, 4)
    s_cmp_lt_u32 s34, s27
    s_cbranch_scc1 L_F2P8
L_F2B8:
    v_mfma_f32_16x16x32_bf16 v[148:151], v[72:75], v[172:175], v[148:151]
    s_waitcnt lgkmcnt(14)
    ds_read2_b32 v[108:109], v61 offset0:0 offset1:1
    s_waitcnt lgkmcnt(14)
    ds_read2_b32 v[110:111], v61 offset0:2 offset1:3
    v_mfma_f32_16x16x32_bf16 v[152:155], v[76:79], v[172:175], v[152:155]
    v_mfma_f32_16x16x32_bf16 v[144:147], v[80:83], v[160:163], v[144:147]
    s_waitcnt lgkmcnt(14)
    ds_read_b128 v[204:207], v59 offset:1536
    v_mfma_f32_16x16x32_bf16 v[148:151], v[80:83], v[164:167], v[148:151]
    v_mfma_f32_16x16x32_bf16 v[152:155], v[80:83], v[168:171], v[152:155]
    s_waitcnt lgkmcnt(14)
    ds_read2_b32 v[112:113], v62 offset0:128 offset1:129
    s_waitcnt lgkmcnt(14)
    ds_read2_b32 v[114:115], v62 offset0:130 offset1:131
    v_mfma_f32_16x16x32_bf16 v[156:159], v[80:83], v[172:175], v[156:159]
    s_getreg_b32 s34, hwreg(HW_REG_IB_STS, 0, 4)
    s_cmp_lt_u32 s34, s27
    s_cbranch_scc1 L_F2P9
L_F2B9:
    v_mfma_f32_16x16x32_bf16 v[144:147], v[64:67], v[176:179], v[144:147]
    s_waitcnt lgkmcnt(14)
    ds_read_b128 v[208:211], v59 offset:2048
    v_mfma_f32_16x16x32_bf16 v[148:151], v[68:71], v[176:179], v[148:151]
    v_mfma_f32_16x16x32_bf16 v[152:155], v[72:75], v[176:179], v[152:155]
    s_waitcnt lgkmcnt(14)
    ds_read2_b32 v[116:117], v62 offset0:0 offset1:1
    s_waitcnt lgkmcnt(14)
    ds_read2_b32 v[118:119], v62 offset0:2 offset1:3
    v_mfma_f32_16x16x32_bf16 v[156:159], v[76:79], v[176:179], v[156:159]
    v_mfma_f32_16x16x32_bf16 v[148:151], v[84:87], v[160:163], v[148:151]
    s_waitcnt lgkmcnt(14)
    ds_read_b128 v[212:215], v59 offset:2560
    v_mfma_f32_16x16x32_bf16 v[152:155], v[84:87], v[164:167], v[152:155]
    s_getreg_b32 s34, hwreg(HW_REG_IB_STS, 0, 4)
    s_cmp_lt_u32 s34, s27
    s_cbranch_scc1 L_F2P10
L_F2B10:
    v_mfma_f32_16x16x32_bf16 v[156:159], v[84:87], v[168:171], v[156:159]
    s_waitcnt lgkmcnt(14)
    ds_read2_b32 v[120:121], v63 offset0:128 offset1:129
    s_waitcnt lgkmcnt(14)
    ds_read2_b32 v[122:123], v63 offset0:130 offset1:131
    v_mfma_f32_16x16x32_bf16 v[148:151], v[64:67], v[180:183], v[148:151]
    v_mfma_f32_16x16x32_bf16 v[152:155], v[68:71], v[180:183], v[152:155]
    s_waitcnt lgkmcnt(14)
    ds_read_b128 v[216:219], v59 offset:3072
    v_mfma_f32_16x16x32_bf16 v[156:159], v[72:75], v[180:183], v[156:159]
    v_mfma_f32_16x16x32_bf16 v[152:155], v[88:91], v[160:163], v[152:155]
    s_waitcnt lgkmcnt(14)
    ds_read2_b32 v[124:125], v63 offset0:0 offset1:1
    s_waitcnt lgkmcnt(14)
    ds_read2_b32 v[126:127], v63 offset0:2 offset1:3
    v_mfma_f32_16x16x32_bf16 v[156:159], v[88:91], v[164:167], v[156:159]
    s_getreg_b32 s34, hwreg(HW_REG_IB_STS, 0, 4)
    s_cmp_lt_u32 s34, s27
    s_cbranch_scc1 L_F2P11
L_F2B11:
    v_mfma_f32_16x16x32_bf16 v[152:155], v[64:67], v[184:187], v[152:155]
    s_waitcnt lgkmcnt(14)
    ds_read_b128 v[220:223], v59 offset:3584
    v_mfma_f32_16x16x32_bf16 v[156:159], v[68:71], v[184:187], v[156:159]
    v_subrev_u32 v60, 64, v60
    v_subrev_u32 v61, 64, v61
    v_subrev_u32 v62, 64, v62
    v_subrev_u32 v63, 64, v63
    v_subrev_u32 v59, 64, v59
    v_mfma_f32_16x16x32_bf16 v[156:159], v[92:95], v[160:163], v[156:159]
    v_mfma_f32_16x16x32_bf16 v[156:159], v[64:67], v[188:191], v[156:159]
    v_mfma_f32_16x16x32_bf16 v[128:131], v[96:99], v[192:195], v[128:131]
    v_mfma_f32_16x16x32_bf16 v[132:135], v[100:103], v[192:195], v[132:135]
    s_getreg_b32 s34, hwreg(HW_REG_IB_STS, 0, 4)
    s_cmp_lt_u32 s34, s27
    s_cbranch_scc1 L_F2P12
L_F2B12:
    v_mfma_f32_16x16x32_bf16 v[132:135], v[96:99], v[196:199], v[132:135]
    s_waitcnt lgkmcnt(14)
    ds_read2_b32 v[64:65], v60 offset0:128 offset1:129
    s_waitcnt lgkmcnt(14)
    ds_read2_b32 v[66:67], v60 offset0:130 offset1:131
    v_mfma_f32_16x16x32_bf16 v[136:139], v[100:103], v[196:199], v[136:139]
    v_mfma_f32_16x16x32_bf16 v[136:139], v[104:107], v[192:195], v[136:139]
    s_waitcnt lgkmcnt(14)
    ds_read_b128 v[160:163], v59 offset:0
    v_mfma_f32_16x16x32_bf16 v[140:143], v[104:107], v[196:199], v[140:143]
    v_mfma_f32_16x16x32_bf16 v[136:139], v[96:99], v[200:203], v[136:139]
    s_waitcnt lgkmcnt(14)
    ds_read2_b32 v[68:69], v60 offset0:0 offset1:1
    s_waitcnt lgkmcnt(14)
    ds_read2_b32 v[70:71], v60 offset0:2 offset1:3
    v_mfma_f32_16x16x32_bf16 v[140:143], v[100:103], v[200:203], v[140:143]
    v_mfma_f32_16x16x32_bf16 v[144:147], v[104:107], v[200:203], v[144:147]
    s_waitcnt lgkmcnt(14)
    ds_read_b128 v[164:167], v59 offset:512
    v_mfma_f32_16x16x32_bf16 v[140:143], v[108:111], v[192:195], v[140:143]
    v_mfma_f32_16x16x32_bf16 v[144:147], v[108:111], v[196:199], v[144:147]
    s_waitcnt lgkmcnt(14)
    ds_read2_b32 v[72:73], v61 offset0:128 offset1:129
    s_waitcnt lgkmcnt(14)
    ds_read2_b32 v[74:75], v61 offset0:130 offset1:131
    v_mfma_f32_16x16x32_bf16 v[148:151], v[108:111], v[200:203], v[148:151]
    v_mfma_f32_16x16x32_bf16 v[140:143], v[96:99], v[204:207], v[140:143]
    s_waitcnt lgkmcnt(14)
    ds_read_b128 v[168:171], v59 offset:1024
    v_mfma_f32_16x16x32_bf16 v[144:147], v[100:103], v[204:207], v[144:147]
    s_getreg_b32 s34, hwreg(HW_REG_IB_STS, 0, 4)
    s_cmp_lt_u32 s34, s27
    s_cbranch_scc1 L_F2P13
L_F2B13:
    v_mfma_f32_16x16x32_bf16 v[148:151], v[104:107], v[204:207], v[148:151]
    s_waitcnt lgkmcnt(14)
    ds_read2_b32 v[76:77], v61 offset0:0 offset1:1
    s_waitcnt lgkmcnt(14)
    ds_read2_b32 v[78:79], v61 offset0:2 offset1:3
    v_mfma_f32_16x16x32_bf16 v[152:155], v[108:111], v[204:207], v[152:155]
    v_mfma_f32_16x16x32_bf16 v[144:147], v[112:115], v[192:195], v[144:147]
    s_waitcnt lgkmcnt(14)
    ds_read_b128 v[172:175], v59 offset:1536
    v_mfma_f32_16x16x32_bf16 v[148:151], v[112:115], v[196:199], v[148:151]
    v_mfma_f32_16x16x32_bf16 v[152:155], v[112:115], v[200:203], v[152:155]
    s_waitcnt lgkmcnt(14)
    ds_read2_b32 v[80:81], v62 offset0:128 offset1:129
    s_waitcnt lgkmcnt(14)
    ds_read2_b32 v[82:83], v62 offset0:130 offset1:131
    v_mfma_f32_16x16x32_bf16 v[156:159], v[112:115], v[204:207], v[156:159]
    v_mfma_f32_16x16x32_bf16 v[144:147], v[96:99], v[208:211], v[144:147]
    s_waitcnt lgkmcnt(14)
    ds_read_b128 v[176:179], v59 offset:2048
    v_mfma_f32_16x16x32_bf16 v[148:151], v[100:103], v[208:211], v[148:151]
    v_mfma_f32_16x16x32_bf16 v[152:155], v[104:107], v[208:211], v[152:155]
    s_waitcnt lgkmcnt(14)
    ds_read2_b32 v[84:85], v62 offset0:0 offset1:1
    s_waitcnt lgkmcnt(14)
    ds_read2_b32 v[86:87], v62 offset0:2 offset1:3
    v_mfma_f32_16x16x32_bf16 v[156:159], v[108:111], v[208:211], v[156:159]
    v_mfma_f32_16x16x32_bf16 v[148:151], v[116:119], v[192:195], v[148:151]
    s_waitcnt lgkmcnt(14)
    ds_read_b128 v[180:183], v59 offset:2560
    v_mfma_f32_16x16x32_bf16 v[152:155], v[116:119], v[196:199], v[152:155]
    s_getreg_b32 s34, hwreg(HW_REG_IB_STS, 0, 4)
    s_cmp_lt_u32 s34, s27
    s_cbranch_scc1 L_F2P14
L_F2B14:
    v_mfma_f32_16x16x32_bf16 v[156:159], v[116:119], v[200:203], v[156:159]
    s_waitcnt lgkmcnt(14)
    ds_read2_b32 v[88:89], v63 offset0:128 offset1:129
    s_waitcnt lgkmcnt(14)
    ds_read2_b32 v[90:91], v63 offset0:130 offset1:131
    v_mfma_f32_16x16x32_bf16 v[148:151], v[96:99], v[212:215], v[148:151]
    v_mfma_f32_16x16x32_bf16 v[152:155], v[100:103], v[212:215], v[152:155]
    s_waitcnt lgkmcnt(14)
    ds_read_b128 v[184:187], v59 offset:3072
    v_mfma_f32_16x16x32_bf16 v[156:159], v[104:107], v[212:215], v[156:159]
    v_mfma_f32_16x16x32_bf16 v[152:155], v[120:123], v[192:195], v[152:155]
    s_waitcnt lgkmcnt(14)
    ds_read2_b32 v[92:93], v63 offset0:0 offset1:1
    s_waitcnt lgkmcnt(14)
    ds_read2_b32 v[94:95], v63 offset0:2 offset1:3
    v_mfma_f32_16x16x32_bf16 v[156:159], v[120:123], v[196:199], v[156:159]
    v_mfma_f32_16x16x32_bf16 v[152:155], v[96:99], v[216:219], v[152:155]
    s_waitcnt lgkmcnt(14)
    ds_read_b128 v[188:191], v59 offset:3584
    v_mfma_f32_16x16x32_bf16 v[156:159], v[100:103], v[216:219], v[156:159]
    v_subrev_u32 v60, 64, v60
    v_subrev_u32 v61, 64, v61
    v_subrev_u32 v62, 64, v62
    v_subrev_u32 v63, 64, v63
    v_subrev_u32 v59, 64, v59
    v_mfma_f32_16x16x32_bf16 v[156:159], v[124:127], v[192:195], v[156:159]
    v_mfma_f32_16x16x32_bf16 v[156:159], v[96:99], v[220:223], v[156:159]
    s_sub_u32 s25, s25, 1
    s_cmp_eq_u32 s25, 0
    s_cbranch_scc1 L_CONVE
    s_cmp_lg_u32 s27, 0
    s_cbranch_scc1 L_CONV
    .p2alignl 3, 0xbf800000
L_CONV2:
    v_mfma_f32_16x16x32_bf16 v[128:131], v[64:67], v[160:163], v[128:131]
    v_mfma_f32_16x16x32_bf16 v[132:135], v[68:71], v[160:163], v[132:135]
    v_mfma_f32_16x16x32_bf16 v[132:135], v[64:67], v[164:167], v[132:135]
    s_waitcnt lgkmcnt(14)
    ds_read2_b32 v[96:97], v60 offset0:128 offset1:129
    s_waitcnt lgkmcnt(14)
    ds_read2_b32 v[98:99], v60 offset0:130 offset1:131
    v_mfma_f32_16x16x32_bf16 v[136:139], v[68:71], v[164:167], v[136:139]
    v_mfma_f32_16x16x32_bf16 v[136:139], v[72:75], v[160:163], v[136:139]
    s_waitcnt lgkmcnt(14)
    ds_read_b128 v[192:195], v59 offset:0
    v_mfma_f32_16x16x32_bf16 v[140:143], v[72:75], v[164:167], v[140:143]
    v_mfma_f32_16x16x32_bf16 v[136:139], v[64:67], v[168:171], v[136:139]
    s_waitcnt lgkmcnt(14)
    ds_read2_b32 v[100:101], v60 offset0:0 offset1:1
    s_waitcnt lgkmcnt(14)
    ds_read2_b32 v[102:103], v60 offset0:2 offset1:3
    v_mfma_f32_16x16x32_bf16 v[140:143], v[68:71], v[168:171], v[140:143]
    v_mfma_f32_16x16x32_bf16 v[144:147], v[72:75], v[168:171], v[144:147]
    s_waitcnt lgkmcnt(14)
    ds_read_b128 v[196:199], v59 offset:512
    v_mfma_f32_16x16x32_bf16 v[140:143], v[76:79], v[160:163], v[140:143]
    v_mfma_f32_16x16x32_bf16 v[144:147], v[76:79], v[164:167], v[144:147]
    s_waitcnt lgkmcnt(14)
    ds_read2_b32 v[104:105], v61 offset0:128 offset1:129
    s_waitcnt lgkmcnt(14)
    ds_read2_b32 v[106:107], v61 offset0:130 offset1:131
    v_mfma_f32_16x16x32_bf16 v[148:151], v[76:79], v[168:171], v[148:151]
    v_mfma_f32_16x16x32_bf16 v[140:143], v[64:67], v[172:175], v[140:143]
    s_waitcnt lgkmcnt(14)
    ds_read_b128 v[200:203], v59 offset:1024
    v_mfma_f32_16x16x32_bf16 v[144:147], v[68:71], v[172:175], v[144:147]
    v_mfma_f32_16x16x32_bf16 v[148:151], v[72:75], v[172:175], v[148:151]
    s_waitcnt lgkmcnt(14)
    ds_read2_b32 v[108:109], v61 offset0:0 offset1:1
    s_waitcnt lgkmcnt(14)
    ds_read2_b32 v[110:111], v61 offset0:2 offset1:3
    v_mfma_f32_16x16x32_bf16 v[152:155], v[76:79], v[172:175], v[152:155]
    v_mfma_f32_16x16x32_bf16 v[144:147], v[80:83], v[160:163], v[144:147]
    s_waitcnt lgkmcnt(14)
    ds_read_b128 v[204:207], v59 offset:1536
    v_mfma_f32_16x16x32_bf16 v[148:151], v[80:83], v[164:167], v[148:151]
    v_mfma_f32_16x16x32_bf16 v[152:155], v[80:83], v[168:171], v[152:155]
    s_waitcnt lgkmcnt(14)
    ds_read2_b32 v[112:113], v62 offset0:128 offset1:129
    s_waitcnt lgkmcnt(14)
    ds_read2_b32 v[114:115], v62 offset0:130 offset1:131
    v_mfma_f32_16x16x32_bf16 v[156:159], v[80:83], v[172:175], v[156:159]
    v_mfma_f32_16x16x32_bf16 v[144:147], v[64:67], v[176:179], v[144:147]
    s_waitcnt lgkmcnt(14)
    ds_read_b128 v[208:211], v59 offset:2048
    v_mfma_f32_16x16x32_bf16 v[148:151], v[68:71], v[176:179], v[148:151]
    v_mfma_f32_16x16x32_bf16 v[152:155], v[72:75], v[176:179], v[152:155]
    s_waitcnt lgkmcnt(14)
    ds_read2_b32 v[116:117], v62 offset0:0 offset1:1
    s_waitcnt lgkmcnt(14)
    ds_read2_b32 v[118:119], v62 offset0:2 offset1:3
    v_mfma_f32_16x16x32_bf16 v[156:159], v[76:79], v[176:179], v[156:159]
    v_mfma_f32_16x16x32_bf16 v[148:151], v[84:87], v[160:163], v[148:151]
    s_waitcnt lgkmcnt(14)
    ds_read_b128 v[212:215], v59 offset:2560
    v_mfma_f32_16x16x32_bf16 v[152:155], v[84:87], v[164:167], v[152:155]
    v_mfma_f32_16x16x32_bf16 v[156:159], v[84:87], v[168:171], v[156:159]
    s_waitcnt lgkmcnt(14)
    ds_read2_b32 v[120:121], v63 offset0:128 offset1:129
    s_waitcnt lgkmcnt(14)
    ds_read2_b32 v[122:123], v63 offset0:130 offset1:131
    v_mfma_f32_16x16x32_bf16 v[148:151], v[64:67], v[180:183], v[148:151]
    v_mfma_f32_16x16x32_bf16 v[152:155], v[68:71], v[180:183], v[152:155]
    s_waitcnt lgkmcnt(14)
    ds_read_b128 v[216:219], v59 offset:3072
    v_mfma_f32_16x16x32_bf16 v[156:159], v[72:75], v[180:183], v[156:159]
    v_mfma_f32_16x16x32_bf16 v[152:155], v[88:91], v[160:163], v[152:155]
    s_waitcnt lgkmcnt(14)
    ds_read2_b32 v[124:125], v63 offset0:0 offset1:1
    s_waitcnt lgkmcnt(14)
    ds_read2_b32 v[126:127], v63 offset0:2 offset1:3
    v_mfma_f32_16x16x32_bf16 v[156:159], v[88:91], v[164:167], v[156:159]
    v_mfma_f32_16x16x32_bf16 v[152:155], v[64:67], v[184:187], v[152:155]
    s_waitcnt lgkmcnt(14)
    ds_read_b128 v[220:223], v59 offset:3584
    v_mfma_f32_16x16x32_bf16 v[156:159], v[68:71], v[184:187], v[156:159]
    v_subrev_u32 v60, 64, v60
    v_subrev_u32 v61, 64, v61
    v_subrev_u32 v62, 64, v62
    v_subrev_u32 v63, 64, v63
    v_subrev_u32 v59, 64, v59
    v_mfma_f32_16x16x32_bf16 v[156:159], v[92:95], v[160:163], v[156:159]
    v_mfma_f32_16x16x32_bf16 v[156:159], v[64:67], v[188:191], v[156:159]
    v_mfma_f32_16x16x32_bf16 v[128:131], v[96:99], v[192:195], v[128:131]
    v_mfma_f32_16x16x32_bf16 v[132:135], v[100:103], v[192:195], v[132:135]
    v_mfma_f32_16x16x32_bf16 v[132:135], v[96:99], v[196:199], v[132:135]
    s_waitcnt lgkmcnt(14)
    ds_read2_b32 v[64:65], v60 offset0:128 offset1:129
    s_waitcnt lgkmcnt(14)
    ds_read2_b32 v[66:67], v60 offset0:130 offset1:131
    v_mfma_f32_16x16x32_bf16 v[136:139], v[100:103], v[196:199], v[136:139]
    v_mfma_f32_16x16x32_bf16 v[136:139], v[104:107], v[192:195], v[136:139]
    s_waitcnt lgkmcnt(14)
    ds_read_b128 v[160:163], v59 offset:0
    v_mfma_f32_16x16x32_bf16 v[140:143], v[104:107], v[196:199], v[140:143]
    v_mfma_f32_16x16x32_bf16 v[136:139], v[96:99], v[200:203], v[136:139]
    s_waitcnt lgkmcnt(14)
    ds_read2_b32 v[68:69], v60 offset0:0 offset1:1
    s_waitcnt lgkmcnt(14)
    ds_read2_b32 v[70:71], v60 offset0:2 offset1:3
    v_mfma_f32_16x16x32_bf16 v[140:143], v[100:103], v[200:203], v[140:143]
    v_mfma_f32_16x16x32_bf16 v[144:147], v[104:107], v[200:203], v[144:147]
    s_waitcnt lgkmcnt(14)
    ds_read_b128 v[164:167], v59 offset:512
    v_mfma_f32_16x16x32_bf16 v[140:143], v[108:111], v[192:195], v[140:143]
    v_mfma_f32_16x16x32_bf16 v[144:147], v[108:111], v[196:199], v[144:147]
    s_waitcnt lgkmcnt(14)
    ds_read2_b32 v[72:73], v61 offset0:128 offset1:129
    s_waitcnt lgkmcnt(14)
    ds_read2_b32 v[74:75], v61 offset0:130 offset1:131
    v_mfma_f32_16x16x32_bf16 v[148:151], v[108:111], v[200:203], v[148:151]
    v_mfma_f32_16x16x32_bf16 v[140:143], v[96:99], v[204:207], v[140:143]
    s_waitcnt lgkmcnt(14)
    ds_read_b128 v[168:171], v59 offset:1024
    v_mfma_f32_16x16x32_bf16 v[144:147], v[100:103], v[204:207], v[144:147]
    v_mfma_f32_16x16x32_bf16 v[148:151], v[104:107], v[204:207], v[148:151]
    s_waitcnt lgkmcnt(14)
    ds_read2_b32 v[76:77], v61 offset0:0 offset1:1
    s_waitcnt lgkmcnt(14)
    ds_read2_b32 v[78:79], v61 offset0:2 offset1:3
    v_mfma_f32_16x16x32_bf16 v[152:155], v[108:111], v[204:207], v[152:155]
    v_mfma_f32_16x16x32_bf16 v[144:147], v[112:115], v[192:195], v[144:147]
    s_waitcnt lgkmcnt(14)
    ds_read_b128 v[172:175], v59 offset:1536
    v_mfma_f32_16x16x32_bf16 v[148:151], v[112:115], v[196:199], v[148:151]
    v_mfma_f32_16x16x32_bf16 v[152:155], v[112:115], v[200:203], v[152:155]
    s_waitcnt lgkmcnt(14)
    ds_read2_b32 v[80:81], v62 offset0:128 offset1:129
    s_waitcnt lgkmcnt(14)
    ds_read2_b32 v[82:83], v62 offset0:130 offset1:131
    v_mfma_f32_16x16x32_bf16 v[156:159], v[112:115], v[204:207], v[156:159]
    v_mfma_f32_16x16x32_bf16 v[144:147], v[96:99], v[208:211], v[144:147]
    s_waitcnt lgkmcnt(14)
    ds_read_b128 v[176:179], v59 offset:2048
    v_mfma_f32_16x16x32_bf16 v[148:151], v[100:103], v[208:211], v[148:151]
    v_mfma_f32_16x16x32_bf16 v[152:155], v[104:107], v[208:211], v[152:155]
    s_waitcnt lgkmcnt(14)
    ds_read2_b32 v[84:85], v62 offset0:0 offset1:1
    s_waitcnt lgkmcnt(14)
    ds_read2_b32 v[86:87], v62 offset0:2 offset1:3
    v_mfma_f32_16x16x32_bf16 v[156:159], v[108:111], v[208:211], v[156:159]
    v_mfma_f32_16x16x32_bf16 v[148:151], v[116:119], v[192:195], v[148:151]
    s_waitcnt lgkmcnt(14)
    ds_read_b128 v[180:183], v59 offset:2560
    v_mfma_f32_16x16x32_bf16 v[152:155], v[116:119], v[196:199], v[152:155]
    v_mfma_f32_16x16x32_bf16 v[156:159], v[116:119], v[200:203], v[156:159]
    s_waitcnt lgkmcnt(14)
    ds_read2_b32 v[88:89], v63 offset0:128 offset1:129
    s_waitcnt lgkmcnt(14)
    ds_read2_b32 v[90:91], v63 offset0:130 offset1:131
    v_mfma_f32_16x16x32_bf16 v[148:151], v[96:99], v[212:215], v[148:151]
    v_mfma_f32_16x16x32_bf16 v[152:155], v[100:103], v[212:215], v[152:155]
    s_waitcnt lgkmcnt(14)
    ds_read_b128 v[184:187], v59 offset:3072
    v_mfma_f32_16x16x32_bf16 v[156:159], v[104:107], v[212:215], v[156:159]
    v_mfma_f32_16x16x32_bf16 v[152:155], v[120:123], v[192:195], v[152:155]
    s_waitcnt lgkmcnt(14)
    ds_read2_b32 v[92:93], v63 offset0:0 offset1:1
    s_waitcnt lgkmcnt(14)
    ds_read2_b32 v[94:95], v63 offset0:2 offset1:3
    v_mfma_f32_16x16x32_bf16 v[156:159], v[120:123], v[196:199], v[156:159]
    v_mfma_f32_16x16x32_bf16 v[152:155], v[96:99], v[216:219], v[152:155]
    s_waitcnt lgkmcnt(14)
    ds_read_b128 v[188:191], v59 offset:3584
    v_mfma_f32_16x16x32_bf16 v[156:159], v[100:103], v[216:219], v[156:159]
    v_subrev_u32 v60, 64, v60
    v_subrev_u32 v61, 64, v61
    v_subrev_u32 v62, 64, v62
    v_subrev_u32 v63, 64, v63
    v_subrev_u32 v59, 64, v59
    v_mfma_f32_16x16x32_bf16 v[156:159], v[124:127], v[192:195], v[156:159]
    v_mfma_f32_16x16x32_bf16 v[156:159], v[96:99], v[220:223], v[156:159]
    s_sub_u32 s25, s25, 1
    s_cmp_lg_u32 s25, 0
    s_cbranch_scc1 L_CONV2
L_CONVE:
    s_cmp_eq_u32 s27, 0
    s_cbranch_scc1 L_F2OK
    s_waitcnt vmcnt(0)
    s_mov_b32 s34, 0
    v_mov_b32 v12, s54
    v_mov_b32 v13, s54
    v_mov_b32 v14, 1
    s_mov_b64 exec, 1
    s_cmp_eq_u32 s27, 2
    s_cbranch_scc1 PF224
    ds_add_u32 v15, v14 offset:44
    s_cmp_eq_u32 s34, 0
    s_cbranch_scc1 PH223
    buffer_store_dword v12, off, s[16:19], s26 sc1
    s_mov_b64 exec, -1
    s_waitcnt lgkmcnt(0)
    s_mov_b32 s27, 2
PH223:
PF224:
    buffer_store_dwordx2 v[12:13], off, s[16:19], s26 sc1
    s_mov_b64 exec, -1
    s_waitcnt lgkmcnt(0)
    s_mov_b32 s27, 0
    s_mov_b32 s4, s40
    s_and_b32 s5, s41, 0xffff
    s_mov_b32 s6, 2621440
    s_mov_b32 s7, 0x00020000
    v_and_b32 v1, 15, v0
    v_lshrrev_b32 v2, 4, v0
    v_mul_u32_u24 v3, 1280, v1
    v_lshl_add_u32 v3, v2, 3, v3
    s_lshl_b32 s77, s72, 2
    s_add_u32 s77, s77, s3
    s_mul_i32 s78, s77, 20480
    s_mul_i32 s79, s73, 160
    s_add_u32 s78, s78, s79
    s_and_b32 s80, s73, 1
    s_cselect_b32 s81, 0, 128
    s_lshl_b32 s80, s80, 5
    s_add_u32 s82, s78, s81
    s_add_u32 s78, s78, s80
    v_lshl_add_u32 v4, v2, 3, v3
    buffer_load_dwordx4 v[224:227], v4, s[4:7], s78 offen offset:0
    buffer_load_dwordx4 v[228:231], v4, s[4:7], s78 offen offset:64
    buffer_load_dwordx2 v[232:233], v3, s[4:7], s82 offen
    s_add_u32 s80, s80, s79
    s_add_u32 s81, s81, s79
    v_lshlrev_b32 v3, 4, v2
    v_add_u32 v3, s80, v3
    v_lshlrev_b32 v4, 3, v2
    v_add_u32 v4, s81, v4
    global_load_dwordx4 v[234:237], v3, s[52:53] offset:0
    global_load_dwordx4 v[238:241], v3, s[52:53] offset:64
    global_load_dwordx2 v[242:243], v4, s[52:53]
    v_lshlrev_b32 v3, 4, v1
    s_lshl_b32 s78, s77, 8
    s_add_u32 s78, s78, 16777216
    buffer_load_dwordx4 v[244:247], v3, s[16:19], s78 offen sc1
L_F2OK:
    s_lshl_b32 s80, s14, 12
    s_add_u32 s80, s80, 13631488
    s_lshl_b32 s81, s74, 7
    s_add_u32 s81, s81, 17039360
    s_cmp_lg_u32 s9, 2
    s_cbranch_scc1 L_CPAIR
    s_nop 7
    v_cvt_pk_bf16_f32 v128, v128, v129
    v_cvt_pk_bf16_f32 v129, v130, v131
    buffer_store_dwordx2 v[128:129], v57, s[16:19], s80 offen offset:0 sc1
    v_cvt_pk_bf16_f32 v132, v132, v133
    v_cvt_pk_bf16_f32 v133, v134, v135
    buffer_store_dwordx2 v[132:133], v57, s[16:19], s80 offen offset:512 sc1
    v_cvt_pk_bf16_f32 v136, v136, v137
    v_cvt_pk_bf16_f32 v137, v138, v139
    buffer_store_dwordx2 v[136:137], v57, s[16:19], s80 offen offset:1024 sc1
    v_cvt_pk_bf16_f32 v140, v140, v141
    v_cvt_pk_bf16_f32 v141, v142, v143
    buffer_store_dwordx2 v[140:141], v57, s[16:19], s80 offen offset:1536 sc1
    v_cvt_pk_bf16_f32 v144, v144, v145
    v_cvt_pk_bf16_f32 v145, v146, v147
    buffer_store_dwordx2 v[144:145], v57, s[16:19], s80 offen offset:2048 sc1
    v_cvt_pk_bf16_f32 v148, v148, v149
    v_cvt_pk_bf16_f32 v149, v150, v151
    buffer_store_dwordx2 v[148:149], v57, s[16:19], s80 offen offset:2560 sc1
    v_cvt_pk_bf16_f32 v152, v152, v153
    v_cvt_pk_bf16_f32 v153, v154, v155
    buffer_store_dwordx2 v[152:153], v57, s[16:19], s80 offen offset:3072 sc1
    v_cvt_pk_bf16_f32 v156, v156, v157
    v_cvt_pk_bf16_f32 v157, v158, v159
    buffer_store_dwordx2 v[156:157], v57, s[16:19], s80 offen offset:3584 sc1
    s_waitcnt lgkmcnt(0)
    v_mov_b32 v1, 161280
    v_mov_b32 v3, 1
    s_mov_b64 exec, 1
    ds_add_u32 v1, v3 offset:112
    s_mov_b64 exec, -1
    s_add_u32 s14, s75, s29
    s_add_u32 s14, s14, 4
    s_mul_i32 s15, s29, 22528
    s_add_u32 s15, s15, 114688
    s_mov_b32 s9, 1
    s_branch L_CONVR
L_CPAIR:
    s_lshl_b32 s24, s28, 12
    s_add_u32 s24, s24, s15
    s_add_u32 s24, s24, 4608
    v_lshlrev_b32 v1, 4, v0
    v_add_u32 v2, s24, v1
    s_xor_b32 s24, s28, 1
    s_lshl_b32 s24, s24, 12
    s_add_u32 s24, s24, s15
    s_add_u32 s24, s24, 4608
    v_add_u32 v4, s24, v1
    s_cmp_eq_u32 s28, 1
    s_cbranch_scc1 L_CP1
    s_waitcnt lgkmcnt(14)
    ds_write_b128 v2, v[144:147] offset:0
    s_waitcnt lgkmcnt(14)
    ds_write_b128 v2, v[148:151] offset:1024
    s_waitcnt lgkmcnt(14)
    ds_write_b128 v2, v[152:155] offset:2048
    s_waitcnt lgkmcnt(14)
    ds_write_b128 v2, v[156:159] offset:3072
    s_waitcnt lgkmcnt(0)
    v_mov_b32 v6, s8
    v_mov_b32 v7, 1
    s_mov_b64 exec, 1
    ds_add_u32 v6, v7 offset:80
    s_mov_b64 exec, -1
    s_mov_b32 s83, 200000
SPL225:
    ds_read_b32 v64, v5 offset:80
    s_waitcnt lgkmcnt(0)
    s_nop 0
    v_readfirstlane_b32 s82, v64
    s_sub_u32 s83, s83, 1
    s_cselect_b32 s82, -1, s82
    s_cmp_ge_u32 s82, 2
    s_cbranch_scc1 SPD226
    s_branch SPL225
SPD226:
    ds_read_b128 v[64:67], v4 offset:0
    ds_read_b128 v[68:71], v4 offset:1024
    ds_read_b128 v[72:75], v4 offset:2048
    ds_read_b128 v[76:79], v4 offset:3072
    s_waitcnt lgkmcnt(3)
    v_add_f32 v128, v128, v64
    v_add_f32 v129, v129, v65
    v_add_f32 v130, v130, v66
    v_add_f32 v131, v131, v67
    v_cvt_pk_bf16_f32 v128, v128, v129
    v_cvt_pk_bf16_f32 v129, v130, v131
    buffer_store_dwordx2 v[128:129], v57, s[16:19], s80 offen offset:0 sc1
    s_waitcnt lgkmcnt(2)
    v_add_f32 v132, v132, v68
    v_add_f32 v133, v133, v69
    v_add_f32 v134, v134, v70
    v_add_f32 v135, v135, v71
    v_cvt_pk_bf16_f32 v132, v132, v133
    v_cvt_pk_bf16_f32 v133, v134, v135
    buffer_store_dwordx2 v[132:133], v57, s[16:19], s80 offen offset:512 sc1
    s_waitcnt lgkmcnt(1)
    v_add_f32 v136, v136, v72
    v_add_f32 v137, v137, v73
    v_add_f32 v138, v138, v74
    v_add_f32 v139, v139, v75
    v_cvt_pk_bf16_f32 v136, v136, v137
    v_cvt_pk_bf16_f32 v137, v138, v139
    buffer_store_dwordx2 v[136:137], v57, s[16:19], s80 offen offset:1024 sc1
    s_waitcnt lgkmcnt(0)
    v_add_f32 v140, v140, v76
    v_add_f32 v141, v141, v77
    v_add_f32 v142, v142, v78
    v_add_f32 v143, v143, v79
    v_cvt_pk_bf16_f32 v140, v140, v141
    v_cvt_pk_bf16_f32 v141, v142, v143
    buffer_store_dwordx2 v[140:141], v57, s[16:19], s80 offen offset:1536 sc1
    s_branch L_CRND
L_CP1:
    s_waitcnt lgkmcnt(14)
    ds_write_b128 v2, v[128:131] offset:0
    s_waitcnt lgkmcnt(14)
    ds_write_b128 v2, v[132:135] offset:1024
    s_waitcnt lgkmcnt(14)
    ds_write_b128 v2, v[136:139] offset:2048
    s_waitcnt lgkmcnt(14)
    ds_write_b128 v2, v[140:143] offset:3072
    s_waitcnt lgkmcnt(0)
    v_mov_b32 v6, s8
    v_mov_b32 v7, 1
    s_mov_b64 exec, 1
    ds_add_u32 v6, v7 offset:80
    s_mov_b64 exec, -1
    s_mov_b32 s83, 200000
SPL227:
    ds_read_b32 v64, v5 offset:80
    s_waitcnt lgkmcnt(0)
    s_nop 0
    v_readfirstlane_b32 s82, v64
    s_sub_u32 s83, s83, 1
    s_cselect_b32 s82, -1, s82
    s_cmp_ge_u32 s82, 2
    s_cbranch_scc1 SPD228
    s_branch SPL227
SPD228:
    ds_read_b128 v[64:67], v4 offset:0
    ds_read_b128 v[68:71], v4 offset:1024
    ds_read_b128 v[72:75], v4 offset:2048
    ds_read_b128 v[76:79], v4 offset:3072
    s_waitcnt lgkmcnt(3)
    v_add_f32 v144, v144, v64
    v_add_f32 v145, v145, v65
    v_add_f32 v146, v146, v66
    v_add_f32 v147, v147, v67
    v_cvt_pk_bf16_f32 v144, v144, v145
    v_cvt_pk_bf16_f32 v145, v146, v147
    buffer_store_dwordx2 v[144:145], v57, s[16:19], s80 offen offset:2048 sc1
    s_waitcnt lgkmcnt(2)
    v_add_f32 v148, v148, v68
    v_add_f32 v149, v149, v69
    v_add_f32 v150, v150, v70
    v_add_f32 v151, v151, v71
    v_cvt_pk_bf16_f32 v148, v148, v149
    v_cvt_pk_bf16_f32 v149, v150, v151
    buffer_store_dwordx2 v[148:149], v57, s[16:19], s80 offen offset:2560 sc1
    s_waitcnt lgkmcnt(1)
    v_add_f32 v152, v152, v72
    v_add_f32 v153, v153, v73
    v_add_f32 v154, v154, v74
    v_add_f32 v155, v155, v75
    v_cvt_pk_bf16_f32 v152, v152, v153
    v_cvt_pk_bf16_f32 v153, v154, v155
    buffer_store_dwordx2 v[152:153], v57, s[16:19], s80 offen offset:3072 sc1
    s_waitcnt lgkmcnt(0)
    v_add_f32 v156, v156, v76
    v_add_f32 v157, v157, v77
    v_add_f32 v158, v158, v78
    v_add_f32 v159, v159, v79
    v_cvt_pk_bf16_f32 v156, v156, v157
    v_cvt_pk_bf16_f32 v157, v158, v159
    buffer_store_dwordx2 v[156:157], v57, s[16:19], s80 offen offset:3584 sc1
L_CRND:
L_CFIN:
    v_mov_b32 v3, 1
    s_waitcnt vmcnt(0)
    s_mov_b64 exec, 1
    ds_add_rtn_u32 v2, v15, v3 offset:48
    v_mov_b32 v1, 0
    v_mov_b32 v3, s54
    s_waitcnt lgkmcnt(0)
    v_readfirstlane_b32 s77, v2
    s_add_u32 s77, s77, 1
    s_cmp_lg_u32 s77, s76
    s_cbranch_scc1 L_NOF3
    buffer_store_dword v3, v1, s[16:19], s81 offen sc1
L_NOF3:
    s_mov_b64 exec, -1
    s_lshl_b32 s77, s72, 2
    s_add_u32 s77, s77, s3
    s_mov_b32 s10, 0xffff0000
    s_waitcnt vmcnt(0)
    v_cmp_ne_u32 vcc, s54, v246
    s_cbranch_vccz L_T3OK
    s_mov_b32 s4, s40
    s_and_b32 s5, s41, 0xffff
    s_mov_b32 s6, 2621440
    s_mov_b32 s7, 0x00020000
    v_and_b32 v1, 15, v0
    v_lshrrev_b32 v2, 4, v0
    v_mul_u32_u24 v3, 1280, v1
    v_lshl_add_u32 v3, v2, 3, v3
    s_lshl_b32 s77, s72, 2
    s_add_u32 s77, s77, s3
    s_mul_i32 s78, s77, 20480
    s_mul_i32 s79, s73, 160
    s_add_u32 s78, s78, s79
    s_and_b32 s80, s73, 1
    s_cselect_b32 s81, 0, 128
    s_lshl_b32 s80, s80, 5
    s_add_u32 s82, s78, s81
    s_add_u32 s78, s78, s80
    v_lshl_add_u32 v4, v2, 3, v3
    buffer_load_dwordx4 v[224:227], v4, s[4:7], s78 offen offset:0
    buffer_load_dwordx4 v[228:231], v4, s[4:7], s78 offen offset:64
    buffer_load_dwordx2 v[232:233], v3, s[4:7], s82 offen
    s_add_u32 s80, s80, s79
    s_add_u32 s81, s81, s79
    v_lshlrev_b32 v3, 4, v2
    v_add_u32 v3, s80, v3
    v_lshlrev_b32 v4, 3, v2
    v_add_u32 v4, s81, v4
    global_load_dwordx4 v[234:237], v3, s[52:53] offset:0
    global_load_dwordx4 v[238:241], v3, s[52:53] offset:64
    global_load_dwordx2 v[242:243], v4, s[52:53]
    v_lshlrev_b32 v3, 4, v1
    s_lshl_b32 s78, s77, 8
    s_add_u32 s78, s78, 16777216
    buffer_load_dwordx4 v[244:247], v3, s[16:19], s78 offen sc1
    s_waitcnt vmcnt(0)
L_T3OK:
    v_mov_b32 v110, v245
    v_mov_b32 v111, v245
    v_mov_b32 v85, v244
    v_mov_b32 v84, v244
    v_lshlrev_b32 v112, 16, v224
    v_and_b32 v113, s10, v224
    v_lshlrev_b32 v116, 16, v234
    v_and_b32 v117, s10, v234
    v_lshlrev_b32 v114, 16, v225
    v_and_b32 v115, s10, v225
    v_lshlrev_b32 v118, 16, v235
    v_and_b32 v119, s10, v235
    v_sub_f32 v120, v112, v84
    v_sub_f32 v121, v113, v84
    v_sub_f32 v122, v114, v84
    v_sub_f32 v123, v115, v84
    v_cvt_pk_bf16_f32 v120, 0, v120
    v_cvt_pk_bf16_f32 v121, 0, v121
    v_cvt_pk_bf16_f32 v122, 0, v122
    v_cvt_pk_bf16_f32 v123, 0, v123
    v_mul_f32 v120, v120, v110
    v_mul_f32 v121, v121, v110
    v_mul_f32 v122, v122, v110
    v_mul_f32 v123, v123, v110
    v_cvt_pk_bf16_f32 v120, 0, v120
    v_cvt_pk_bf16_f32 v121, 0, v121
    v_cvt_pk_bf16_f32 v122, 0, v122
    v_cvt_pk_bf16_f32 v123, 0, v123
    v_mul_f32 v120, v120, v116
    v_mul_f32 v121, v121, v117
    v_mul_f32 v122, v122, v118
    v_mul_f32 v123, v123, v119
    v_cvt_pk_bf16_f32 v120, 0, v120
    v_cvt_pk_bf16_f32 v121, 0, v121
    v_cvt_pk_bf16_f32 v122, 0, v122
    v_cvt_pk_bf16_f32 v123, 0, v123
    v_lshlrev_b32 v128, 16, v226
    v_and_b32 v129, s10, v226
    v_lshlrev_b32 v132, 16, v236
    v_and_b32 v133, s10, v236
    v_lshlrev_b32 v130, 16, v227
    v_and_b32 v131, s10, v227
    v_lshlrev_b32 v134, 16, v237
    v_and_b32 v135, s10, v237
    v_sub_f32 v136, v128, v84
    v_sub_f32 v137, v129, v84
    v_sub_f32 v138, v130, v84
    v_sub_f32 v139, v131, v84
    v_cvt_pk_bf16_f32 v136, 0, v136
    v_cvt_pk_bf16_f32 v137, 0, v137
    v_cvt_pk_bf16_f32 v138, 0, v138
    v_cvt_pk_bf16_f32 v139, 0, v139
    v_mul_f32 v136, v136, v110
    v_mul_f32 v137, v137, v110
    v_mul_f32 v138, v138, v110
    v_mul_f32 v139, v139, v110
    v_cvt_pk_bf16_f32 v136, 0, v136
    v_cvt_pk_bf16_f32 v137, 0, v137
    v_cvt_pk_bf16_f32 v138, 0, v138
    v_cvt_pk_bf16_f32 v139, 0, v139
    v_mul_f32 v136, v136, v132
    v_mul_f32 v137, v137, v133
    v_mul_f32 v138, v138, v134
    v_mul_f32 v139, v139, v135
    v_cvt_pk_bf16_f32 v136, 0, v136
    v_cvt_pk_bf16_f32 v137, 0, v137
    v_cvt_pk_bf16_f32 v138, 0, v138
    v_cvt_pk_bf16_f32 v139, 0, v139
    v_lshlrev_b32 v144, 16, v228
    v_and_b32 v145, s10, v228
    v_lshlrev_b32 v148, 16, v238
    v_and_b32 v149, s10, v238
    v_lshlrev_b32 v146, 16, v229
    v_and_b32 v147, s10, v229
    v_lshlrev_b32 v150, 16, v239
    v_and_b32 v151, s10, v239
    v_sub_f32 v152, v144, v84
    v_sub_f32 v153, v145, v84
    v_sub_f32 v154, v146, v84
    v_sub_f32 v155, v147, v84
    v_cvt_pk_bf16_f32 v152, 0, v152
    v_cvt_pk_bf16_f32 v153, 0, v153
    v_cvt_pk_bf16_f32 v154, 0, v154
    v_cvt_pk_bf16_f32 v155, 0, v155
    v_mul_f32 v152, v152, v110
    v_mul_f32 v153, v153, v110
    v_mul_f32 v154, v154, v110
    v_mul_f32 v155, v155, v110
    v_cvt_pk_bf16_f32 v152, 0, v152
    v_cvt_pk_bf16_f32 v153, 0, v153
    v_cvt_pk_bf16_f32 v154, 0, v154
    v_cvt_pk_bf16_f32 v155, 0, v155
    v_mul_f32 v152, v152, v148
    v_mul_f32 v153, v153, v149
    v_mul_f32 v154, v154, v150
    v_mul_f32 v155, v155, v151
    v_cvt_pk_bf16_f32 v152, 0, v152
    v_cvt_pk_bf16_f32 v153, 0, v153
    v_cvt_pk_bf16_f32 v154, 0, v154
    v_cvt_pk_bf16_f32 v155, 0, v155
    v_lshlrev_b32 v160, 16, v230
    v_and_b32 v161, s10, v230
    v_lshlrev_b32 v164, 16, v240
    v_and_b32 v165, s10, v240
    v_lshlrev_b32 v162, 16, v231
    v_and_b32 v163, s10, v231
    v_lshlrev_b32 v166, 16, v241
    v_and_b32 v167, s10, v241
    v_sub_f32 v168, v160, v84
    v_sub_f32 v169, v161, v84
    v_sub_f32 v170, v162, v84
    v_sub_f32 v171, v163, v84
    v_cvt_pk_bf16_f32 v168, 0, v168
    v_cvt_pk_bf16_f32 v169, 0, v169
    v_cvt_pk_bf16_f32 v170, 0, v170
    v_cvt_pk_bf16_f32 v171, 0, v171
    v_mul_f32 v168, v168, v110
    v_mul_f32 v169, v169, v110
    v_mul_f32 v170, v170, v110
    v_mul_f32 v171, v171, v110
    v_cvt_pk_bf16_f32 v168, 0, v168
    v_cvt_pk_bf16_f32 v169, 0, v169
    v_cvt_pk_bf16_f32 v170, 0, v170
    v_cvt_pk_bf16_f32 v171, 0, v171
    v_mul_f32 v168, v168, v164
    v_mul_f32 v169, v169, v165
    v_mul_f32 v170, v170, v166
    v_mul_f32 v171, v171, v167
    v_cvt_pk_bf16_f32 v168, 0, v168
    v_cvt_pk_bf16_f32 v169, 0, v169
    v_cvt_pk_bf16_f32 v170, 0, v170
    v_cvt_pk_bf16_f32 v171, 0, v171
    v_lshlrev_b32 v176, 16, v232
    v_and_b32 v177, s10, v232
    v_lshlrev_b32 v180, 16, v242
    v_and_b32 v181, s10, v242
    v_lshlrev_b32 v178, 16, v233
    v_and_b32 v179, s10, v233
    v_lshlrev_b32 v182, 16, v243
    v_and_b32 v183, s10, v243
    v_sub_f32 v184, v176, v84
    v_sub_f32 v185, v177, v84
    v_sub_f32 v186, v178, v84
    v_sub_f32 v187, v179, v84
    v_cvt_pk_bf16_f32 v184, 0, v184
    v_cvt_pk_bf16_f32 v185, 0, v185
    v_cvt_pk_bf16_f32 v186, 0, v186
    v_cvt_pk_bf16_f32 v187, 0, v187
    v_mul_f32 v184, v184, v110
    v_mul_f32 v185, v185, v110
    v_mul_f32 v186, v186, v110
    v_mul_f32 v187, v187, v110
    v_cvt_pk_bf16_f32 v184, 0, v184
    v_cvt_pk_bf16_f32 v185, 0, v185
    v_cvt_pk_bf16_f32 v186, 0, v186
    v_cvt_pk_bf16_f32 v187, 0, v187
    v_mul_f32 v184, v184, v180
    v_mul_f32 v185, v185, v181
    v_mul_f32 v186, v186, v182
    v_mul_f32 v187, v187, v183
    v_cvt_pk_bf16_f32 v184, 0, v184
    v_cvt_pk_bf16_f32 v185, 0, v185
    v_cvt_pk_bf16_f32 v186, 0, v186
    v_cvt_pk_bf16_f32 v187, 0, v187
    v_and_b32 v3, 31, v0
    v_lshlrev_b32 v3, 7, v3
    s_lshl_b32 s78, s73, 12
    s_add_u32 s12, s78, 17039360
    v_lshrrev_b32 v4, 3, v0
    v_and_b32 v5, 7, v0
    v_lshlrev_b32 v5, 4, v5
    v_lshl_add_u32 v7, v4, 12, v5
    s_mul_i32 s79, s3, 2880
    s_add_u32 s79, s79, 124928
    v_mul_u32_u24 v8, 144, v4
    v_add3_u32 v8, v8, v5, s79
    s_and_b32 s78, s73, 1
    s_cselect_b32 s80, 0, 9216
    s_mul_i32 s78, s78, 2304
    s_lshl_b32 s79, s3, 5
    s_add_u32 s79, s79, 124928
    s_add_u32 s78, s78, s79
    s_add_u32 s80, s80, s79
    v_lshrrev_b32 v4, 2, v0
    v_mul_u32_u24 v4, 144, v4
    v_and_b32 v5, 3, v0
    v_lshl_add_u32 v4, v5, 3, v4
    v_lshrrev_b32 v6, 4, v0
    v_mul_u32_u24 v6, 576, v6
    v_add3_u32 v6, v6, v4, s78
    v_add_u32 v4, s80, v4
    s_mul_i32 s78, s3, 2560
    s_add_u32 s78, s78, 114688
    v_lshlrev_b32 v5, 3, v0
    v_add_u32 v5, s78, v5
    s_mul_i32 s78, s73, 80
    s_mul_i32 s79, s3, 20
    s_add_u32 s78, s78, s79
    s_lshl_b32 s78, s78, 12
    s_lshl_b32 s79, s72, 7
    s_add_u32 s78, s78, s79
    s_add_u32 s78, s78, 13631488
    s_add_u32 s79, s78, 32768
    s_add_u32 s80, s78, 65536
    v_mov_b32 v9, 1
    s_mov_b32 s83, 200000
SPL229:
    ds_read_b32 v60, v15 offset:48
    s_waitcnt lgkmcnt(0)
    s_nop 0
    v_readfirstlane_b32 s82, v60
    s_sub_u32 s83, s83, 1
    s_cselect_b32 s82, -1, s82
    s_cmp_ge_u32 s82, s76
    s_cbranch_scc1 SPD230
    s_sleep 4
    s_branch SPL229
SPD230:
    s_cmp_lg_u32 s3, 0
    s_cbranch_scc1 L_F3W
    s_mov_b32 s83, 200000
SPL231:
    ds_read_b32 v60, v15 offset:24
    s_waitcnt lgkmcnt(0)
    s_nop 0
    v_readfirstlane_b32 s82, v60
    s_sub_u32 s83, s83, 1
    s_cselect_b32 s82, -1, s82
    s_cmp_ge_u32 s82, 4
    s_cbranch_scc1 SPD232
    s_sleep 2
    s_branch SPL231
SPD232:
    s_mov_b32 s83, 12500
SPG233:
    buffer_load_dword v86, v3, s[16:19], s12 offen sc1
    s_waitcnt vmcnt(0)
    v_cmp_ne_u32 vcc, s54, v86
    s_sub_u32 s83, s83, 1
    s_cbranch_scc1 SPE234
    s_cmp_eq_u64 vcc, 0
    s_cbranch_scc1 SPE234
    s_sleep 4
    s_branch SPG233
SPE234:
    v_mov_b32 v86, 100
    ds_write_b32 v15, v86 offset:44
    s_branch L_F3X
L_F3W:
    s_mov_b32 s83, 200000
SPL235:
    ds_read_b32 v60, v15 offset:44
    s_waitcnt lgkmcnt(0)
    s_nop 0
    v_readfirstlane_b32 s82, v60
    s_sub_u32 s83, s83, 1
    s_cselect_b32 s82, -1, s82
    s_cmp_ge_u32 s82, 100
    s_cbranch_scc1 SPD236
    s_sleep 1
    s_branch SPL235
SPD236:
L_F3X:
    s_mov_b32 s83, 200000
SPL237:
    ds_read_b32 v60, v15 offset:28
    s_waitcnt lgkmcnt(0)
    s_nop 0
    v_readfirstlane_b32 s82, v60
    s_sub_u32 s83, s83, 1
    s_cselect_b32 s82, -1, s82
    s_cmp_ge_u32 s82, 4
    s_cbranch_scc1 SPD238
    s_sleep 2
    s_branch SPL237
SPD238:
    buffer_load_dwordx4 v[88:91], v7, s[16:19], s78 offen sc1
    buffer_load_dwordx4 v[92:95], v7, s[16:19], s79 offen sc1
    s_mov_b32 exec_hi, 0
    buffer_load_dwordx4 v[96:99], v7, s[16:19], s80 offen sc1
    s_mov_b64 exec, -1
    s_waitcnt vmcnt(2)
    ds_write_b128 v8, v[88:91] offset:0
    s_waitcnt vmcnt(1)
    ds_write_b128 v8, v[92:95] offset:1152
    s_waitcnt vmcnt(0)
    s_mov_b32 exec_hi, 0
    ds_write_b128 v8, v[96:99] offset:2304
    s_mov_b64 exec, 1
    ds_add_u32 v15, v9 offset:48
    s_mov_b64 exec, -1
    s_mov_b32 s83, 200000
SPL239:
    ds_read_b32 v60, v15 offset:48
    s_waitcnt lgkmcnt(0)
    s_nop 0
    v_readfirstlane_b32 s82, v60
    s_sub_u32 s83, s83, 1
    s_cselect_b32 s82, -1, s82
    s_cmp_ge_u32 s82, 8
    s_cbranch_scc1 SPD240
    s_branch SPL239
SPD240:
    ds_read_b64_tr_b16 v[100:101], v6 offset:0
    ds_read_b64_tr_b16 v[102:103], v6 offset:576
    ds_read_b64_tr_b16 v[104:105], v6 offset:4608
    ds_read_b64_tr_b16 v[106:107], v6 offset:5184
    ds_read_b64_tr_b16 v[108:109], v4
    s_waitcnt lgkmcnt(4)
    v_lshlrev_b32 v116, 16, v100
    v_and_b32 v117, s10, v100
    v_lshlrev_b32 v118, 16, v101
    v_and_b32 v119, s10, v101
    v_add_f32 v120, v120, v116
    v_add_f32 v121, v121, v117
    v_add_f32 v122, v122, v118
    v_add_f32 v123, v123, v119
    v_cvt_pk_bf16_f32 v120, 0, v120
    v_cvt_pk_bf16_f32 v121, 0, v121
    v_cvt_pk_bf16_f32 v122, 0, v122
    v_cvt_pk_bf16_f32 v123, 0, v123
    v_add_f32 v120, v120, v112
    v_add_f32 v121, v121, v113
    v_add_f32 v122, v122, v114
    v_add_f32 v123, v123, v115
    v_cvt_pk_bf16_f32 v124, v120, v121
    v_cvt_pk_bf16_f32 v125, v122, v123
    ds_write_b64 v5, v[124:125] offset:0
    s_waitcnt lgkmcnt(4)
    v_lshlrev_b32 v132, 16, v102
    v_and_b32 v133, s10, v102
    v_lshlrev_b32 v134, 16, v103
    v_and_b32 v135, s10, v103
    v_add_f32 v136, v136, v132
    v_add_f32 v137, v137, v133
    v_add_f32 v138, v138, v134
    v_add_f32 v139, v139, v135
    v_cvt_pk_bf16_f32 v136, 0, v136
    v_cvt_pk_bf16_f32 v137, 0, v137
    v_cvt_pk_bf16_f32 v138, 0, v138
    v_cvt_pk_bf16_f32 v139, 0, v139
    v_add_f32 v136, v136, v128
    v_add_f32 v137, v137, v129
    v_add_f32 v138, v138, v130
    v_add_f32 v139, v139, v131
    v_cvt_pk_bf16_f32 v140, v136, v137
    v_cvt_pk_bf16_f32 v141, v138, v139
    ds_write_b64 v5, v[140:141] offset:512
    s_waitcnt lgkmcnt(4)
    v_lshlrev_b32 v148, 16, v104
    v_and_b32 v149, s10, v104
    v_lshlrev_b32 v150, 16, v105
    v_and_b32 v151, s10, v105
    v_add_f32 v152, v152, v148
    v_add_f32 v153, v153, v149
    v_add_f32 v154, v154, v150
    v_add_f32 v155, v155, v151
    v_cvt_pk_bf16_f32 v152, 0, v152
    v_cvt_pk_bf16_f32 v153, 0, v153
    v_cvt_pk_bf16_f32 v154, 0, v154
    v_cvt_pk_bf16_f32 v155, 0, v155
    v_add_f32 v152, v152, v144
    v_add_f32 v153, v153, v145
    v_add_f32 v154, v154, v146
    v_add_f32 v155, v155, v147
    v_cvt_pk_bf16_f32 v156, v152, v153
    v_cvt_pk_bf16_f32 v157, v154, v155
    ds_write_b64 v5, v[156:157] offset:1024
    s_waitcnt lgkmcnt(4)
    v_lshlrev_b32 v164, 16, v106
    v_and_b32 v165, s10, v106
    v_lshlrev_b32 v166, 16, v107
    v_and_b32 v167, s10, v107
    v_add_f32 v168, v168, v164
    v_add_f32 v169, v169, v165
    v_add_f32 v170, v170, v166
    v_add_f32 v171, v171, v167
    v_cvt_pk_bf16_f32 v168, 0, v168
    v_cvt_pk_bf16_f32 v169, 0, v169
    v_cvt_pk_bf16_f32 v170, 0, v170
    v_cvt_pk_bf16_f32 v171, 0, v171
    v_add_f32 v168, v168, v160
    v_add_f32 v169, v169, v161
    v_add_f32 v170, v170, v162
    v_add_f32 v171, v171, v163
    v_cvt_pk_bf16_f32 v172, v168, v169
    v_cvt_pk_bf16_f32 v173, v170, v171
    ds_write_b64 v5, v[172:173] offset:1536
    s_waitcnt lgkmcnt(4)
    v_lshlrev_b32 v180, 16, v108
    v_and_b32 v181, s10, v108
    v_lshlrev_b32 v182, 16, v109
    v_and_b32 v183, s10, v109
    v_add_f32 v184, v184, v180
    v_add_f32 v185, v185, v181
    v_add_f32 v186, v186, v182
    v_add_f32 v187, v187, v183
    v_cvt_pk_bf16_f32 v184, 0, v184
    v_cvt_pk_bf16_f32 v185, 0, v185
    v_cvt_pk_bf16_f32 v186, 0, v186
    v_cvt_pk_bf16_f32 v187, 0, v187
    v_add_f32 v184, v184, v176
    v_add_f32 v185, v185, v177
    v_add_f32 v186, v186, v178
    v_add_f32 v187, v187, v179
    v_cvt_pk_bf16_f32 v188, v184, v185
    v_cvt_pk_bf16_f32 v189, v186, v187
    ds_write_b64 v5, v[188:189] offset:2048
    v_mov_b32 v1, 161280
    v_mov_b32 v3, 1
    s_mov_b64 exec, 1
    ds_add_u32 v1, v3 offset:92
    s_mov_b64 exec, -1
    s_waitcnt lgkmcnt(0)
L_END:
    s_endpgm
L_FWAIT:
    s_mov_b32 s83, 12500
L_FWL:
    buffer_load_dword v11, v9, s[16:19], s43 offen sc1
    s_waitcnt vmcnt(0)
    v_cmp_eq_u32 vcc, s54, v11
    s_sub_u32 s83, s83, 1
    s_cselect_b32 s48, -1, vcc_lo
    s_andn2_b32 s79, s78, s48
    s_cbranch_scc0 L_FWD
    s_sleep 6
    s_branch L_FWL
L_FWD:
    s_setpc_b64 s[52:53]
FW54:
    s_getpc_b64 s[52:53]
FW54r:
    s_sub_u32 s52, s52, FW54r-FB55
    s_subb_u32 s53, s53, 0
    s_branch L_FWAIT
FW56:
    s_getpc_b64 s[52:53]
FW56r:
    s_sub_u32 s52, s52, FW56r-FB57
    s_subb_u32 s53, s53, 0
    s_branch L_FWAIT
FW58:
    s_getpc_b64 s[52:53]
FW58r:
    s_sub_u32 s52, s52, FW58r-FB59
    s_subb_u32 s53, s53, 0
    s_branch L_FWAIT
FW60:
    s_getpc_b64 s[52:53]
FW60r:
    s_sub_u32 s52, s52, FW60r-FB61
    s_subb_u32 s53, s53, 0
    s_branch L_FWAIT
FW62:
    s_getpc_b64 s[52:53]
FW62r:
    s_sub_u32 s52, s52, FW62r-FB63
    s_subb_u32 s53, s53, 0
    s_branch L_FWAIT
FW64:
    s_getpc_b64 s[52:53]
FW64r:
    s_sub_u32 s52, s52, FW64r-FB65
    s_subb_u32 s53, s53, 0
    s_branch L_FWAIT
FW66:
    s_getpc_b64 s[52:53]
FW66r:
    s_sub_u32 s52, s52, FW66r-FB67
    s_subb_u32 s53, s53, 0
    s_branch L_FWAIT
FW68:
    s_getpc_b64 s[52:53]
FW68r:
    s_sub_u32 s52, s52, FW68r-FB69
    s_subb_u32 s53, s53, 0
    s_branch L_FWAIT
FW70:
    s_getpc_b64 s[52:53]
FW70r:
    s_sub_u32 s52, s52, FW70r-FB71
    s_subb_u32 s53, s53, 0
    s_branch L_FWAIT
FW72:
    s_getpc_b64 s[52:53]
FW72r:
    s_sub_u32 s52, s52, FW72r-FB73
    s_subb_u32 s53, s53, 0
    s_branch L_FWAIT
FW74:
    s_getpc_b64 s[52:53]
FW74r:
    s_sub_u32 s52, s52, FW74r-FB75
    s_subb_u32 s53, s53, 0
    s_branch L_FWAIT
FW76:
    s_getpc_b64 s[52:53]
FW76r:
    s_sub_u32 s52, s52, FW76r-FB77
    s_subb_u32 s53, s53, 0
    s_branch L_FWAIT
FW78:
    s_getpc_b64 s[52:53]
FW78r:
    s_sub_u32 s52, s52, FW78r-FB79
    s_subb_u32 s53, s53, 0
    s_branch L_FWAIT
FW80:
    s_getpc_b64 s[52:53]
FW80r:
    s_sub_u32 s52, s52, FW80r-FB81
    s_subb_u32 s53, s53, 0
    s_branch L_FWAIT
FW98:
    s_getpc_b64 s[52:53]
FW98r:
    s_sub_u32 s52, s52, FW98r-FB99
    s_subb_u32 s53, s53, 0
    s_branch L_FWAIT
FW100:
    s_getpc_b64 s[52:53]
FW100r:
    s_sub_u32 s52, s52, FW100r-FB101
    s_subb_u32 s53, s53, 0
    s_branch L_FWAIT
FW102:
    s_getpc_b64 s[52:53]
FW102r:
    s_sub_u32 s52, s52, FW102r-FB103
    s_subb_u32 s53, s53, 0
    s_branch L_FWAIT
FW104:
    s_getpc_b64 s[52:53]
FW104r:
    s_sub_u32 s52, s52, FW104r-FB105
    s_subb_u32 s53, s53, 0
    s_branch L_FWAIT
FW106:
    s_getpc_b64 s[52:53]
FW106r:
    s_sub_u32 s52, s52, FW106r-FB107
    s_subb_u32 s53, s53, 0
    s_branch L_FWAIT
FW108:
    s_getpc_b64 s[52:53]
FW108r:
    s_sub_u32 s52, s52, FW108r-FB109
    s_subb_u32 s53, s53, 0
    s_branch L_FWAIT
FW110:
    s_getpc_b64 s[52:53]
FW110r:
    s_sub_u32 s52, s52, FW110r-FB111
    s_subb_u32 s53, s53, 0
    s_branch L_FWAIT
FW112:
    s_getpc_b64 s[52:53]
FW112r:
    s_sub_u32 s52, s52, FW112r-FB113
    s_subb_u32 s53, s53, 0
    s_branch L_FWAIT
FW114:
    s_getpc_b64 s[52:53]
FW114r:
    s_sub_u32 s52, s52, FW114r-FB115
    s_subb_u32 s53, s53, 0
    s_branch L_FWAIT
FW116:
    s_getpc_b64 s[52:53]
FW116r:
    s_sub_u32 s52, s52, FW116r-FB117
    s_subb_u32 s53, s53, 0
    s_branch L_FWAIT
FW118:
    s_getpc_b64 s[52:53]
FW118r:
    s_sub_u32 s52, s52, FW118r-FB119
    s_subb_u32 s53, s53, 0
    s_branch L_FWAIT
FW120:
    s_getpc_b64 s[52:53]
FW120r:
    s_sub_u32 s52, s52, FW120r-FB121
    s_subb_u32 s53, s53, 0
    s_branch L_FWAIT
FW134:
    s_getpc_b64 s[52:53]
FW134r:
    s_sub_u32 s52, s52, FW134r-FB135
    s_subb_u32 s53, s53, 0
    s_branch L_FWAIT
FW136:
    s_getpc_b64 s[52:53]
FW136r:
    s_sub_u32 s52, s52, FW136r-FB137
    s_subb_u32 s53, s53, 0
    s_branch L_FWAIT
FW138:
    s_getpc_b64 s[52:53]
FW138r:
    s_sub_u32 s52, s52, FW138r-FB139
    s_subb_u32 s53, s53, 0
    s_branch L_FWAIT
FW140:
    s_getpc_b64 s[52:53]
FW140r:
    s_sub_u32 s52, s52, FW140r-FB141
    s_subb_u32 s53, s53, 0
    s_branch L_FWAIT
FW142:
    s_getpc_b64 s[52:53]
FW142r:
    s_sub_u32 s52, s52, FW142r-FB143
    s_subb_u32 s53, s53, 0
    s_branch L_FWAIT
FW144:
    s_getpc_b64 s[52:53]
FW144r:
    s_sub_u32 s52, s52, FW144r-FB145
    s_subb_u32 s53, s53, 0
    s_branch L_FWAIT
FW146:
    s_getpc_b64 s[52:53]
FW146r:
    s_sub_u32 s52, s52, FW146r-FB147
    s_subb_u32 s53, s53, 0
    s_branch L_FWAIT
FW148:
    s_getpc_b64 s[52:53]
FW148r:
    s_sub_u32 s52, s52, FW148r-FB149
    s_subb_u32 s53, s53, 0
    s_branch L_FWAIT
FW150:
    s_getpc_b64 s[52:53]
FW150r:
    s_sub_u32 s52, s52, FW150r-FB151
    s_subb_u32 s53, s53, 0
    s_branch L_FWAIT
FW152:
    s_getpc_b64 s[52:53]
FW152r:
    s_sub_u32 s52, s52, FW152r-FB153
    s_subb_u32 s53, s53, 0
    s_branch L_FWAIT
FW154:
    s_getpc_b64 s[52:53]
FW154r:
    s_sub_u32 s52, s52, FW154r-FB155
    s_subb_u32 s53, s53, 0
    s_branch L_FWAIT
FW156:
    s_getpc_b64 s[52:53]
FW156r:
    s_sub_u32 s52, s52, FW156r-FB157
    s_subb_u32 s53, s53, 0
    s_branch L_FWAIT
FW158:
    s_getpc_b64 s[52:53]
FW158r:
    s_sub_u32 s52, s52, FW158r-FB159
    s_subb_u32 s53, s53, 0
    s_branch L_FWAIT
FW160:
    s_getpc_b64 s[52:53]
FW160r:
    s_sub_u32 s52, s52, FW160r-FB161
    s_subb_u32 s53, s53, 0
    s_branch L_FWAIT
FW174:
    s_getpc_b64 s[52:53]
FW174r:
    s_sub_u32 s52, s52, FW174r-FB175
    s_subb_u32 s53, s53, 0
    s_branch L_FWAIT
FW176:
    s_getpc_b64 s[52:53]
FW176r:
    s_sub_u32 s52, s52, FW176r-FB177
    s_subb_u32 s53, s53, 0
    s_branch L_FWAIT
FW178:
    s_getpc_b64 s[52:53]
FW178r:
    s_sub_u32 s52, s52, FW178r-FB179
    s_subb_u32 s53, s53, 0
    s_branch L_FWAIT
FW180:
    s_getpc_b64 s[52:53]
FW180r:
    s_sub_u32 s52, s52, FW180r-FB181
    s_subb_u32 s53, s53, 0
    s_branch L_FWAIT
FW182:
    s_getpc_b64 s[52:53]
FW182r:
    s_sub_u32 s52, s52, FW182r-FB183
    s_subb_u32 s53, s53, 0
    s_branch L_FWAIT
FW184:
    s_getpc_b64 s[52:53]
FW184r:
    s_sub_u32 s52, s52, FW184r-FB185
    s_subb_u32 s53, s53, 0
    s_branch L_FWAIT
FW186:
    s_getpc_b64 s[52:53]
FW186r:
    s_sub_u32 s52, s52, FW186r-FB187
    s_subb_u32 s53, s53, 0
    s_branch L_FWAIT
FW188:
    s_getpc_b64 s[52:53]
FW188r:
    s_sub_u32 s52, s52, FW188r-FB189
    s_subb_u32 s53, s53, 0
    s_branch L_FWAIT
FW190:
    s_getpc_b64 s[52:53]
FW190r:
    s_sub_u32 s52, s52, FW190r-FB191
    s_subb_u32 s53, s53, 0
    s_branch L_FWAIT
FW192:
    s_getpc_b64 s[52:53]
FW192r:
    s_sub_u32 s52, s52, FW192r-FB193
    s_subb_u32 s53, s53, 0
    s_branch L_FWAIT
FW194:
    s_getpc_b64 s[52:53]
FW194r:
    s_sub_u32 s52, s52, FW194r-FB195
    s_subb_u32 s53, s53, 0
    s_branch L_FWAIT
FW196:
    s_getpc_b64 s[52:53]
FW196r:
    s_sub_u32 s52, s52, FW196r-FB197
    s_subb_u32 s53, s53, 0
    s_branch L_FWAIT
L_XJS:
    s_mov_b32 s83, 200000
SPL241:
    ds_read_b32 v13, v8 offset:112
    s_waitcnt lgkmcnt(0)
    s_nop 0
    v_readfirstlane_b32 s82, v13
    s_sub_u32 s83, s83, 1
    s_cselect_b32 s82, -1, s82
    s_cmp_ge_u32 s82, 1
    s_cbranch_scc1 SPD242
    s_sleep 1
    s_branch SPL241
SPD242:
    s_branch L_XJB
L_F2PUB:
    v_mov_b32 v12, s54
    v_mov_b32 v13, s54
    v_mov_b32 v14, 1
    s_mov_b64 exec, 1
    s_cmp_eq_u32 s27, 2
    s_cbranch_scc1 PF244
    ds_add_u32 v15, v14 offset:44
    s_cmp_eq_u32 s34, 0
    s_cbranch_scc1 PH243
    buffer_store_dword v12, off, s[16:19], s26 sc1
    s_mov_b64 exec, -1
    s_waitcnt lgkmcnt(0)
    s_mov_b32 s27, 2
    s_setpc_b64 s[32:33]
PH243:
PF244:
    buffer_store_dwordx2 v[12:13], off, s[16:19], s26 sc1
    s_mov_b64 exec, -1
    s_waitcnt lgkmcnt(0)
    s_mov_b32 s27, 0
    s_mov_b32 s4, s40
    s_and_b32 s5, s41, 0xffff
    s_mov_b32 s6, 2621440
    s_mov_b32 s7, 0x00020000
    v_and_b32 v1, 15, v0
    v_lshrrev_b32 v2, 4, v0
    v_mul_u32_u24 v3, 1280, v1
    v_lshl_add_u32 v3, v2, 3, v3
    s_lshl_b32 s77, s72, 2
    s_add_u32 s77, s77, s3
    s_mul_i32 s78, s77, 20480
    s_mul_i32 s79, s73, 160
    s_add_u32 s78, s78, s79
    s_and_b32 s80, s73, 1
    s_cselect_b32 s81, 0, 128
    s_lshl_b32 s80, s80, 5
    s_add_u32 s82, s78, s81
    s_add_u32 s78, s78, s80
    v_lshl_add_u32 v4, v2, 3, v3
    buffer_load_dwordx4 v[224:227], v4, s[4:7], s78 offen offset:0
    buffer_load_dwordx4 v[228:231], v4, s[4:7], s78 offen offset:64
    buffer_load_dwordx2 v[232:233], v3, s[4:7], s82 offen
    s_add_u32 s80, s80, s79
    s_add_u32 s81, s81, s79
    v_lshlrev_b32 v3, 4, v2
    v_add_u32 v3, s80, v3
    v_lshlrev_b32 v4, 3, v2
    v_add_u32 v4, s81, v4
    global_load_dwordx4 v[234:237], v3, s[52:53] offset:0
    global_load_dwordx4 v[238:241], v3, s[52:53] offset:64
    global_load_dwordx2 v[242:243], v4, s[52:53]
    v_lshlrev_b32 v3, 4, v1
    s_lshl_b32 s78, s77, 8
    s_add_u32 s78, s78, 16777216
    buffer_load_dwordx4 v[244:247], v3, s[16:19], s78 offen sc1
    s_setpc_b64 s[32:33]
L_F2P0:
    s_getpc_b64 s[32:33]
L_F2Q0:
    s_sub_u32 s32, s32, L_F2Q0-L_F2B0
    s_subb_u32 s33, s33, 0
    s_branch L_F2PUB
L_F2P1:
    s_getpc_b64 s[32:33]
L_F2Q1:
    s_sub_u32 s32, s32, L_F2Q1-L_F2B1
    s_subb_u32 s33, s33, 0
    s_branch L_F2PUB
L_F2P2:
    s_getpc_b64 s[32:33]
L_F2Q2:
    s_sub_u32 s32, s32, L_F2Q2-L_F2B2
    s_subb_u32 s33, s33, 0
    s_branch L_F2PUB
L_F2P3:
    s_getpc_b64 s[32:33]
L_F2Q3:
    s_sub_u32 s32, s32, L_F2Q3-L_F2B3
    s_subb_u32 s33, s33, 0
    s_branch L_F2PUB
L_F2P4:
    s_getpc_b64 s[32:33]
L_F2Q4:
    s_sub_u32 s32, s32, L_F2Q4-L_F2B4
    s_subb_u32 s33, s33, 0
    s_branch L_F2PUB
L_F2P5:
    s_getpc_b64 s[32:33]
L_F2Q5:
    s_sub_u32 s32, s32, L_F2Q5-L_F2B5
    s_subb_u32 s33, s33, 0
    s_branch L_F2PUB
L_F2P6:
    s_getpc_b64 s[32:33]
L_F2Q6:
    s_sub_u32 s32, s32, L_F2Q6-L_F2B6
    s_subb_u32 s33, s33, 0
    s_branch L_F2PUB
L_F2P7:
    s_getpc_b64 s[32:33]
L_F2Q7:
    s_sub_u32 s32, s32, L_F2Q7-L_F2B7
    s_subb_u32 s33, s33, 0
    s_branch L_F2PUB
L_F2P8:
    s_getpc_b64 s[32:33]
L_F2Q8:
    s_sub_u32 s32, s32, L_F2Q8-L_F2B8
    s_subb_u32 s33, s33, 0
    s_branch L_F2PUB
L_F2P9:
    s_getpc_b64 s[32:33]
L_F2Q9:
    s_sub_u32 s32, s32, L_F2Q9-L_F2B9
    s_subb_u32 s33, s33, 0
    s_branch L_F2PUB
L_F2P10:
    s_getpc_b64 s[32:33]
L_F2Q10:
    s_sub_u32 s32, s32, L_F2Q10-L_F2B10
    s_subb_u32 s33, s33, 0
    s_branch L_F2PUB
L_F2P11:
    s_getpc_b64 s[32:33]
L_F2Q11:
    s_sub_u32 s32, s32, L_F2Q11-L_F2B11
    s_subb_u32 s33, s33, 0
    s_branch L_F2PUB
L_F2P12:
    s_getpc_b64 s[32:33]
L_F2Q12:
    s_sub_u32 s32, s32, L_F2Q12-L_F2B12
    s_subb_u32 s33, s33, 0
    s_branch L_F2PUB
L_F2P13:
    s_getpc_b64 s[32:33]
L_F2Q13:
    s_sub_u32 s32, s32, L_F2Q13-L_F2B13
    s_subb_u32 s33, s33, 0
    s_branch L_F2PUB
L_F2P14:
    s_getpc_b64 s[32:33]
L_F2Q14:
    s_sub_u32 s32, s32, L_F2Q14-L_F2B14
    s_subb_u32 s33, s33, 0
    s_branch L_F2PUB
    .p2align 6
L_TABLE:
    .long 1, 2, 3, 4, 5, 6, 7, 8, 9, 10, 11, 12, 13, 14, 15, 16, 17, 18, 19, 20, 21, 22, 23, 24, 25, 26, 27, 28, 29, 30, 31, 32

.section .rodata,"a"
.p2align 6
.amdhsa_kernel parallel_sum__ssm_conv_s4d__glu_gated_reglu__prompt_kernel
  .amdhsa_next_free_vgpr 256
  .amdhsa_next_free_sgpr 102
  .amdhsa_accum_offset 256
  .amdhsa_group_segment_fixed_size 0
  .amdhsa_kernarg_size 112
  .amdhsa_user_sgpr_count 2
  .amdhsa_user_sgpr_kernarg_segment_ptr 1
  .amdhsa_system_sgpr_workgroup_id_x 1
.end_amdhsa_kernel
```
